```python
import torch

def _softmax(x, axis=-1):
    return torch.softmax(x, dim=axis)
def _gelu(x):
    return torch.nn.functional.gelu(x, approximate="tanh")
def _silu(x):
    return torch.nn.functional.silu(x)
def _sigmoid(x):
    return torch.sigmoid(x)
def _layernorm(x, axis=-1, eps=1e-5):
    m = x.mean(dim=axis, keepdim=True)
    v = x.var(dim=axis, keepdim=True, unbiased=False)
    return (x - m) / torch.sqrt(v + eps)
def _scatter_add(tgt, idx, src, axis=0):
    return tgt.clone().index_add_(axis, idx, src)
def _segment_sum(src, seg, n):
    out = torch.zeros((n,) + src.shape[1:], dtype=src.dtype)
    return out.index_add_(0, seg, src)
def _pad(x, pw):
    flat = tuple(v for pair in reversed(pw) for v in pair)
    return torch.nn.functional.pad(x, flat)

kernel_name = 'recurrent_scan__grouped_kv_mqa__mixer_channel_mlp__prompt'

def setup_inputs():

    _w = (lambda a: (lambda t: t.to(torch.bfloat16) if t.is_floating_point() else t)(torch.as_tensor(a)))
    def _A_setup():
        B, S, D, H = 1, 2048, 512, 32
        Dh = D // H
        return {
            "x": _w((lambda *s: torch.randn(*s, dtype=torch.bfloat16) * 0.05)(B, S, D)),
            "wq": _w((lambda *s: torch.randn(*s, dtype=torch.bfloat16) * 0.05)(D, H * Dh)),
            "wk": _w((lambda *s: torch.randn(*s, dtype=torch.bfloat16) * 0.05)(D, Dh)),
            "wv": _w((lambda *s: torch.randn(*s, dtype=torch.bfloat16) * 0.05)(D, Dh)),
            "wo": _w((lambda *s: torch.randn(*s, dtype=torch.bfloat16) * 0.05)(H * Dh, D)),
        }
    _A_in = _A_setup()

    def _B_setup():
        B, S, D, F = 1, 2048, 512, 1376
        return {
            "x": _w((lambda *s: torch.randn(*s, dtype=torch.bfloat16) * 0.05)(B, S, D)),
            "w1": _w((lambda *s: torch.randn(*s, dtype=torch.bfloat16) * 3.2)(D, F) * (D ** -0.5)),
            "b1": _w((lambda *s: torch.randn(*s, dtype=torch.bfloat16) * 1.6)(F)),
            "w2": _w((lambda *s: torch.randn(*s, dtype=torch.bfloat16) * 0.05)(F, D) * (F ** -0.5)),
            "b2": _w((lambda *s: torch.randn(*s, dtype=torch.bfloat16) * 0.05)(D)),
        }
    _B_in = _B_setup()

    return {
        "A_x": _A_in["x"],
        "A_wq": _A_in["wq"],
        "A_wk": _A_in["wk"],
        "A_wv": _A_in["wv"],
        "A_wo": _A_in["wo"],
        "B_x": _B_in["x"],
        "B_w1": _B_in["w1"],
        "B_b1": _B_in["b1"],
        "B_w2": _B_in["w2"],
        "B_b2": _B_in["b2"],
    }

def reference(A_x, A_wq, A_wk, A_wv, A_wo, B_x, B_w1, B_b1, B_w2, B_b2):
    def _A_ref(x, wq, wk, wv, wo):
        B, S, D = x.shape
        H = 32
        Dh = D // H
        q = (lambda x, *d: x.permute(*d))((x @ wq).reshape(B, S, H, Dh), 0, 2, 1, 3)
        k = x @ wk
        v = x @ wv
        scores = torch.einsum("bhqd,bkd->bhqk", q, k) * (Dh ** -0.5)
        p = _softmax(scores, axis=-1)
        o = torch.einsum("bhqk,bkd->bhqd", p, v)
        return (lambda x, *d: x.permute(*d))(o, 0, 2, 1, 3).reshape(B, S, H * Dh) @ wo

    def _B_ref(x, w1, b1, w2, b2):
        y = _layernorm(x, axis=-1)
        h = _gelu(torch.einsum("bsd,df->bsf", y, w1) + b1)
        return torch.einsum("bsf,fd->bsd", h, w2) + b2

    x = A_x
    xn = _layernorm(x, axis=-1)
    s = _A_ref(xn, A_wq, A_wk, A_wv, A_wo)
    g = _silu(_B_ref(xn, B_w1, B_b1, B_w2, B_b2))
    return x + s * g
```

```asm
; @launch grid=(256,1,1) block=(512,1,1) lds=157696
.amdgcn_target "amdgcn-amd-amdhsa--gfx950"
.text
.globl recurrent_scan__grouped_kv_mqa__mixer_channel_mlp__prompt_kernel
.p2align 8
.type recurrent_scan__grouped_kv_mqa__mixer_channel_mlp__prompt_kernel,@function
recurrent_scan__grouped_kv_mqa__mixer_channel_mlp__prompt_kernel:
    s_load_dwordx2 s[4:5], s[0:1], 0
    s_load_dwordx4 s[48:51], s[0:1], 16
    s_load_dwordx2 s[8:9], s[0:1], 96
    s_load_dwordx2 s[12:13], s[0:1], 8
    s_cmp_ge_u32 s2, 256
    s_cbranch_scc1 L_exit
    s_getpc_b64 s[60:61]
L_pc:
    v_lshrrev_b32 v7, 6, v0
    v_and_b32 v1, 63, v0
    v_lshlrev_b32 v118, 7, v0
    v_min_u32 v118, L_code_end-L_pc-4, v118
    v_mov_b32 v121, s61
    v_add_co_u32 v120, vcc, s60, v118
    s_nop 1
    v_addc_co_u32 v121, vcc, 0, v121, vcc
    global_load_dword v6, v[120:121], off
    v_readfirstlane_b32 s44, v7
    s_load_dwordx2 s[20:21], s[0:1], 48
    s_load_dwordx2 s[32:33], s[0:1], 56
    s_load_dwordx2 s[24:25], s[0:1], 64
    s_load_dwordx2 s[36:37], s[0:1], 72
    s_load_dwordx2 s[40:41], s[0:1], 80
    s_load_dwordx2 s[28:29], s[0:1], 32
    s_and_b32 s3, s2, 7
    s_lshr_b32 s54, s2, 3
    s_and_b32 s46, s54, 7
    s_lshr_b32 s54, s54, 3
    s_lshl_b32 s3, s3, 2
    s_add_u32 s45, s3, s54
    s_lshl_b32 s55, s54, 3
    s_and_b32 s3, s2, 7
    s_add_u32 s55, s55, s3
    s_lshr_b32 s52, s46, 1
    s_and_b32 s53, s44, 3
    v_lshlrev_b32 v2, 4, v1
    v_lshrrev_b32 v3, 4, v1
    v_and_b32 v4, 15, v1
    v_lshlrev_b32 v8, 10, v3
    v_lshl_add_u32 v8, v4, 4, v8
    s_mov_b32 s6, 2097152
    s_mov_b32 s7, 0x20000
    s_lshr_b32 s3, s44, 2
    s_add_u32 s3, s3, s52
    s_and_b32 s3, s3, 3
    s_lshl_b32 s3, s3, 2
    s_add_u32 s57, s3, s53
    s_lshl_b32 s57, s57, 2
    s_lshl_b32 s56, s45, 16
    s_lshl_b32 s58, s57, 10
    s_add_u32 s58, s58, s56
    v_mov_b32 v12, 157184
    v_mov_b32 v10, 0
    v_mov_b32 v11, 0
    s_mov_b64 exec, 15
    v_lshl_add_u32 v13, v1, 3, v12
    ds_write_b64 v13, v[10:11]
    s_mov_b64 exec, -1
    s_and_b32 s3, s46, 1
    s_cmp_eq_u32 s3, 0
    s_waitcnt lgkmcnt(0)
    s_cselect_b32 s16, s48, s50
    s_cselect_b32 s17, s49, s51
    s_mov_b32 s1, s55
    s_mov_b32 s18, 16384
    s_mov_b32 s19, 0x20000
    s_cmp_lg_u32 s44, 7
    s_cbranch_scc1 L_nowkv
    s_mov_b32 m0, 132096
    s_mov_b32 s3, 0
    buffer_load_dwordx4 v2, s[16:19], s3 offen offset:0 lds
    buffer_load_dwordx4 v2, s[16:19], s3 offen offset:1024 lds
    buffer_load_dwordx4 v2, s[16:19], s3 offen offset:2048 lds
    buffer_load_dwordx4 v2, s[16:19], s3 offen offset:3072 lds
    s_mov_b32 m0, 136192
    s_mov_b32 s3, 4096
    buffer_load_dwordx4 v2, s[16:19], s3 offen offset:0 lds
    buffer_load_dwordx4 v2, s[16:19], s3 offen offset:1024 lds
    buffer_load_dwordx4 v2, s[16:19], s3 offen offset:2048 lds
    buffer_load_dwordx4 v2, s[16:19], s3 offen offset:3072 lds
    s_mov_b32 m0, 140288
    s_mov_b32 s3, 8192
    buffer_load_dwordx4 v2, s[16:19], s3 offen offset:0 lds
    buffer_load_dwordx4 v2, s[16:19], s3 offen offset:1024 lds
    buffer_load_dwordx4 v2, s[16:19], s3 offen offset:2048 lds
    buffer_load_dwordx4 v2, s[16:19], s3 offen offset:3072 lds
    s_mov_b32 m0, 144384
    s_mov_b32 s3, 12288
    buffer_load_dwordx4 v2, s[16:19], s3 offen offset:0 lds
    buffer_load_dwordx4 v2, s[16:19], s3 offen offset:1024 lds
    buffer_load_dwordx4 v2, s[16:19], s3 offen offset:2048 lds
    buffer_load_dwordx4 v2, s[16:19], s3 offen offset:3072 lds
L_nowkv:
    buffer_load_dwordx4 v[16:19], v8, s[4:7], s58 offen offset:0
    buffer_load_dwordx4 v[20:23], v8, s[4:7], s58 offen offset:256
    buffer_load_dwordx4 v[24:27], v8, s[4:7], s58 offen offset:512
    buffer_load_dwordx4 v[28:31], v8, s[4:7], s58 offen offset:768
    s_nop 0
    s_load_dword s47, s[8:9], 0
    s_getreg_b32 s100, hwreg(HW_REG_XCC_ID, 0, 4)
    v_lshrrev_b32 v15, 3, v1
    v_and_b32 v5, 7, v1
    s_mov_b32 s10, 16777216
    s_mov_b32 s11, 0x20000
    s_mov_b32 s14, 524288
    s_mov_b32 s15, 0x20000
    s_mov_b32 s22, 1409024
    s_mov_b32 s23, 0x20000
    s_mov_b32 s26, 1409024
    s_mov_b32 s27, 0x20000
    s_mov_b32 s30, 524288
    s_mov_b32 s31, 0x20000
    s_mov_b32 s34, 2752
    s_mov_b32 s35, 0x20000
    s_mov_b32 s38, 1024
    s_mov_b32 s39, 0x20000
    s_mov_b32 s42, 2097152
    s_mov_b32 s43, 0x20000
    s_mov_b32 s64, 0x3f803f80
    s_mov_b32 s65, 0x00003f80
    s_mov_b32 s66, 0x3f800000
    v_add_u32 v3, s57, v3
    v_mul_u32_u24 v10, 1040, v3
    v_lshl_add_u32 v10, v4, 4, v10
    v_lshlrev_b32 v11, 2, v3
    v_add_u32 v11, 156672, v11
    v_mov_b32 v13, 1
    s_cmp_ge_u32 s44, 4
    s_cbranch_scc1 L_G
    s_setprio 2
    v_mov_b32 v92, 0
    v_mov_b32 v93, 0
    v_mov_b32 v94, 0
    v_mov_b32 v95, 0
    s_add_u32 s62, s2, 0
    s_and_b32 s62, s62, 6
    s_lshl_b32 s3, s62, 3
    v_add_u32 v125, s3, v1
    v_and_b32 v125, 63, v125
    v_lshlrev_b32 v125, 3, v125
    s_lshl_b32 s62, s62, 12
    s_add_u32 s20, s62, 0
    s_and_b32 s20, s20, 0x7fff
    s_add_u32 s21, s62, 4096
    s_and_b32 s21, s21, 0x7fff
    s_add_u32 s22, s62, 8192
    s_and_b32 s22, s22, 0x7fff
    s_add_u32 s23, s62, 12288
    s_and_b32 s23, s23, 0x7fff
    s_add_u32 s24, s62, 16384
    s_and_b32 s24, s24, 0x7fff
    s_add_u32 s25, s62, 20480
    s_and_b32 s25, s25, 0x7fff
    s_add_u32 s26, s62, 24576
    s_and_b32 s26, s26, 0x7fff
    s_add_u32 s27, s62, 28672
    s_and_b32 s27, s27, 0x7fff
    v_mov_b32 v116, 0xdddddddd
    v_mfma_f32_32x32x16_bf16 v[128:143], v[92:95], v[92:95], 0
    v_mfma_f32_32x32x16_bf16 v[144:159], v[92:95], v[92:95], 0
    v_mfma_f32_32x32x16_bf16 v[160:175], v[92:95], v[92:95], 0
    v_mfma_f32_32x32x16_bf16 v[176:191], v[92:95], v[92:95], 0
    v_mfma_f32_32x32x16_bf16 v[192:207], v[92:95], v[92:95], 0
    v_mfma_f32_32x32x16_bf16 v[208:223], v[92:95], v[92:95], 0
    v_mfma_f32_32x32x16_bf16 v[224:239], v[92:95], v[92:95], 0
    v_mfma_f32_32x32x16_bf16 v[240:255], v[92:95], v[92:95], 0
    v_and_b32 v9, 15, v1
    v_lshrrev_b32 v7, 5, v1
    v_lshl_add_u32 v9, v7, 4, v9
    v_lshlrev_b32 v9, 4, v9
    s_lshl_b32 s63, s53, 15
    s_add_u32 s63, s63, 65536
    s_add_u32 s3, s63, 1024
    v_add_u32 v117, s3, v9
    s_lshr_b32 s3, s44, 1
    s_lshl_b32 s3, s3, 12
    s_and_b32 s54, s44, 1
    s_lshl_b32 s54, s54, 10
    s_add_u32 s3, s3, s54
    s_add_u32 s3, s3, 148480
    v_add_u32 v124, s3, v2
    s_mov_b32 s68, 0x0000ffff
    s_mov_b32 s69, 0x0000ffff
    v_and_b32 v7, 27, v1
    v_cmp_eq_u32 vcc, 16, v7
    v_mov_b32 v7, s64
    s_nop 0
    v_cndmask_b32 v92, 0, v7, vcc
    s_add_u32 s3, s53, 1
    s_and_b32 s3, s3, 3
    s_mul_i32 s3, s3, 13824
    s_add_u32 s3, s3, 9216
    v_add_u32 v118, s3, v2
    s_add_u32 s3, s3, 4096
    v_lshl_add_u32 v121, v1, 2, s3
    s_add_u32 s3, s53, 2
    s_and_b32 s3, s3, 3
    s_mul_i32 s3, s3, 13824
    s_add_u32 s3, s3, 4608
    v_add_u32 v119, s3, v2
    s_add_u32 s3, s3, 4096
    v_lshl_add_u32 v122, v1, 2, s3
    s_add_u32 s3, s53, 3
    s_and_b32 s3, s3, 3
    s_mul_i32 s3, s3, 13824
    s_add_u32 s3, s3, 0
    v_add_u32 v120, s3, v2
    s_add_u32 s3, s3, 4096
    v_lshl_add_u32 v123, v1, 2, s3
    v_mov_b32 v93, v92
    v_mov_b32 v94, v92
    v_mov_b32 v95, v92
    v_mov_b32 v96, v92
    v_mov_b32 v97, v92
    v_mov_b32 v98, v92
    v_mov_b32 v99, v92
    v_mov_b32 v100, v92
    v_mov_b32 v101, v92
    v_mov_b32 v102, v92
    v_mov_b32 v103, v92
    v_mov_b32 v104, v92
    v_mov_b32 v105, v92
    v_mov_b32 v106, v92
    v_mov_b32 v107, v92
    v_mov_b32 v108, v92
    v_mov_b32 v109, v92
    v_mov_b32 v110, v92
    v_mov_b32 v111, v92
    v_mov_b32 v112, v92
    v_mov_b32 v113, v92
    v_mov_b32 v114, v92
    v_mov_b32 v115, v92
    v_lshlrev_b32 v7, 10, v15
    v_lshl_add_u32 v7, v5, 4, v7
    s_lshr_b32 s3, s53, 1
    s_add_u32 s3, s3, s52
    s_add_u32 s3, s3, 2
    s_and_b32 s3, s3, 3
    s_lshl_b32 s3, s3, 1
    s_and_b32 s59, s53, 1
    s_add_u32 s59, s59, s3
    s_lshl_b32 s59, s59, 3
    s_lshl_b32 s58, s59, 10
    s_add_u32 s58, s58, s56
    buffer_load_dwordx4 v[32:35], v7, s[4:7], s58 offen offset:0
    buffer_load_dwordx4 v[36:39], v7, s[4:7], s58 offen offset:128
    buffer_load_dwordx4 v[40:43], v7, s[4:7], s58 offen offset:256
    buffer_load_dwordx4 v[44:47], v7, s[4:7], s58 offen offset:384
    buffer_load_dwordx4 v[48:51], v7, s[4:7], s58 offen offset:512
    buffer_load_dwordx4 v[52:55], v7, s[4:7], s58 offen offset:640
    buffer_load_dwordx4 v[56:59], v7, s[4:7], s58 offen offset:768
    buffer_load_dwordx4 v[60:63], v7, s[4:7], s58 offen offset:896
    s_barrier
    v_add_u32 v8, s59, v15
    v_mul_u32_u24 v14, 1040, v8
    v_lshl_add_u32 v14, v5, 4, v14
    v_lshlrev_b32 v15, 2, v8
    v_add_u32 v15, 156672, v15
    s_waitcnt vmcnt(8)
    v_dot2_f32_bf16 v64, v16, s64, 0
    v_dot2_f32_bf16 v65, v16, v16, 0
    v_dot2_f32_bf16 v64, v17, s64, v64
    v_dot2_f32_bf16 v65, v17, v17, v65
    v_dot2_f32_bf16 v64, v18, s64, v64
    v_dot2_f32_bf16 v65, v18, v18, v65
    v_dot2_f32_bf16 v64, v19, s64, v64
    v_dot2_f32_bf16 v65, v19, v19, v65
    v_dot2_f32_bf16 v64, v20, s64, v64
    v_dot2_f32_bf16 v65, v20, v20, v65
    v_dot2_f32_bf16 v64, v21, s64, v64
    v_dot2_f32_bf16 v65, v21, v21, v65
    v_dot2_f32_bf16 v64, v22, s64, v64
    v_dot2_f32_bf16 v65, v22, v22, v65
    v_dot2_f32_bf16 v64, v23, s64, v64
    v_dot2_f32_bf16 v65, v23, v23, v65
    v_dot2_f32_bf16 v64, v24, s64, v64
    v_dot2_f32_bf16 v65, v24, v24, v65
    v_dot2_f32_bf16 v64, v25, s64, v64
    v_dot2_f32_bf16 v65, v25, v25, v65
    v_dot2_f32_bf16 v64, v26, s64, v64
    v_dot2_f32_bf16 v65, v26, v26, v65
    v_dot2_f32_bf16 v64, v27, s64, v64
    v_dot2_f32_bf16 v65, v27, v27, v65
    v_dot2_f32_bf16 v64, v28, s64, v64
    v_dot2_f32_bf16 v65, v28, v28, v65
    v_dot2_f32_bf16 v64, v29, s64, v64
    v_dot2_f32_bf16 v65, v29, v29, v65
    v_dot2_f32_bf16 v64, v30, s64, v64
    v_dot2_f32_bf16 v65, v30, v30, v65
    v_dot2_f32_bf16 v64, v31, s64, v64
    v_dot2_f32_bf16 v65, v31, v31, v65
    s_nop 1
    v_add_f32_dpp v64, v64, v64 quad_perm:[1,0,3,2] row_mask:0xf bank_mask:0xf
    v_add_f32_dpp v65, v65, v65 quad_perm:[1,0,3,2] row_mask:0xf bank_mask:0xf
    s_nop 0
    v_add_f32_dpp v64, v64, v64 quad_perm:[2,3,0,1] row_mask:0xf bank_mask:0xf
    v_add_f32_dpp v65, v65, v65 quad_perm:[2,3,0,1] row_mask:0xf bank_mask:0xf
    s_nop 0
    v_add_f32_dpp v64, v64, v64 row_half_mirror row_mask:0xf bank_mask:0xf
    v_add_f32_dpp v65, v65, v65 row_half_mirror row_mask:0xf bank_mask:0xf
    s_nop 0
    v_add_f32_dpp v64, v64, v64 row_mirror row_mask:0xf bank_mask:0xf
    v_add_f32_dpp v65, v65, v65 row_mirror row_mask:0xf bank_mask:0xf
    v_mul_f32 v64, 0xbb000000, v64
    v_mul_f32 v65, 0x3b000000, v65
    v_dot2_f32_bf16 v66, v16, s65, v64
    v_dot2_f32_bf16 v67, v16, s66, v64
    v_dot2_f32_bf16 v68, v17, s65, v64
    v_dot2_f32_bf16 v69, v17, s66, v64
    v_dot2_f32_bf16 v70, v18, s65, v64
    v_dot2_f32_bf16 v71, v18, s66, v64
    v_dot2_f32_bf16 v72, v19, s65, v64
    v_dot2_f32_bf16 v73, v19, s66, v64
    v_dot2_f32_bf16 v74, v20, s65, v64
    v_dot2_f32_bf16 v75, v20, s66, v64
    v_dot2_f32_bf16 v76, v21, s65, v64
    v_dot2_f32_bf16 v77, v21, s66, v64
    v_dot2_f32_bf16 v78, v22, s65, v64
    v_dot2_f32_bf16 v79, v22, s66, v64
    v_dot2_f32_bf16 v80, v23, s65, v64
    v_dot2_f32_bf16 v81, v23, s66, v64
    v_fma_f32 v65, -v64, v64, v65
    v_max_f32 v65, 0, v65
    v_add_f32 v82, 0x3727c5ac, v65
    v_cvt_pk_bf16_f32 v16, v66, v67
    v_cvt_pk_bf16_f32 v17, v68, v69
    v_cvt_pk_bf16_f32 v18, v70, v71
    v_cvt_pk_bf16_f32 v19, v72, v73
    ds_write_b128 v10, v[16:19] offset:0
    v_dot2_f32_bf16 v66, v24, s65, v64
    v_dot2_f32_bf16 v67, v24, s66, v64
    v_dot2_f32_bf16 v68, v25, s65, v64
    v_dot2_f32_bf16 v69, v25, s66, v64
    v_dot2_f32_bf16 v70, v26, s65, v64
    v_dot2_f32_bf16 v71, v26, s66, v64
    v_dot2_f32_bf16 v72, v27, s65, v64
    v_dot2_f32_bf16 v73, v27, s66, v64
    v_rsq_f32 v82, v82
    s_nop 0
    v_mul_f32 v65, v82, v65
    v_cvt_pk_bf16_f32 v20, v74, v75
    v_cvt_pk_bf16_f32 v21, v76, v77
    v_cvt_pk_bf16_f32 v22, v78, v79
    v_cvt_pk_bf16_f32 v23, v80, v81
    ds_write_b128 v10, v[20:23] offset:256
    v_dot2_f32_bf16 v74, v28, s65, v64
    v_dot2_f32_bf16 v75, v28, s66, v64
    v_dot2_f32_bf16 v76, v29, s65, v64
    v_dot2_f32_bf16 v77, v29, s66, v64
    v_dot2_f32_bf16 v78, v30, s65, v64
    v_dot2_f32_bf16 v79, v30, s66, v64
    v_dot2_f32_bf16 v80, v31, s65, v64
    v_dot2_f32_bf16 v81, v31, s66, v64
    v_mul_f32 v65, v82, v65
    v_add_f32 v65, 0x3727c5ac, v65
    v_rsq_f32 v65, v65
    v_cvt_pk_bf16_f32 v24, v66, v67
    v_cvt_pk_bf16_f32 v25, v68, v69
    v_cvt_pk_bf16_f32 v26, v70, v71
    v_cvt_pk_bf16_f32 v27, v72, v73
    ds_write_b128 v10, v[24:27] offset:512
    v_mul_f32 v65, v82, v65
    v_cvt_pk_bf16_f32 v28, v74, v75
    v_cvt_pk_bf16_f32 v29, v76, v77
    v_cvt_pk_bf16_f32 v30, v78, v79
    v_cvt_pk_bf16_f32 v31, v80, v81
    ds_write_b128 v10, v[28:31] offset:768
    s_mov_b32 exec_lo, 0x00010001
    s_mov_b32 exec_hi, 0x00010001
    ds_write2st64_b32 v11, v82, v65 offset1:1
    s_mov_b64 exec, -1
    s_mov_b64 exec, 1
    ds_add_u32 v12, v13 offset:16
    s_mov_b64 exec, -1
    s_waitcnt vmcnt(0)
    v_dot2_f32_bf16 v64, v32, s64, 0
    v_dot2_f32_bf16 v65, v32, v32, 0
    v_dot2_f32_bf16 v64, v33, s64, v64
    v_dot2_f32_bf16 v65, v33, v33, v65
    v_dot2_f32_bf16 v64, v34, s64, v64
    v_dot2_f32_bf16 v65, v34, v34, v65
    v_dot2_f32_bf16 v64, v35, s64, v64
    v_dot2_f32_bf16 v65, v35, v35, v65
    v_dot2_f32_bf16 v64, v36, s64, v64
    v_dot2_f32_bf16 v65, v36, v36, v65
    v_dot2_f32_bf16 v64, v37, s64, v64
    v_dot2_f32_bf16 v65, v37, v37, v65
    v_dot2_f32_bf16 v64, v38, s64, v64
    v_dot2_f32_bf16 v65, v38, v38, v65
    v_dot2_f32_bf16 v64, v39, s64, v64
    v_dot2_f32_bf16 v65, v39, v39, v65
    v_dot2_f32_bf16 v64, v40, s64, v64
    v_dot2_f32_bf16 v65, v40, v40, v65
    v_dot2_f32_bf16 v64, v41, s64, v64
    v_dot2_f32_bf16 v65, v41, v41, v65
    v_dot2_f32_bf16 v64, v42, s64, v64
    v_dot2_f32_bf16 v65, v42, v42, v65
    v_dot2_f32_bf16 v64, v43, s64, v64
    v_dot2_f32_bf16 v65, v43, v43, v65
    v_dot2_f32_bf16 v64, v44, s64, v64
    v_dot2_f32_bf16 v65, v44, v44, v65
    v_dot2_f32_bf16 v64, v45, s64, v64
    v_dot2_f32_bf16 v65, v45, v45, v65
    v_dot2_f32_bf16 v64, v46, s64, v64
    v_dot2_f32_bf16 v65, v46, v46, v65
    v_dot2_f32_bf16 v64, v47, s64, v64
    v_dot2_f32_bf16 v65, v47, v47, v65
    v_dot2_f32_bf16 v64, v48, s64, v64
    v_dot2_f32_bf16 v65, v48, v48, v65
    v_dot2_f32_bf16 v64, v49, s64, v64
    v_dot2_f32_bf16 v65, v49, v49, v65
    v_dot2_f32_bf16 v64, v50, s64, v64
    v_dot2_f32_bf16 v65, v50, v50, v65
    v_dot2_f32_bf16 v64, v51, s64, v64
    v_dot2_f32_bf16 v65, v51, v51, v65
    v_dot2_f32_bf16 v64, v52, s64, v64
    v_dot2_f32_bf16 v65, v52, v52, v65
    v_dot2_f32_bf16 v64, v53, s64, v64
    v_dot2_f32_bf16 v65, v53, v53, v65
    v_dot2_f32_bf16 v64, v54, s64, v64
    v_dot2_f32_bf16 v65, v54, v54, v65
    v_dot2_f32_bf16 v64, v55, s64, v64
    v_dot2_f32_bf16 v65, v55, v55, v65
    v_dot2_f32_bf16 v64, v56, s64, v64
    v_dot2_f32_bf16 v65, v56, v56, v65
    v_dot2_f32_bf16 v64, v57, s64, v64
    v_dot2_f32_bf16 v65, v57, v57, v65
    v_dot2_f32_bf16 v64, v58, s64, v64
    v_dot2_f32_bf16 v65, v58, v58, v65
    v_dot2_f32_bf16 v64, v59, s64, v64
    v_dot2_f32_bf16 v65, v59, v59, v65
    v_dot2_f32_bf16 v64, v60, s64, v64
    v_dot2_f32_bf16 v65, v60, v60, v65
    v_dot2_f32_bf16 v64, v61, s64, v64
    v_dot2_f32_bf16 v65, v61, v61, v65
    v_dot2_f32_bf16 v64, v62, s64, v64
    v_dot2_f32_bf16 v65, v62, v62, v65
    v_dot2_f32_bf16 v64, v63, s64, v64
    v_dot2_f32_bf16 v65, v63, v63, v65
    s_nop 1
    v_add_f32_dpp v64, v64, v64 quad_perm:[1,0,3,2] row_mask:0xf bank_mask:0xf
    v_add_f32_dpp v65, v65, v65 quad_perm:[1,0,3,2] row_mask:0xf bank_mask:0xf
    s_nop 0
    v_add_f32_dpp v64, v64, v64 quad_perm:[2,3,0,1] row_mask:0xf bank_mask:0xf
    v_add_f32_dpp v65, v65, v65 quad_perm:[2,3,0,1] row_mask:0xf bank_mask:0xf
    s_nop 0
    v_add_f32_dpp v64, v64, v64 row_half_mirror row_mask:0xf bank_mask:0xf
    v_add_f32_dpp v65, v65, v65 row_half_mirror row_mask:0xf bank_mask:0xf
    v_mul_f32 v64, 0xbb000000, v64
    v_mul_f32 v65, 0x3b000000, v65
    v_dot2_f32_bf16 v66, v32, s65, v64
    v_dot2_f32_bf16 v67, v32, s66, v64
    v_dot2_f32_bf16 v68, v33, s65, v64
    v_dot2_f32_bf16 v69, v33, s66, v64
    v_dot2_f32_bf16 v70, v34, s65, v64
    v_dot2_f32_bf16 v71, v34, s66, v64
    v_dot2_f32_bf16 v72, v35, s65, v64
    v_dot2_f32_bf16 v73, v35, s66, v64
    v_dot2_f32_bf16 v74, v36, s65, v64
    v_dot2_f32_bf16 v75, v36, s66, v64
    v_dot2_f32_bf16 v76, v37, s65, v64
    v_dot2_f32_bf16 v77, v37, s66, v64
    v_dot2_f32_bf16 v78, v38, s65, v64
    v_dot2_f32_bf16 v79, v38, s66, v64
    v_dot2_f32_bf16 v80, v39, s65, v64
    v_dot2_f32_bf16 v81, v39, s66, v64
    v_fma_f32 v65, -v64, v64, v65
    v_max_f32 v65, 0, v65
    v_add_f32 v82, 0x3727c5ac, v65
    v_cvt_pk_bf16_f32 v32, v66, v67
    v_cvt_pk_bf16_f32 v33, v68, v69
    v_cvt_pk_bf16_f32 v34, v70, v71
    v_cvt_pk_bf16_f32 v35, v72, v73
    ds_write_b128 v14, v[32:35] offset:0
    v_dot2_f32_bf16 v66, v40, s65, v64
    v_dot2_f32_bf16 v67, v40, s66, v64
    v_dot2_f32_bf16 v68, v41, s65, v64
    v_dot2_f32_bf16 v69, v41, s66, v64
    v_dot2_f32_bf16 v70, v42, s65, v64
    v_dot2_f32_bf16 v71, v42, s66, v64
    v_dot2_f32_bf16 v72, v43, s65, v64
    v_dot2_f32_bf16 v73, v43, s66, v64
    v_rsq_f32 v82, v82
    s_nop 0
    v_mul_f32 v65, v82, v65
    v_cvt_pk_bf16_f32 v36, v74, v75
    v_cvt_pk_bf16_f32 v37, v76, v77
    v_cvt_pk_bf16_f32 v38, v78, v79
    v_cvt_pk_bf16_f32 v39, v80, v81
    ds_write_b128 v14, v[36:39] offset:128
    v_dot2_f32_bf16 v74, v44, s65, v64
    v_dot2_f32_bf16 v75, v44, s66, v64
    v_dot2_f32_bf16 v76, v45, s65, v64
    v_dot2_f32_bf16 v77, v45, s66, v64
    v_dot2_f32_bf16 v78, v46, s65, v64
    v_dot2_f32_bf16 v79, v46, s66, v64
    v_dot2_f32_bf16 v80, v47, s65, v64
    v_dot2_f32_bf16 v81, v47, s66, v64
    v_mul_f32 v65, v82, v65
    v_add_f32 v65, 0x3727c5ac, v65
    v_rsq_f32 v65, v65
    v_cvt_pk_bf16_f32 v40, v66, v67
    v_cvt_pk_bf16_f32 v41, v68, v69
    v_cvt_pk_bf16_f32 v42, v70, v71
    v_cvt_pk_bf16_f32 v43, v72, v73
    ds_write_b128 v14, v[40:43] offset:256
    v_dot2_f32_bf16 v66, v48, s65, v64
    v_dot2_f32_bf16 v67, v48, s66, v64
    v_dot2_f32_bf16 v68, v49, s65, v64
    v_dot2_f32_bf16 v69, v49, s66, v64
    v_dot2_f32_bf16 v70, v50, s65, v64
    v_dot2_f32_bf16 v71, v50, s66, v64
    v_dot2_f32_bf16 v72, v51, s65, v64
    v_dot2_f32_bf16 v73, v51, s66, v64
    v_mul_f32 v65, v82, v65
    v_cvt_pk_bf16_f32 v44, v74, v75
    v_cvt_pk_bf16_f32 v45, v76, v77
    v_cvt_pk_bf16_f32 v46, v78, v79
    v_cvt_pk_bf16_f32 v47, v80, v81
    ds_write_b128 v14, v[44:47] offset:384
    v_dot2_f32_bf16 v74, v52, s65, v64
    v_dot2_f32_bf16 v75, v52, s66, v64
    v_dot2_f32_bf16 v76, v53, s65, v64
    v_dot2_f32_bf16 v77, v53, s66, v64
    v_dot2_f32_bf16 v78, v54, s65, v64
    v_dot2_f32_bf16 v79, v54, s66, v64
    v_dot2_f32_bf16 v80, v55, s65, v64
    v_dot2_f32_bf16 v81, v55, s66, v64
    v_cvt_pk_bf16_f32 v48, v66, v67
    v_cvt_pk_bf16_f32 v49, v68, v69
    v_cvt_pk_bf16_f32 v50, v70, v71
    v_cvt_pk_bf16_f32 v51, v72, v73
    ds_write_b128 v14, v[48:51] offset:512
    v_dot2_f32_bf16 v66, v56, s65, v64
    v_dot2_f32_bf16 v67, v56, s66, v64
    v_dot2_f32_bf16 v68, v57, s65, v64
    v_dot2_f32_bf16 v69, v57, s66, v64
    v_dot2_f32_bf16 v70, v58, s65, v64
    v_dot2_f32_bf16 v71, v58, s66, v64
    v_dot2_f32_bf16 v72, v59, s65, v64
    v_dot2_f32_bf16 v73, v59, s66, v64
    v_cvt_pk_bf16_f32 v52, v74, v75
    v_cvt_pk_bf16_f32 v53, v76, v77
    v_cvt_pk_bf16_f32 v54, v78, v79
    v_cvt_pk_bf16_f32 v55, v80, v81
    ds_write_b128 v14, v[52:55] offset:640
    v_dot2_f32_bf16 v74, v60, s65, v64
    v_dot2_f32_bf16 v75, v60, s66, v64
    v_dot2_f32_bf16 v76, v61, s65, v64
    v_dot2_f32_bf16 v77, v61, s66, v64
    v_dot2_f32_bf16 v78, v62, s65, v64
    v_dot2_f32_bf16 v79, v62, s66, v64
    v_dot2_f32_bf16 v80, v63, s65, v64
    v_dot2_f32_bf16 v81, v63, s66, v64
    v_cvt_pk_bf16_f32 v56, v66, v67
    v_cvt_pk_bf16_f32 v57, v68, v69
    v_cvt_pk_bf16_f32 v58, v70, v71
    v_cvt_pk_bf16_f32 v59, v72, v73
    ds_write_b128 v14, v[56:59] offset:768
    v_cvt_pk_bf16_f32 v60, v74, v75
    v_cvt_pk_bf16_f32 v61, v76, v77
    v_cvt_pk_bf16_f32 v62, v78, v79
    v_cvt_pk_bf16_f32 v63, v80, v81
    ds_write_b128 v14, v[60:63] offset:896
    s_mov_b32 exec_lo, 0x01010101
    s_mov_b32 exec_hi, 0x01010101
    ds_write2st64_b32 v15, v82, v65 offset1:1
    s_mov_b64 exec, -1
    s_and_b32 s56, s44, 1
    s_lshr_b32 s57, s44, 1
    v_and_b32 v5, 31, v1
    s_lshl_b32 s3, s56, 5
    v_add_u32 v5, s3, v5
    v_mul_u32_u24 v3, 1040, v5
    v_lshrrev_b32 v7, 5, v1
    v_lshl_add_u32 v3, v7, 4, v3
    v_lshlrev_b32 v5, 2, v5
    v_add_u32 v5, 156672, v5
    v_lshrrev_b32 v7, 1, v1
    v_and_b32 v7, 1, v7
    v_lshrrev_b32 v8, 3, v1
    v_and_b32 v4, 2, v8
    v_or_b32 v7, v7, v4
    v_and_b32 v8, 1, v8
    v_lshl_or_b32 v7, v8, 2, v7
    v_lshlrev_b32 v7, 4, v7
    v_and_b32 v8, 1, v1
    v_lshl_or_b32 v7, v8, 3, v7
    v_bfe_u32 v8, v1, 2, 2
    v_lshl_or_b32 v7, v8, 7, v7
    v_lshrrev_b32 v8, 5, v1
    v_lshl_or_b32 v7, v8, 10, v7
    v_add_u32 v4, 66560, v7
    s_lshl_b32 s3, s57, 6
    v_xor_b32 v4, s3, v4
    v_add_u32 v11, s63, v2
    s_and_b32 s56, s2, 7
    s_lshl_b32 s56, s56, 2
    s_add_u32 s56, s56, s53
    s_lshl_b32 s56, s56, 9
    s_add_u32 s56, s56, 16384
    s_waitcnt lgkmcnt(0)
    s_add_u32 s47, s47, 0x9e3779b9
    s_barrier
    ds_read_b32 v8, v5
    ds_read_b64_tr_b16 v[16:17], v4 offset:0
    ds_read_b64_tr_b16 v[18:19], v4 offset:512
    ds_read_b128 v[20:23], v3 offset:0
    ds_read_b64_tr_b16 v[24:25], v4 offset:2048
    ds_read_b64_tr_b16 v[26:27], v4 offset:2560
    ds_read_b128 v[28:31], v3 offset:32
    ds_read_b64_tr_b16 v[32:33], v4 offset:4096
    ds_read_b64_tr_b16 v[34:35], v4 offset:4608
    ds_read_b128 v[36:39], v3 offset:64
    ds_read_b64_tr_b16 v[40:41], v4 offset:6144
    ds_read_b64_tr_b16 v[42:43], v4 offset:6656
    ds_read_b128 v[44:47], v3 offset:96
    ds_read_b64_tr_b16 v[64:65], v4 offset:8192
    ds_read_b64_tr_b16 v[66:67], v4 offset:8704
    ds_read_b128 v[68:71], v3 offset:128
    s_waitcnt lgkmcnt(12)
    v_mfma_f32_32x32x16_bf16 v[48:63], v[16:19], v[20:23], 0
    ds_read_b64_tr_b16 v[16:17], v4 offset:10240
    ds_read_b64_tr_b16 v[18:19], v4 offset:10752
    ds_read_b128 v[20:23], v3 offset:160
    s_waitcnt lgkmcnt(12)
    v_mfma_f32_32x32x16_bf16 v[48:63], v[24:27], v[28:31], v[48:63]
    ds_read_b64_tr_b16 v[24:25], v4 offset:12288
    ds_read_b64_tr_b16 v[26:27], v4 offset:12800
    ds_read_b128 v[28:31], v3 offset:192
    s_waitcnt lgkmcnt(12)
    v_mfma_f32_32x32x16_bf16 v[48:63], v[32:35], v[36:39], v[48:63]
    ds_read_b64_tr_b16 v[32:33], v4 offset:14336
    ds_read_b64_tr_b16 v[34:35], v4 offset:14848
    ds_read_b128 v[36:39], v3 offset:224
    s_waitcnt lgkmcnt(12)
    v_mfma_f32_32x32x16_bf16 v[48:63], v[40:43], v[44:47], v[48:63]
    ds_read_b64_tr_b16 v[40:41], v4 offset:16384
    ds_read_b64_tr_b16 v[42:43], v4 offset:16896
    ds_read_b128 v[44:47], v3 offset:256
    s_waitcnt lgkmcnt(12)
    v_mfma_f32_32x32x16_bf16 v[48:63], v[64:67], v[68:71], v[48:63]
    ds_read_b64_tr_b16 v[64:65], v4 offset:18432
    ds_read_b64_tr_b16 v[66:67], v4 offset:18944
    ds_read_b128 v[68:71], v3 offset:288
    s_waitcnt lgkmcnt(12)
    v_mfma_f32_32x32x16_bf16 v[48:63], v[16:19], v[20:23], v[48:63]
    ds_read_b64_tr_b16 v[16:17], v4 offset:20480
    ds_read_b64_tr_b16 v[18:19], v4 offset:20992
    ds_read_b128 v[20:23], v3 offset:320
    s_waitcnt lgkmcnt(12)
    v_mfma_f32_32x32x16_bf16 v[48:63], v[24:27], v[28:31], v[48:63]
    ds_read_b64_tr_b16 v[24:25], v4 offset:22528
    ds_read_b64_tr_b16 v[26:27], v4 offset:23040
    ds_read_b128 v[28:31], v3 offset:352
    s_waitcnt lgkmcnt(12)
    v_mfma_f32_32x32x16_bf16 v[48:63], v[32:35], v[36:39], v[48:63]
    ds_read_b64_tr_b16 v[32:33], v4 offset:24576
    ds_read_b64_tr_b16 v[34:35], v4 offset:25088
    ds_read_b128 v[36:39], v3 offset:384
    s_waitcnt lgkmcnt(12)
    v_mfma_f32_32x32x16_bf16 v[48:63], v[40:43], v[44:47], v[48:63]
    ds_read_b64_tr_b16 v[40:41], v4 offset:26624
    ds_read_b64_tr_b16 v[42:43], v4 offset:27136
    ds_read_b128 v[44:47], v3 offset:416
    s_waitcnt lgkmcnt(12)
    v_mfma_f32_32x32x16_bf16 v[48:63], v[64:67], v[68:71], v[48:63]
    ds_read_b64_tr_b16 v[64:65], v4 offset:28672
    ds_read_b64_tr_b16 v[66:67], v4 offset:29184
    ds_read_b128 v[68:71], v3 offset:448
    s_waitcnt lgkmcnt(12)
    v_mfma_f32_32x32x16_bf16 v[48:63], v[16:19], v[20:23], v[48:63]
    ds_read_b64_tr_b16 v[16:17], v4 offset:30720
    ds_read_b64_tr_b16 v[18:19], v4 offset:31232
    ds_read_b128 v[20:23], v3 offset:480
    s_waitcnt lgkmcnt(12)
    v_mfma_f32_32x32x16_bf16 v[48:63], v[24:27], v[28:31], v[48:63]
    s_barrier
    ds_read_b64_tr_b16 v[24:25], v4 offset:32768
    ds_read_b64_tr_b16 v[26:27], v4 offset:33280
    ds_read_b128 v[28:31], v3 offset:512
    s_waitcnt lgkmcnt(12)
    v_mfma_f32_32x32x16_bf16 v[48:63], v[32:35], v[36:39], v[48:63]
    ds_read_b64_tr_b16 v[32:33], v4 offset:34816
    ds_read_b64_tr_b16 v[34:35], v4 offset:35328
    ds_read_b128 v[36:39], v3 offset:544
    s_waitcnt lgkmcnt(12)
    v_mfma_f32_32x32x16_bf16 v[48:63], v[40:43], v[44:47], v[48:63]
    ds_read_b64_tr_b16 v[40:41], v4 offset:36864
    ds_read_b64_tr_b16 v[42:43], v4 offset:37376
    ds_read_b128 v[44:47], v3 offset:576
    s_waitcnt lgkmcnt(12)
    v_mfma_f32_32x32x16_bf16 v[48:63], v[64:67], v[68:71], v[48:63]
    ds_read_b64_tr_b16 v[64:65], v4 offset:38912
    ds_read_b64_tr_b16 v[66:67], v4 offset:39424
    ds_read_b128 v[68:71], v3 offset:608
    s_waitcnt lgkmcnt(12)
    v_mfma_f32_32x32x16_bf16 v[48:63], v[16:19], v[20:23], v[48:63]
    ds_read_b64_tr_b16 v[16:17], v4 offset:40960
    ds_read_b64_tr_b16 v[18:19], v4 offset:41472
    ds_read_b128 v[20:23], v3 offset:640
    s_waitcnt lgkmcnt(12)
    v_mfma_f32_32x32x16_bf16 v[48:63], v[24:27], v[28:31], v[48:63]
    ds_read_b64_tr_b16 v[24:25], v4 offset:43008
    ds_read_b64_tr_b16 v[26:27], v4 offset:43520
    ds_read_b128 v[28:31], v3 offset:672
    s_waitcnt lgkmcnt(12)
    v_mfma_f32_32x32x16_bf16 v[48:63], v[32:35], v[36:39], v[48:63]
    ds_read_b64_tr_b16 v[32:33], v4 offset:45056
    ds_read_b64_tr_b16 v[34:35], v4 offset:45568
    ds_read_b128 v[36:39], v3 offset:704
    s_waitcnt lgkmcnt(12)
    v_mfma_f32_32x32x16_bf16 v[48:63], v[40:43], v[44:47], v[48:63]
    ds_read_b64_tr_b16 v[40:41], v4 offset:47104
    ds_read_b64_tr_b16 v[42:43], v4 offset:47616
    ds_read_b128 v[44:47], v3 offset:736
    s_waitcnt lgkmcnt(12)
    v_mfma_f32_32x32x16_bf16 v[48:63], v[64:67], v[68:71], v[48:63]
    s_mov_b64 exec, 0xffff
    buffer_load_dwordx2 v[126:127], v125, s[8:11], s56 offen sc1
    s_mov_b64 exec, -1
    ds_read_b64_tr_b16 v[64:65], v4 offset:49152
    ds_read_b64_tr_b16 v[66:67], v4 offset:49664
    ds_read_b128 v[68:71], v3 offset:768
    s_waitcnt lgkmcnt(12)
    v_mfma_f32_32x32x16_bf16 v[48:63], v[16:19], v[20:23], v[48:63]
    ds_read_b64_tr_b16 v[16:17], v4 offset:51200
    ds_read_b64_tr_b16 v[18:19], v4 offset:51712
    ds_read_b128 v[20:23], v3 offset:800
    s_waitcnt lgkmcnt(12)
    v_mfma_f32_32x32x16_bf16 v[48:63], v[24:27], v[28:31], v[48:63]
    ds_read_b64_tr_b16 v[24:25], v4 offset:53248
    ds_read_b64_tr_b16 v[26:27], v4 offset:53760
    ds_read_b128 v[28:31], v3 offset:832
    s_waitcnt lgkmcnt(12)
    v_mfma_f32_32x32x16_bf16 v[48:63], v[32:35], v[36:39], v[48:63]
    ds_read_b64_tr_b16 v[32:33], v4 offset:55296
    ds_read_b64_tr_b16 v[34:35], v4 offset:55808
    ds_read_b128 v[36:39], v3 offset:864
    s_waitcnt lgkmcnt(12)
    v_mfma_f32_32x32x16_bf16 v[48:63], v[40:43], v[44:47], v[48:63]
    ds_read_b64_tr_b16 v[40:41], v4 offset:57344
    ds_read_b64_tr_b16 v[42:43], v4 offset:57856
    ds_read_b128 v[44:47], v3 offset:896
    s_waitcnt lgkmcnt(12)
    v_mfma_f32_32x32x16_bf16 v[48:63], v[64:67], v[68:71], v[48:63]
    ds_read_b64_tr_b16 v[64:65], v4 offset:59392
    ds_read_b64_tr_b16 v[66:67], v4 offset:59904
    ds_read_b128 v[68:71], v3 offset:928
    s_waitcnt lgkmcnt(12)
    v_mfma_f32_32x32x16_bf16 v[48:63], v[16:19], v[20:23], v[48:63]
    ds_read_b64_tr_b16 v[16:17], v4 offset:61440
    ds_read_b64_tr_b16 v[18:19], v4 offset:61952
    ds_read_b128 v[20:23], v3 offset:960
    s_waitcnt lgkmcnt(12)
    v_mfma_f32_32x32x16_bf16 v[48:63], v[24:27], v[28:31], v[48:63]
    ds_read_b64_tr_b16 v[24:25], v4 offset:63488
    ds_read_b64_tr_b16 v[26:27], v4 offset:64000
    ds_read_b128 v[28:31], v3 offset:992
    s_waitcnt lgkmcnt(12)
    v_mfma_f32_32x32x16_bf16 v[48:63], v[32:35], v[36:39], v[48:63]
    s_waitcnt lgkmcnt(9)
    v_mfma_f32_32x32x16_bf16 v[48:63], v[40:43], v[44:47], v[48:63]
    s_waitcnt lgkmcnt(6)
    v_mfma_f32_32x32x16_bf16 v[48:63], v[64:67], v[68:71], v[48:63]
    s_waitcnt lgkmcnt(3)
    v_mfma_f32_32x32x16_bf16 v[48:63], v[16:19], v[20:23], v[48:63]
    s_waitcnt lgkmcnt(0)
    v_mfma_f32_32x32x16_bf16 v[48:63], v[24:27], v[28:31], v[48:63]
    s_waitcnt vmcnt(0)
    v_cmp_ne_u32 vcc, s47, v126
    v_mul_f32 v8, 0x3eb8aa3b, v8
    s_and_b64 s[60:61], vcc, 65535
    s_cbranch_scc1 L_kv_notyet
    s_add_u32 s58, s62, 2048
    buffer_load_dwordx4 v[80:83], v11, s[8:11], s62 offen sc1
    s_mov_b64 exec, s[68:69]
    buffer_load_dwordx4 v[92:95], v117, s[8:11], s62 offen sc1
    buffer_load_dwordx4 v[96:99], v117, s[8:11], s62 offen offset:512 sc1
    buffer_load_dwordx4 v[100:103], v117, s[8:11], s58 offen sc1
    buffer_load_dwordx4 v[104:107], v117, s[8:11], s58 offen offset:512 sc1
    s_mov_b64 exec, -1
    buffer_load_dwordx4 v[84:87], v11, s[8:11], s58 offen sc1
L_kv_notyet:
    s_add_u32 s3, s53, 1
    s_and_b32 s3, s3, 3
    s_lshl_b32 s3, s3, 11
    s_add_u32 s3, s3, 148480
    v_add_u32 v3, s3, v2
    s_add_u32 s3, s53, 2
    s_and_b32 s3, s3, 3
    s_lshl_b32 s3, s3, 11
    s_add_u32 s3, s3, 148480
    v_add_u32 v4, s3, v2
    s_add_u32 s3, s53, 3
    s_and_b32 s3, s3, 3
    s_lshl_b32 s3, s3, 11
    s_add_u32 s3, s3, 148480
    v_add_u32 v5, s3, v2
    s_add_u32 s3, s53, 4
    s_and_b32 s3, s3, 3
    s_lshl_b32 s3, s3, 11
    s_add_u32 s3, s3, 148480
    v_add_u32 v7, s3, v2
    v_pk_mul_f32 v[48:49], v[48:49], v[8:9] op_sel_hi:[1,0]
    v_pk_mul_f32 v[50:51], v[50:51], v[8:9] op_sel_hi:[1,0]
    v_pk_mul_f32 v[52:53], v[52:53], v[8:9] op_sel_hi:[1,0]
    v_pk_mul_f32 v[54:55], v[54:55], v[8:9] op_sel_hi:[1,0]
    v_pk_mul_f32 v[56:57], v[56:57], v[8:9] op_sel_hi:[1,0]
    v_pk_mul_f32 v[58:59], v[58:59], v[8:9] op_sel_hi:[1,0]
    v_pk_mul_f32 v[60:61], v[60:61], v[8:9] op_sel_hi:[1,0]
    v_pk_mul_f32 v[62:63], v[62:63], v[8:9] op_sel_hi:[1,0]
    v_cvt_pk_bf16_f32 v16, v48, v49
    v_cvt_pk_bf16_f32 v17, v50, v51
    v_cvt_pk_bf16_f32 v18, v52, v53
    v_cvt_pk_bf16_f32 v19, v54, v55
    v_cvt_pk_bf16_f32 v20, v56, v57
    v_cvt_pk_bf16_f32 v21, v58, v59
    v_cvt_pk_bf16_f32 v22, v60, v61
    v_cvt_pk_bf16_f32 v23, v62, v63
    ds_write_b128 v124, v[16:19]
    ds_write_b128 v124, v[20:23] offset:2048
    v_dot2_f32_bf16 v48, v16, v16, 0
    v_dot2_f32_bf16 v49, v20, v20, 0
    v_dot2_f32_bf16 v48, v17, v17, v48
    v_dot2_f32_bf16 v49, v21, v21, v49
    v_dot2_f32_bf16 v48, v18, v18, v48
    v_dot2_f32_bf16 v49, v22, v22, v49
    v_dot2_f32_bf16 v48, v19, v19, v48
    v_dot2_f32_bf16 v49, v23, v23, v49
    s_nop 2
    v_permlane32_swap_b32 v48, v49
    v_add_f32 v48, v48, v49
    ds_max_u32 v12, v48 offset:4
    s_mov_b64 exec, 1
    ds_add_u32 v12, v13 offset:0
    s_mov_b64 exec, -1
    s_cmp_eq_u64 s[60:61], 0
    s_cbranch_scc1 L_kv_have
    s_mov_b32 s54, 1048576
L_kw_1:
    s_sleep 4
    s_mov_b64 exec, 0xffff
    buffer_load_dwordx2 v[126:127], v125, s[8:11], s56 offen sc1
    s_mov_b64 exec, -1
    s_waitcnt vmcnt(0)
    v_cmp_ne_u32 vcc, s47, v126
    s_sub_u32 s54, s54, 1
    s_cselect_b64 vcc, 0, vcc
    s_and_b64 vcc, vcc, 0xffff
    s_cbranch_scc1 L_kw_1
    s_add_u32 s58, s62, 2048
    buffer_load_dwordx4 v[80:83], v11, s[8:11], s62 offen sc1
    s_mov_b64 exec, s[68:69]
    buffer_load_dwordx4 v[92:95], v117, s[8:11], s62 offen sc1
    buffer_load_dwordx4 v[96:99], v117, s[8:11], s62 offen offset:512 sc1
    buffer_load_dwordx4 v[100:103], v117, s[8:11], s58 offen sc1
    buffer_load_dwordx4 v[104:107], v117, s[8:11], s58 offen offset:512 sc1
    s_mov_b64 exec, -1
    buffer_load_dwordx4 v[84:87], v11, s[8:11], s58 offen sc1
L_kv_have:
    v_mov_b32 v72, 0
    v_mov_b32 v73, 0
    v_mov_b32 v74, 0
    v_mov_b32 v75, 0
    v_mov_b32 v76, 0
    v_mov_b32 v77, 0
    v_mov_b32 v78, 0
    v_mov_b32 v79, 0
    s_mov_b32 s54, 1048576
L_qw_2:
    ds_read_b64 v[8:9], v12
    s_waitcnt lgkmcnt(0)
    v_readfirstlane_b32 s55, v8
    s_cmp_ge_u32 s55, 4
    s_cbranch_scc1 L_qd_3
    s_sub_u32 s54, s54, 1
    s_cmp_lg_u32 s54, 0
    s_cbranch_scc1 L_qw_2
L_qd_3:
    ds_read_b128 v[16:19], v3
    ds_read_b128 v[20:23], v3 offset:1024
    ds_read_b128 v[24:27], v4
    ds_read_b128 v[28:31], v4 offset:1024
    ds_read_b128 v[32:35], v5
    ds_read_b128 v[36:39], v5 offset:1024
    ds_read_b128 v[40:43], v7
    ds_read_b128 v[44:47], v7 offset:1024
    s_waitcnt vmcnt(5) lgkmcnt(0)
    v_mfma_f32_32x32x16_bf16 v[48:63], v[80:83], v[16:19], 0
    s_setprio 0
    s_lshl_b32 s3, s46, 2
    s_add_u32 s3, s3, s53
    s_lshl_b32 s3, s3, 11
    s_lshl_b32 s60, s45, 16
    s_add_u32 s60, s60, s3
    s_add_u32 s60, s60, 262144
    v_and_b32 v3, 1, v1
    v_cmp_eq_u32 s[96:97], 0, v3
    v_mov_b32 v3, 0x45800000
    v_mov_b32 v4, 0x53800000
    v_mov_b32 v5, 1.0
    v_cndmask_b32 v3, v4, v3, s[96:97]
    v_cndmask_b32 v9, v5, v9, s[96:97]
    s_waitcnt vmcnt(3)
.p2align 6
L_att:
    v_exp_f32 v48, v48
    v_exp_f32 v49, v49
    v_smfmac_f32_32x32x32_bf16 v[240:255], v[112:115], v[72:79], v116
    v_exp_f32 v50, v50
    v_exp_f32 v51, v51
    v_exp_f32 v52, v52
    v_mfma_f32_32x32x16_bf16 v[64:79], v[80:83], v[20:23], 0
    v_exp_f32 v53, v53
    v_exp_f32 v54, v54
    v_exp_f32 v55, v55
    v_exp_f32 v56, v56
    buffer_load_dwordx4 v[88:91], v11, s[8:11], s21 offen offset:0 sc1
    s_mov_b64 exec, s[68:69]
    buffer_load_dwordx4 v[108:111], v117, s[8:11], s21 offen offset:0 sc1
    buffer_load_dwordx4 v[112:115], v117, s[8:11], s21 offen offset:512 sc1
    s_mov_b64 exec, -1
    v_exp_f32 v57, v57
    v_exp_f32 v58, v58
    v_exp_f32 v59, v59
    v_exp_f32 v60, v60
    v_exp_f32 v61, v61
    v_exp_f32 v62, v62
    v_smfmac_f32_32x32x32_bf16 v[128:143], v[92:95], v[48:55], v116
    v_exp_f32 v63, v63
    v_exp_f32 v64, v64
    v_exp_f32 v65, v65
    v_smfmac_f32_32x32x32_bf16 v[128:143], v[96:99], v[56:63], v116
    v_exp_f32 v66, v66
    v_exp_f32 v67, v67
    v_exp_f32 v68, v68
    v_mfma_f32_32x32x16_bf16 v[48:63], v[80:83], v[24:27], 0
    v_exp_f32 v69, v69
    v_exp_f32 v70, v70
    v_exp_f32 v71, v71
    v_exp_f32 v72, v72
    v_exp_f32 v73, v73
    v_exp_f32 v74, v74
    v_exp_f32 v75, v75
    v_exp_f32 v76, v76
    v_exp_f32 v77, v77
    v_exp_f32 v78, v78
    v_smfmac_f32_32x32x32_bf16 v[144:159], v[92:95], v[64:71], v116
    v_exp_f32 v79, v79
    v_exp_f32 v48, v48
    v_exp_f32 v49, v49
    v_smfmac_f32_32x32x32_bf16 v[144:159], v[96:99], v[72:79], v116
    v_exp_f32 v50, v50
    v_exp_f32 v51, v51
    v_exp_f32 v52, v52
    v_mfma_f32_32x32x16_bf16 v[64:79], v[80:83], v[28:31], 0
    v_exp_f32 v53, v53
    v_exp_f32 v54, v54
    v_exp_f32 v55, v55
    v_exp_f32 v56, v56
    v_exp_f32 v57, v57
    v_exp_f32 v58, v58
    v_exp_f32 v59, v59
    v_exp_f32 v60, v60
    v_exp_f32 v61, v61
    v_exp_f32 v62, v62
    v_smfmac_f32_32x32x32_bf16 v[160:175], v[92:95], v[48:55], v116
    v_exp_f32 v63, v63
    v_exp_f32 v64, v64
    v_exp_f32 v65, v65
    v_smfmac_f32_32x32x32_bf16 v[160:175], v[96:99], v[56:63], v116
    v_exp_f32 v66, v66
    v_exp_f32 v67, v67
    v_exp_f32 v68, v68
    v_mfma_f32_32x32x16_bf16 v[48:63], v[80:83], v[32:35], 0
    v_exp_f32 v69, v69
    v_exp_f32 v70, v70
    v_exp_f32 v71, v71
    v_exp_f32 v72, v72
    v_exp_f32 v73, v73
    v_exp_f32 v74, v74
    v_exp_f32 v75, v75
    v_exp_f32 v76, v76
    v_exp_f32 v77, v77
    v_exp_f32 v78, v78
    v_smfmac_f32_32x32x32_bf16 v[176:191], v[92:95], v[64:71], v116
    v_exp_f32 v79, v79
    v_exp_f32 v48, v48
    v_exp_f32 v49, v49
    v_smfmac_f32_32x32x32_bf16 v[176:191], v[96:99], v[72:79], v116
    v_exp_f32 v50, v50
    v_exp_f32 v51, v51
    v_exp_f32 v52, v52
    v_mfma_f32_32x32x16_bf16 v[64:79], v[80:83], v[36:39], 0
    v_exp_f32 v53, v53
    v_exp_f32 v54, v54
    v_exp_f32 v55, v55
    v_exp_f32 v56, v56
    v_exp_f32 v57, v57
    v_exp_f32 v58, v58
    v_exp_f32 v59, v59
    v_exp_f32 v60, v60
    v_exp_f32 v61, v61
    v_exp_f32 v62, v62
    v_smfmac_f32_32x32x32_bf16 v[192:207], v[92:95], v[48:55], v116
    v_exp_f32 v63, v63
    v_exp_f32 v64, v64
    v_exp_f32 v65, v65
    v_smfmac_f32_32x32x32_bf16 v[192:207], v[96:99], v[56:63], v116
    v_exp_f32 v66, v66
    v_exp_f32 v67, v67
    v_exp_f32 v68, v68
    v_mfma_f32_32x32x16_bf16 v[48:63], v[80:83], v[40:43], 0
    v_exp_f32 v69, v69
    v_exp_f32 v70, v70
    v_exp_f32 v71, v71
    v_exp_f32 v72, v72
    v_exp_f32 v73, v73
    v_exp_f32 v74, v74
    v_exp_f32 v75, v75
    v_exp_f32 v76, v76
    v_exp_f32 v77, v77
    v_exp_f32 v78, v78
    v_smfmac_f32_32x32x32_bf16 v[208:223], v[92:95], v[64:71], v116
    v_exp_f32 v79, v79
    v_exp_f32 v48, v48
    v_exp_f32 v49, v49
    v_smfmac_f32_32x32x32_bf16 v[208:223], v[96:99], v[72:79], v116
    v_exp_f32 v50, v50
    v_exp_f32 v51, v51
    v_exp_f32 v52, v52
    v_mfma_f32_32x32x16_bf16 v[64:79], v[80:83], v[44:47], 0
    v_exp_f32 v53, v53
    v_exp_f32 v54, v54
    v_exp_f32 v55, v55
    v_exp_f32 v56, v56
    v_exp_f32 v57, v57
    v_exp_f32 v58, v58
    v_exp_f32 v59, v59
    v_exp_f32 v60, v60
    v_exp_f32 v61, v61
    v_exp_f32 v62, v62
    v_smfmac_f32_32x32x32_bf16 v[224:239], v[92:95], v[48:55], v116
    v_exp_f32 v63, v63
    v_exp_f32 v64, v64
    v_exp_f32 v65, v65
    v_smfmac_f32_32x32x32_bf16 v[224:239], v[96:99], v[56:63], v116
    v_exp_f32 v66, v66
    v_exp_f32 v67, v67
    v_exp_f32 v68, v68
    s_waitcnt vmcnt(3)
    v_mfma_f32_32x32x16_bf16 v[48:63], v[84:87], v[16:19], 0
    v_exp_f32 v69, v69
    v_exp_f32 v70, v70
    v_exp_f32 v71, v71
    v_exp_f32 v72, v72
    v_exp_f32 v73, v73
    v_exp_f32 v74, v74
    v_exp_f32 v75, v75
    v_exp_f32 v76, v76
    v_exp_f32 v77, v77
    v_exp_f32 v78, v78
    v_smfmac_f32_32x32x32_bf16 v[240:255], v[92:95], v[64:71], v116
    v_exp_f32 v79, v79
    buffer_load_dwordx2 v[126:127], v125, s[8:11], s56 offen sc1
    v_exp_f32 v48, v48
    v_exp_f32 v49, v49
    v_smfmac_f32_32x32x32_bf16 v[240:255], v[96:99], v[72:79], v116
    v_exp_f32 v50, v50
    v_exp_f32 v51, v51
    v_exp_f32 v52, v52
    v_mfma_f32_32x32x16_bf16 v[64:79], v[84:87], v[20:23], 0
    v_exp_f32 v53, v53
    v_exp_f32 v54, v54
    v_exp_f32 v55, v55
    v_exp_f32 v56, v56
    buffer_load_dwordx4 v[80:83], v11, s[8:11], s21 offen offset:2048 sc1
    s_mov_b64 exec, s[68:69]
    buffer_load_dwordx4 v[92:95], v117, s[8:11], s21 offen offset:2048 sc1
    buffer_load_dwordx4 v[96:99], v117, s[8:11], s21 offen offset:2560 sc1
    s_mov_b64 exec, -1
    v_exp_f32 v57, v57
    v_exp_f32 v58, v58
    v_exp_f32 v59, v59
    v_exp_f32 v60, v60
    v_exp_f32 v61, v61
    v_exp_f32 v62, v62
    v_smfmac_f32_32x32x32_bf16 v[128:143], v[100:103], v[48:55], v116
    v_exp_f32 v63, v63
    v_exp_f32 v64, v64
    v_exp_f32 v65, v65
    v_smfmac_f32_32x32x32_bf16 v[128:143], v[104:107], v[56:63], v116
    v_exp_f32 v66, v66
    v_exp_f32 v67, v67
    v_exp_f32 v68, v68
    v_mfma_f32_32x32x16_bf16 v[48:63], v[84:87], v[24:27], 0
    v_exp_f32 v69, v69
    v_exp_f32 v70, v70
    v_exp_f32 v71, v71
    v_exp_f32 v72, v72
    v_exp_f32 v73, v73
    v_exp_f32 v74, v74
    v_exp_f32 v75, v75
    v_exp_f32 v76, v76
    v_exp_f32 v77, v77
    v_exp_f32 v78, v78
    v_smfmac_f32_32x32x32_bf16 v[144:159], v[100:103], v[64:71], v116
    v_exp_f32 v79, v79
    v_exp_f32 v48, v48
    v_exp_f32 v49, v49
    v_smfmac_f32_32x32x32_bf16 v[144:159], v[104:107], v[72:79], v116
    v_exp_f32 v50, v50
    v_exp_f32 v51, v51
    v_exp_f32 v52, v52
    v_mfma_f32_32x32x16_bf16 v[64:79], v[84:87], v[28:31], 0
    v_exp_f32 v53, v53
    v_exp_f32 v54, v54
    v_exp_f32 v55, v55
    v_exp_f32 v56, v56
    v_exp_f32 v57, v57
    v_exp_f32 v58, v58
    v_exp_f32 v59, v59
    v_exp_f32 v60, v60
    v_exp_f32 v61, v61
    v_exp_f32 v62, v62
    v_smfmac_f32_32x32x32_bf16 v[160:175], v[100:103], v[48:55], v116
    v_exp_f32 v63, v63
    v_exp_f32 v64, v64
    v_exp_f32 v65, v65
    v_smfmac_f32_32x32x32_bf16 v[160:175], v[104:107], v[56:63], v116
    v_exp_f32 v66, v66
    v_exp_f32 v67, v67
    v_exp_f32 v68, v68
    v_mfma_f32_32x32x16_bf16 v[48:63], v[84:87], v[32:35], 0
    v_exp_f32 v69, v69
    v_exp_f32 v70, v70
    v_exp_f32 v71, v71
    v_exp_f32 v72, v72
    v_exp_f32 v73, v73
    v_exp_f32 v74, v74
    v_exp_f32 v75, v75
    v_exp_f32 v76, v76
    v_exp_f32 v77, v77
    v_exp_f32 v78, v78
    v_smfmac_f32_32x32x32_bf16 v[176:191], v[100:103], v[64:71], v116
    v_exp_f32 v79, v79
    v_exp_f32 v48, v48
    v_exp_f32 v49, v49
    v_smfmac_f32_32x32x32_bf16 v[176:191], v[104:107], v[72:79], v116
    v_exp_f32 v50, v50
    v_exp_f32 v51, v51
    v_exp_f32 v52, v52
    v_mfma_f32_32x32x16_bf16 v[64:79], v[84:87], v[36:39], 0
    v_exp_f32 v53, v53
    v_exp_f32 v54, v54
    v_exp_f32 v55, v55
    v_exp_f32 v56, v56
    v_exp_f32 v57, v57
    v_exp_f32 v58, v58
    v_exp_f32 v59, v59
    v_exp_f32 v60, v60
    v_exp_f32 v61, v61
    v_exp_f32 v62, v62
    v_smfmac_f32_32x32x32_bf16 v[192:207], v[100:103], v[48:55], v116
    v_exp_f32 v63, v63
    v_exp_f32 v64, v64
    v_exp_f32 v65, v65
    v_smfmac_f32_32x32x32_bf16 v[192:207], v[104:107], v[56:63], v116
    v_exp_f32 v66, v66
    v_exp_f32 v67, v67
    v_exp_f32 v68, v68
    v_mfma_f32_32x32x16_bf16 v[48:63], v[84:87], v[40:43], 0
    v_exp_f32 v69, v69
    v_exp_f32 v70, v70
    v_exp_f32 v71, v71
    v_exp_f32 v72, v72
    v_exp_f32 v73, v73
    v_exp_f32 v74, v74
    v_exp_f32 v75, v75
    v_exp_f32 v76, v76
    v_exp_f32 v77, v77
    v_exp_f32 v78, v78
    v_smfmac_f32_32x32x32_bf16 v[208:223], v[100:103], v[64:71], v116
    v_exp_f32 v79, v79
    v_exp_f32 v48, v48
    v_exp_f32 v49, v49
    v_smfmac_f32_32x32x32_bf16 v[208:223], v[104:107], v[72:79], v116
    v_exp_f32 v50, v50
    v_exp_f32 v51, v51
    v_exp_f32 v52, v52
    v_mfma_f32_32x32x16_bf16 v[64:79], v[84:87], v[44:47], 0
    v_exp_f32 v53, v53
    v_exp_f32 v54, v54
    v_exp_f32 v55, v55
    v_exp_f32 v56, v56
    v_exp_f32 v57, v57
    v_exp_f32 v58, v58
    v_exp_f32 v59, v59
    v_exp_f32 v60, v60
    v_exp_f32 v61, v61
    v_exp_f32 v62, v62
    v_smfmac_f32_32x32x32_bf16 v[224:239], v[100:103], v[48:55], v116
    v_exp_f32 v63, v63
    v_exp_f32 v64, v64
    v_exp_f32 v65, v65
    v_smfmac_f32_32x32x32_bf16 v[224:239], v[104:107], v[56:63], v116
    v_exp_f32 v66, v66
    v_exp_f32 v67, v67
    v_exp_f32 v68, v68
    s_waitcnt vmcnt(3)
    v_mfma_f32_32x32x16_bf16 v[48:63], v[88:91], v[16:19], 0
    v_exp_f32 v69, v69
    v_exp_f32 v70, v70
    v_exp_f32 v71, v71
    v_exp_f32 v72, v72
    v_exp_f32 v73, v73
    v_exp_f32 v74, v74
    v_exp_f32 v75, v75
    v_exp_f32 v76, v76
    v_exp_f32 v77, v77
    v_exp_f32 v78, v78
    v_smfmac_f32_32x32x32_bf16 v[240:255], v[100:103], v[64:71], v116
    v_exp_f32 v79, v79
    s_waitcnt vmcnt(3)
    v_cmp_ne_u32 vcc, s47, v126
    s_and_b64 vcc, vcc, -1
    s_cbranch_scc0 L_kd_4
    s_mov_b32 s54, 1048576
L_kw_5:
    s_sleep 4
    s_mov_b64 exec, -1
    buffer_load_dwordx2 v[126:127], v125, s[8:11], s56 offen sc1
    s_mov_b64 exec, -1
    s_waitcnt vmcnt(0)
    v_cmp_ne_u32 vcc, s47, v126
    s_sub_u32 s54, s54, 1
    s_cselect_b64 vcc, 0, vcc
    s_and_b64 vcc, vcc, -1
    s_cbranch_scc1 L_kw_5
L_kd_4:
    v_mul_f32 v4, v127, v9
    v_cmp_nge_f32 vcc, v3, v4
    v_mov_b32 v4, 0x2b800000
    v_cmp_le_f32 s[98:99], v4, v127
    s_andn2_b64 s[98:99], s[98:99], s[96:97]
    s_cselect_b64 s[98:99], 0, 1
    s_or_b64 vcc, vcc, s[98:99]
    s_cselect_b32 s3, 1, 0
    v_mov_b32 v4, s3
    s_mov_b64 exec, 1
    ds_add_u32 v12, v4 offset:24
    s_mov_b64 exec, -1
    v_exp_f32 v48, v48
    v_exp_f32 v49, v49
    v_smfmac_f32_32x32x32_bf16 v[240:255], v[104:107], v[72:79], v116
    v_exp_f32 v50, v50
    v_exp_f32 v51, v51
    v_exp_f32 v52, v52
    v_mfma_f32_32x32x16_bf16 v[64:79], v[88:91], v[20:23], 0
    v_exp_f32 v53, v53
    v_exp_f32 v54, v54
    v_exp_f32 v55, v55
    v_exp_f32 v56, v56
    buffer_load_dwordx4 v[84:87], v11, s[8:11], s22 offen offset:0 sc1
    s_mov_b64 exec, s[68:69]
    buffer_load_dwordx4 v[100:103], v117, s[8:11], s22 offen offset:0 sc1
    buffer_load_dwordx4 v[104:107], v117, s[8:11], s22 offen offset:512 sc1
    s_mov_b64 exec, -1
    v_exp_f32 v57, v57
    v_exp_f32 v58, v58
    v_exp_f32 v59, v59
    v_exp_f32 v60, v60
    v_exp_f32 v61, v61
    v_exp_f32 v62, v62
    v_smfmac_f32_32x32x32_bf16 v[128:143], v[108:111], v[48:55], v116
    v_exp_f32 v63, v63
    v_exp_f32 v64, v64
    v_exp_f32 v65, v65
    v_smfmac_f32_32x32x32_bf16 v[128:143], v[112:115], v[56:63], v116
    v_exp_f32 v66, v66
    v_exp_f32 v67, v67
    v_exp_f32 v68, v68
    v_mfma_f32_32x32x16_bf16 v[48:63], v[88:91], v[24:27], 0
    v_exp_f32 v69, v69
    v_exp_f32 v70, v70
    v_exp_f32 v71, v71
    v_exp_f32 v72, v72
    v_exp_f32 v73, v73
    v_exp_f32 v74, v74
    v_exp_f32 v75, v75
    v_exp_f32 v76, v76
    v_exp_f32 v77, v77
    v_exp_f32 v78, v78
    v_smfmac_f32_32x32x32_bf16 v[144:159], v[108:111], v[64:71], v116
    v_exp_f32 v79, v79
    v_exp_f32 v48, v48
    v_exp_f32 v49, v49
    v_smfmac_f32_32x32x32_bf16 v[144:159], v[112:115], v[72:79], v116
    v_exp_f32 v50, v50
    v_exp_f32 v51, v51
    v_exp_f32 v52, v52
    v_mfma_f32_32x32x16_bf16 v[64:79], v[88:91], v[28:31], 0
    v_exp_f32 v53, v53
    v_exp_f32 v54, v54
    v_exp_f32 v55, v55
    v_exp_f32 v56, v56
    v_exp_f32 v57, v57
    v_exp_f32 v58, v58
    v_exp_f32 v59, v59
    v_exp_f32 v60, v60
    v_exp_f32 v61, v61
    v_exp_f32 v62, v62
    v_smfmac_f32_32x32x32_bf16 v[160:175], v[108:111], v[48:55], v116
    v_exp_f32 v63, v63
    v_exp_f32 v64, v64
    v_exp_f32 v65, v65
    v_smfmac_f32_32x32x32_bf16 v[160:175], v[112:115], v[56:63], v116
    v_exp_f32 v66, v66
    v_exp_f32 v67, v67
    v_exp_f32 v68, v68
    v_mfma_f32_32x32x16_bf16 v[48:63], v[88:91], v[32:35], 0
    v_exp_f32 v69, v69
    v_exp_f32 v70, v70
    v_exp_f32 v71, v71
    v_exp_f32 v72, v72
    v_exp_f32 v73, v73
    v_exp_f32 v74, v74
    v_exp_f32 v75, v75
    v_exp_f32 v76, v76
    v_exp_f32 v77, v77
    v_exp_f32 v78, v78
    v_smfmac_f32_32x32x32_bf16 v[176:191], v[108:111], v[64:71], v116
    v_exp_f32 v79, v79
    v_exp_f32 v48, v48
    v_exp_f32 v49, v49
    v_smfmac_f32_32x32x32_bf16 v[176:191], v[112:115], v[72:79], v116
    v_exp_f32 v50, v50
    v_exp_f32 v51, v51
    v_exp_f32 v52, v52
    v_mfma_f32_32x32x16_bf16 v[64:79], v[88:91], v[36:39], 0
    v_exp_f32 v53, v53
    v_exp_f32 v54, v54
    v_exp_f32 v55, v55
    v_exp_f32 v56, v56
    v_exp_f32 v57, v57
    v_exp_f32 v58, v58
    v_exp_f32 v59, v59
    v_exp_f32 v60, v60
    v_exp_f32 v61, v61
    v_exp_f32 v62, v62
    v_smfmac_f32_32x32x32_bf16 v[192:207], v[108:111], v[48:55], v116
    v_exp_f32 v63, v63
    v_exp_f32 v64, v64
    v_exp_f32 v65, v65
    v_smfmac_f32_32x32x32_bf16 v[192:207], v[112:115], v[56:63], v116
    v_exp_f32 v66, v66
    v_exp_f32 v67, v67
    v_exp_f32 v68, v68
    v_mfma_f32_32x32x16_bf16 v[48:63], v[88:91], v[40:43], 0
    v_exp_f32 v69, v69
    v_exp_f32 v70, v70
    v_exp_f32 v71, v71
    v_exp_f32 v72, v72
    v_exp_f32 v73, v73
    v_exp_f32 v74, v74
    v_exp_f32 v75, v75
    v_exp_f32 v76, v76
    v_exp_f32 v77, v77
    v_exp_f32 v78, v78
    v_smfmac_f32_32x32x32_bf16 v[208:223], v[108:111], v[64:71], v116
    v_exp_f32 v79, v79
    v_exp_f32 v48, v48
    v_exp_f32 v49, v49
    v_smfmac_f32_32x32x32_bf16 v[208:223], v[112:115], v[72:79], v116
    v_exp_f32 v50, v50
    v_exp_f32 v51, v51
    v_exp_f32 v52, v52
    v_mfma_f32_32x32x16_bf16 v[64:79], v[88:91], v[44:47], 0
    v_exp_f32 v53, v53
    v_exp_f32 v54, v54
    v_exp_f32 v55, v55
    v_exp_f32 v56, v56
    v_exp_f32 v57, v57
    v_exp_f32 v58, v58
    v_exp_f32 v59, v59
    v_exp_f32 v60, v60
    v_exp_f32 v61, v61
    v_exp_f32 v62, v62
    v_smfmac_f32_32x32x32_bf16 v[224:239], v[108:111], v[48:55], v116
    v_exp_f32 v63, v63
    v_exp_f32 v64, v64
    v_exp_f32 v65, v65
    v_smfmac_f32_32x32x32_bf16 v[224:239], v[112:115], v[56:63], v116
    v_exp_f32 v66, v66
    v_exp_f32 v67, v67
    v_exp_f32 v68, v68
    s_waitcnt vmcnt(3)
    v_mfma_f32_32x32x16_bf16 v[48:63], v[80:83], v[16:19], 0
    v_exp_f32 v69, v69
    v_exp_f32 v70, v70
    v_exp_f32 v71, v71
    v_exp_f32 v72, v72
    v_exp_f32 v73, v73
    v_exp_f32 v74, v74
    v_exp_f32 v75, v75
    v_exp_f32 v76, v76
    v_exp_f32 v77, v77
    v_exp_f32 v78, v78
    v_smfmac_f32_32x32x32_bf16 v[240:255], v[108:111], v[64:71], v116
    v_exp_f32 v79, v79
    v_exp_f32 v48, v48
    v_exp_f32 v49, v49
    v_smfmac_f32_32x32x32_bf16 v[240:255], v[112:115], v[72:79], v116
    v_exp_f32 v50, v50
    v_exp_f32 v51, v51
    v_exp_f32 v52, v52
    v_mfma_f32_32x32x16_bf16 v[64:79], v[80:83], v[20:23], 0
    v_exp_f32 v53, v53
    v_exp_f32 v54, v54
    v_exp_f32 v55, v55
    v_exp_f32 v56, v56
    buffer_load_dwordx4 v[88:91], v11, s[8:11], s22 offen offset:2048 sc1
    s_mov_b64 exec, s[68:69]
    buffer_load_dwordx4 v[108:111], v117, s[8:11], s22 offen offset:2048 sc1
    buffer_load_dwordx4 v[112:115], v117, s[8:11], s22 offen offset:2560 sc1
    s_mov_b64 exec, -1
    v_exp_f32 v57, v57
    v_exp_f32 v58, v58
    v_exp_f32 v59, v59
    v_exp_f32 v60, v60
    v_exp_f32 v61, v61
    v_exp_f32 v62, v62
    v_smfmac_f32_32x32x32_bf16 v[128:143], v[92:95], v[48:55], v116
    v_exp_f32 v63, v63
    v_exp_f32 v64, v64
    v_exp_f32 v65, v65
    v_smfmac_f32_32x32x32_bf16 v[128:143], v[96:99], v[56:63], v116
    v_exp_f32 v66, v66
    v_exp_f32 v67, v67
    v_exp_f32 v68, v68
    v_mfma_f32_32x32x16_bf16 v[48:63], v[80:83], v[24:27], 0
    v_exp_f32 v69, v69
    v_exp_f32 v70, v70
    v_exp_f32 v71, v71
    v_exp_f32 v72, v72
    v_exp_f32 v73, v73
    v_exp_f32 v74, v74
    v_exp_f32 v75, v75
    v_exp_f32 v76, v76
    v_exp_f32 v77, v77
    v_exp_f32 v78, v78
    v_smfmac_f32_32x32x32_bf16 v[144:159], v[92:95], v[64:71], v116
    v_exp_f32 v79, v79
    v_exp_f32 v48, v48
    v_exp_f32 v49, v49
    v_smfmac_f32_32x32x32_bf16 v[144:159], v[96:99], v[72:79], v116
    v_exp_f32 v50, v50
    v_exp_f32 v51, v51
    v_exp_f32 v52, v52
    v_mfma_f32_32x32x16_bf16 v[64:79], v[80:83], v[28:31], 0
    v_exp_f32 v53, v53
    v_exp_f32 v54, v54
    v_exp_f32 v55, v55
    v_exp_f32 v56, v56
    v_exp_f32 v57, v57
    v_exp_f32 v58, v58
    v_exp_f32 v59, v59
    v_exp_f32 v60, v60
    v_exp_f32 v61, v61
    v_exp_f32 v62, v62
    v_smfmac_f32_32x32x32_bf16 v[160:175], v[92:95], v[48:55], v116
    v_exp_f32 v63, v63
    v_exp_f32 v64, v64
    v_exp_f32 v65, v65
    v_smfmac_f32_32x32x32_bf16 v[160:175], v[96:99], v[56:63], v116
    v_exp_f32 v66, v66
    v_exp_f32 v67, v67
    v_exp_f32 v68, v68
    v_mfma_f32_32x32x16_bf16 v[48:63], v[80:83], v[32:35], 0
    v_exp_f32 v69, v69
    v_exp_f32 v70, v70
    v_exp_f32 v71, v71
    v_exp_f32 v72, v72
    v_exp_f32 v73, v73
    v_exp_f32 v74, v74
    v_exp_f32 v75, v75
    v_exp_f32 v76, v76
    v_exp_f32 v77, v77
    v_exp_f32 v78, v78
    v_smfmac_f32_32x32x32_bf16 v[176:191], v[92:95], v[64:71], v116
    v_exp_f32 v79, v79
    v_exp_f32 v48, v48
    v_exp_f32 v49, v49
    v_smfmac_f32_32x32x32_bf16 v[176:191], v[96:99], v[72:79], v116
    v_exp_f32 v50, v50
    v_exp_f32 v51, v51
    v_exp_f32 v52, v52
    v_mfma_f32_32x32x16_bf16 v[64:79], v[80:83], v[36:39], 0
    v_exp_f32 v53, v53
    v_exp_f32 v54, v54
    v_exp_f32 v55, v55
    v_exp_f32 v56, v56
    v_exp_f32 v57, v57
    v_exp_f32 v58, v58
    v_exp_f32 v59, v59
    v_exp_f32 v60, v60
    v_exp_f32 v61, v61
    v_exp_f32 v62, v62
    v_smfmac_f32_32x32x32_bf16 v[192:207], v[92:95], v[48:55], v116
    v_exp_f32 v63, v63
    v_exp_f32 v64, v64
    v_exp_f32 v65, v65
    v_smfmac_f32_32x32x32_bf16 v[192:207], v[96:99], v[56:63], v116
    v_exp_f32 v66, v66
    v_exp_f32 v67, v67
    v_exp_f32 v68, v68
    v_mfma_f32_32x32x16_bf16 v[48:63], v[80:83], v[40:43], 0
    v_exp_f32 v69, v69
    v_exp_f32 v70, v70
    v_exp_f32 v71, v71
    v_exp_f32 v72, v72
    v_exp_f32 v73, v73
    v_exp_f32 v74, v74
    v_exp_f32 v75, v75
    v_exp_f32 v76, v76
    v_exp_f32 v77, v77
    v_exp_f32 v78, v78
    v_smfmac_f32_32x32x32_bf16 v[208:223], v[92:95], v[64:71], v116
    v_exp_f32 v79, v79
    v_exp_f32 v48, v48
    v_exp_f32 v49, v49
    v_smfmac_f32_32x32x32_bf16 v[208:223], v[96:99], v[72:79], v116
    v_exp_f32 v50, v50
    v_exp_f32 v51, v51
    v_exp_f32 v52, v52
    v_mfma_f32_32x32x16_bf16 v[64:79], v[80:83], v[44:47], 0
    v_exp_f32 v53, v53
    v_exp_f32 v54, v54
    v_exp_f32 v55, v55
    v_exp_f32 v56, v56
    v_exp_f32 v57, v57
    v_exp_f32 v58, v58
    v_exp_f32 v59, v59
    v_exp_f32 v60, v60
    v_exp_f32 v61, v61
    v_exp_f32 v62, v62
    v_smfmac_f32_32x32x32_bf16 v[224:239], v[92:95], v[48:55], v116
    v_exp_f32 v63, v63
    v_exp_f32 v64, v64
    v_exp_f32 v65, v65
    v_smfmac_f32_32x32x32_bf16 v[224:239], v[96:99], v[56:63], v116
    v_exp_f32 v66, v66
    v_exp_f32 v67, v67
    v_exp_f32 v68, v68
    s_waitcnt vmcnt(3)
    v_mfma_f32_32x32x16_bf16 v[48:63], v[84:87], v[16:19], 0
    v_exp_f32 v69, v69
    v_exp_f32 v70, v70
    v_exp_f32 v71, v71
    v_exp_f32 v72, v72
    v_exp_f32 v73, v73
    v_exp_f32 v74, v74
    v_exp_f32 v75, v75
    v_exp_f32 v76, v76
    v_exp_f32 v77, v77
    v_exp_f32 v78, v78
    v_smfmac_f32_32x32x32_bf16 v[240:255], v[92:95], v[64:71], v116
    v_exp_f32 v79, v79
    v_exp_f32 v48, v48
    v_exp_f32 v49, v49
    v_smfmac_f32_32x32x32_bf16 v[240:255], v[96:99], v[72:79], v116
    v_exp_f32 v50, v50
    v_exp_f32 v51, v51
    v_exp_f32 v52, v52
    v_mfma_f32_32x32x16_bf16 v[64:79], v[84:87], v[20:23], 0
    v_exp_f32 v53, v53
    v_exp_f32 v54, v54
    v_exp_f32 v55, v55
    v_exp_f32 v56, v56
    buffer_load_dwordx4 v[80:83], v11, s[8:11], s23 offen offset:0 sc1
    s_mov_b64 exec, s[68:69]
    buffer_load_dwordx4 v[92:95], v117, s[8:11], s23 offen offset:0 sc1
    buffer_load_dwordx4 v[96:99], v117, s[8:11], s23 offen offset:512 sc1
    s_mov_b64 exec, -1
    v_exp_f32 v57, v57
    v_exp_f32 v58, v58
    v_exp_f32 v59, v59
    v_exp_f32 v60, v60
    v_exp_f32 v61, v61
    v_exp_f32 v62, v62
    v_smfmac_f32_32x32x32_bf16 v[128:143], v[100:103], v[48:55], v116
    v_exp_f32 v63, v63
    v_exp_f32 v64, v64
    v_exp_f32 v65, v65
    v_smfmac_f32_32x32x32_bf16 v[128:143], v[104:107], v[56:63], v116
    v_exp_f32 v66, v66
    v_exp_f32 v67, v67
    v_exp_f32 v68, v68
    v_mfma_f32_32x32x16_bf16 v[48:63], v[84:87], v[24:27], 0
    v_exp_f32 v69, v69
    v_exp_f32 v70, v70
    v_exp_f32 v71, v71
    v_exp_f32 v72, v72
    v_exp_f32 v73, v73
    v_exp_f32 v74, v74
    v_exp_f32 v75, v75
    v_exp_f32 v76, v76
    v_exp_f32 v77, v77
    v_exp_f32 v78, v78
    v_smfmac_f32_32x32x32_bf16 v[144:159], v[100:103], v[64:71], v116
    v_exp_f32 v79, v79
    v_exp_f32 v48, v48
    v_exp_f32 v49, v49
    v_smfmac_f32_32x32x32_bf16 v[144:159], v[104:107], v[72:79], v116
    v_exp_f32 v50, v50
    v_exp_f32 v51, v51
    v_exp_f32 v52, v52
    v_mfma_f32_32x32x16_bf16 v[64:79], v[84:87], v[28:31], 0
    v_exp_f32 v53, v53
    v_exp_f32 v54, v54
    v_exp_f32 v55, v55
    v_exp_f32 v56, v56
    v_exp_f32 v57, v57
    v_exp_f32 v58, v58
    v_exp_f32 v59, v59
    v_exp_f32 v60, v60
    v_exp_f32 v61, v61
    v_exp_f32 v62, v62
    v_smfmac_f32_32x32x32_bf16 v[160:175], v[100:103], v[48:55], v116
    v_exp_f32 v63, v63
    v_exp_f32 v64, v64
    v_exp_f32 v65, v65
    v_smfmac_f32_32x32x32_bf16 v[160:175], v[104:107], v[56:63], v116
    v_exp_f32 v66, v66
    v_exp_f32 v67, v67
    v_exp_f32 v68, v68
    v_mfma_f32_32x32x16_bf16 v[48:63], v[84:87], v[32:35], 0
    v_exp_f32 v69, v69
    v_exp_f32 v70, v70
    v_exp_f32 v71, v71
    v_exp_f32 v72, v72
    v_exp_f32 v73, v73
    v_exp_f32 v74, v74
    v_exp_f32 v75, v75
    v_exp_f32 v76, v76
    v_exp_f32 v77, v77
    v_exp_f32 v78, v78
    v_smfmac_f32_32x32x32_bf16 v[176:191], v[100:103], v[64:71], v116
    v_exp_f32 v79, v79
    v_exp_f32 v48, v48
    v_exp_f32 v49, v49
    v_smfmac_f32_32x32x32_bf16 v[176:191], v[104:107], v[72:79], v116
    v_exp_f32 v50, v50
    v_exp_f32 v51, v51
    v_exp_f32 v52, v52
    v_mfma_f32_32x32x16_bf16 v[64:79], v[84:87], v[36:39], 0
    v_exp_f32 v53, v53
    v_exp_f32 v54, v54
    v_exp_f32 v55, v55
    v_exp_f32 v56, v56
    v_exp_f32 v57, v57
    v_exp_f32 v58, v58
    v_exp_f32 v59, v59
    v_exp_f32 v60, v60
    v_exp_f32 v61, v61
    v_exp_f32 v62, v62
    v_smfmac_f32_32x32x32_bf16 v[192:207], v[100:103], v[48:55], v116
    v_exp_f32 v63, v63
    v_exp_f32 v64, v64
    v_exp_f32 v65, v65
    v_smfmac_f32_32x32x32_bf16 v[192:207], v[104:107], v[56:63], v116
    v_exp_f32 v66, v66
    v_exp_f32 v67, v67
    v_exp_f32 v68, v68
    v_mfma_f32_32x32x16_bf16 v[48:63], v[84:87], v[40:43], 0
    v_exp_f32 v69, v69
    v_exp_f32 v70, v70
    v_exp_f32 v71, v71
    v_exp_f32 v72, v72
    v_exp_f32 v73, v73
    v_exp_f32 v74, v74
    v_exp_f32 v75, v75
    v_exp_f32 v76, v76
    v_exp_f32 v77, v77
    v_exp_f32 v78, v78
    v_smfmac_f32_32x32x32_bf16 v[208:223], v[100:103], v[64:71], v116
    v_exp_f32 v79, v79
    v_exp_f32 v48, v48
    v_exp_f32 v49, v49
    v_smfmac_f32_32x32x32_bf16 v[208:223], v[104:107], v[72:79], v116
    v_exp_f32 v50, v50
    v_exp_f32 v51, v51
    v_exp_f32 v52, v52
    v_mfma_f32_32x32x16_bf16 v[64:79], v[84:87], v[44:47], 0
    v_exp_f32 v53, v53
    v_exp_f32 v54, v54
    v_exp_f32 v55, v55
    v_exp_f32 v56, v56
    v_exp_f32 v57, v57
    v_exp_f32 v58, v58
    v_exp_f32 v59, v59
    v_exp_f32 v60, v60
    v_exp_f32 v61, v61
    v_exp_f32 v62, v62
    v_smfmac_f32_32x32x32_bf16 v[224:239], v[100:103], v[48:55], v116
    v_exp_f32 v63, v63
    v_exp_f32 v64, v64
    v_exp_f32 v65, v65
    v_smfmac_f32_32x32x32_bf16 v[224:239], v[104:107], v[56:63], v116
    v_exp_f32 v66, v66
    v_exp_f32 v67, v67
    v_exp_f32 v68, v68
    s_waitcnt vmcnt(3)
    v_mfma_f32_32x32x16_bf16 v[48:63], v[88:91], v[16:19], 0
    v_exp_f32 v69, v69
    v_exp_f32 v70, v70
    v_exp_f32 v71, v71
    v_exp_f32 v72, v72
    v_exp_f32 v73, v73
    v_exp_f32 v74, v74
    v_exp_f32 v75, v75
    v_exp_f32 v76, v76
    v_exp_f32 v77, v77
    v_exp_f32 v78, v78
    v_smfmac_f32_32x32x32_bf16 v[240:255], v[100:103], v[64:71], v116
    v_exp_f32 v79, v79
    v_exp_f32 v48, v48
    v_exp_f32 v49, v49
    v_smfmac_f32_32x32x32_bf16 v[240:255], v[104:107], v[72:79], v116
    v_exp_f32 v50, v50
    v_exp_f32 v51, v51
    v_exp_f32 v52, v52
    v_mfma_f32_32x32x16_bf16 v[64:79], v[88:91], v[20:23], 0
    v_exp_f32 v53, v53
    v_exp_f32 v54, v54
    v_exp_f32 v55, v55
    v_exp_f32 v56, v56
    buffer_load_dwordx4 v[84:87], v11, s[8:11], s23 offen offset:2048 sc1
    s_mov_b64 exec, s[68:69]
    buffer_load_dwordx4 v[100:103], v117, s[8:11], s23 offen offset:2048 sc1
    buffer_load_dwordx4 v[104:107], v117, s[8:11], s23 offen offset:2560 sc1
    s_mov_b64 exec, -1
    v_exp_f32 v57, v57
    v_exp_f32 v58, v58
    v_exp_f32 v59, v59
    v_exp_f32 v60, v60
    v_exp_f32 v61, v61
    v_exp_f32 v62, v62
    v_smfmac_f32_32x32x32_bf16 v[128:143], v[108:111], v[48:55], v116
    v_exp_f32 v63, v63
    v_exp_f32 v64, v64
    v_exp_f32 v65, v65
    v_smfmac_f32_32x32x32_bf16 v[128:143], v[112:115], v[56:63], v116
    v_exp_f32 v66, v66
    v_exp_f32 v67, v67
    v_exp_f32 v68, v68
    v_mfma_f32_32x32x16_bf16 v[48:63], v[88:91], v[24:27], 0
    v_exp_f32 v69, v69
    v_exp_f32 v70, v70
    v_exp_f32 v71, v71
    v_exp_f32 v72, v72
    v_exp_f32 v73, v73
    v_exp_f32 v74, v74
    v_exp_f32 v75, v75
    v_exp_f32 v76, v76
    v_exp_f32 v77, v77
    v_exp_f32 v78, v78
    v_smfmac_f32_32x32x32_bf16 v[144:159], v[108:111], v[64:71], v116
    v_exp_f32 v79, v79
    v_exp_f32 v48, v48
    v_exp_f32 v49, v49
    v_smfmac_f32_32x32x32_bf16 v[144:159], v[112:115], v[72:79], v116
    v_exp_f32 v50, v50
    v_exp_f32 v51, v51
    v_exp_f32 v52, v52
    v_mfma_f32_32x32x16_bf16 v[64:79], v[88:91], v[28:31], 0
    v_exp_f32 v53, v53
    v_exp_f32 v54, v54
    v_exp_f32 v55, v55
    v_exp_f32 v56, v56
    v_exp_f32 v57, v57
    v_exp_f32 v58, v58
    v_exp_f32 v59, v59
    v_exp_f32 v60, v60
    v_exp_f32 v61, v61
    v_exp_f32 v62, v62
    v_smfmac_f32_32x32x32_bf16 v[160:175], v[108:111], v[48:55], v116
    v_exp_f32 v63, v63
    v_exp_f32 v64, v64
    v_exp_f32 v65, v65
    v_smfmac_f32_32x32x32_bf16 v[160:175], v[112:115], v[56:63], v116
    v_exp_f32 v66, v66
    v_exp_f32 v67, v67
    v_exp_f32 v68, v68
    v_mfma_f32_32x32x16_bf16 v[48:63], v[88:91], v[32:35], 0
    v_exp_f32 v69, v69
    v_exp_f32 v70, v70
    v_exp_f32 v71, v71
    v_exp_f32 v72, v72
    v_exp_f32 v73, v73
    v_exp_f32 v74, v74
    v_exp_f32 v75, v75
    v_exp_f32 v76, v76
    v_exp_f32 v77, v77
    v_exp_f32 v78, v78
    v_smfmac_f32_32x32x32_bf16 v[176:191], v[108:111], v[64:71], v116
    v_exp_f32 v79, v79
    v_exp_f32 v48, v48
    v_exp_f32 v49, v49
    v_smfmac_f32_32x32x32_bf16 v[176:191], v[112:115], v[72:79], v116
    v_exp_f32 v50, v50
    v_exp_f32 v51, v51
    v_exp_f32 v52, v52
    v_mfma_f32_32x32x16_bf16 v[64:79], v[88:91], v[36:39], 0
    v_exp_f32 v53, v53
    v_exp_f32 v54, v54
    v_exp_f32 v55, v55
    v_exp_f32 v56, v56
    v_exp_f32 v57, v57
    v_exp_f32 v58, v58
    v_exp_f32 v59, v59
    v_exp_f32 v60, v60
    v_exp_f32 v61, v61
    v_exp_f32 v62, v62
    v_smfmac_f32_32x32x32_bf16 v[192:207], v[108:111], v[48:55], v116
    v_exp_f32 v63, v63
    v_exp_f32 v64, v64
    v_exp_f32 v65, v65
    v_smfmac_f32_32x32x32_bf16 v[192:207], v[112:115], v[56:63], v116
    v_exp_f32 v66, v66
    v_exp_f32 v67, v67
    v_exp_f32 v68, v68
    v_mfma_f32_32x32x16_bf16 v[48:63], v[88:91], v[40:43], 0
    v_exp_f32 v69, v69
    v_exp_f32 v70, v70
    v_exp_f32 v71, v71
    v_exp_f32 v72, v72
    v_exp_f32 v73, v73
    v_exp_f32 v74, v74
    v_exp_f32 v75, v75
    v_exp_f32 v76, v76
    v_exp_f32 v77, v77
    v_exp_f32 v78, v78
    v_smfmac_f32_32x32x32_bf16 v[208:223], v[108:111], v[64:71], v116
    v_exp_f32 v79, v79
    v_exp_f32 v48, v48
    v_exp_f32 v49, v49
    v_smfmac_f32_32x32x32_bf16 v[208:223], v[112:115], v[72:79], v116
    v_exp_f32 v50, v50
    v_exp_f32 v51, v51
    v_exp_f32 v52, v52
    v_mfma_f32_32x32x16_bf16 v[64:79], v[88:91], v[44:47], 0
    v_exp_f32 v53, v53
    v_exp_f32 v54, v54
    v_exp_f32 v55, v55
    v_exp_f32 v56, v56
    v_exp_f32 v57, v57
    v_exp_f32 v58, v58
    v_exp_f32 v59, v59
    v_exp_f32 v60, v60
    v_exp_f32 v61, v61
    v_exp_f32 v62, v62
    v_smfmac_f32_32x32x32_bf16 v[224:239], v[108:111], v[48:55], v116
    v_exp_f32 v63, v63
    v_exp_f32 v64, v64
    v_exp_f32 v65, v65
    v_smfmac_f32_32x32x32_bf16 v[224:239], v[112:115], v[56:63], v116
    v_exp_f32 v66, v66
    v_exp_f32 v67, v67
    v_exp_f32 v68, v68
    s_waitcnt vmcnt(3)
    v_mfma_f32_32x32x16_bf16 v[48:63], v[80:83], v[16:19], 0
    v_exp_f32 v69, v69
    v_exp_f32 v70, v70
    v_exp_f32 v71, v71
    v_exp_f32 v72, v72
    v_exp_f32 v73, v73
    v_exp_f32 v74, v74
    v_exp_f32 v75, v75
    v_exp_f32 v76, v76
    v_exp_f32 v77, v77
    v_exp_f32 v78, v78
    v_smfmac_f32_32x32x32_bf16 v[240:255], v[108:111], v[64:71], v116
    v_exp_f32 v79, v79
    v_exp_f32 v48, v48
    v_exp_f32 v49, v49
    v_smfmac_f32_32x32x32_bf16 v[240:255], v[112:115], v[72:79], v116
    v_exp_f32 v50, v50
    v_exp_f32 v51, v51
    v_exp_f32 v52, v52
    v_mfma_f32_32x32x16_bf16 v[64:79], v[80:83], v[20:23], 0
    v_exp_f32 v53, v53
    v_exp_f32 v54, v54
    v_exp_f32 v55, v55
    v_exp_f32 v56, v56
    buffer_load_dwordx4 v[88:91], v11, s[8:11], s24 offen offset:0 sc1
    s_mov_b64 exec, s[68:69]
    buffer_load_dwordx4 v[108:111], v117, s[8:11], s24 offen offset:0 sc1
    buffer_load_dwordx4 v[112:115], v117, s[8:11], s24 offen offset:512 sc1
    s_mov_b64 exec, -1
    v_exp_f32 v57, v57
    v_exp_f32 v58, v58
    v_exp_f32 v59, v59
    v_exp_f32 v60, v60
    v_exp_f32 v61, v61
    v_exp_f32 v62, v62
    v_smfmac_f32_32x32x32_bf16 v[128:143], v[92:95], v[48:55], v116
    v_exp_f32 v63, v63
    v_exp_f32 v64, v64
    v_exp_f32 v65, v65
    v_smfmac_f32_32x32x32_bf16 v[128:143], v[96:99], v[56:63], v116
    v_exp_f32 v66, v66
    v_exp_f32 v67, v67
    v_exp_f32 v68, v68
    v_mfma_f32_32x32x16_bf16 v[48:63], v[80:83], v[24:27], 0
    v_exp_f32 v69, v69
    v_exp_f32 v70, v70
    v_exp_f32 v71, v71
    v_exp_f32 v72, v72
    v_exp_f32 v73, v73
    v_exp_f32 v74, v74
    v_exp_f32 v75, v75
    v_exp_f32 v76, v76
    v_exp_f32 v77, v77
    v_exp_f32 v78, v78
    v_smfmac_f32_32x32x32_bf16 v[144:159], v[92:95], v[64:71], v116
    v_exp_f32 v79, v79
    v_exp_f32 v48, v48
    v_exp_f32 v49, v49
    v_smfmac_f32_32x32x32_bf16 v[144:159], v[96:99], v[72:79], v116
    v_exp_f32 v50, v50
    v_exp_f32 v51, v51
    v_exp_f32 v52, v52
    v_mfma_f32_32x32x16_bf16 v[64:79], v[80:83], v[28:31], 0
    v_exp_f32 v53, v53
    v_exp_f32 v54, v54
    v_exp_f32 v55, v55
    v_exp_f32 v56, v56
    v_exp_f32 v57, v57
    v_exp_f32 v58, v58
    v_exp_f32 v59, v59
    v_exp_f32 v60, v60
    v_exp_f32 v61, v61
    v_exp_f32 v62, v62
    v_smfmac_f32_32x32x32_bf16 v[160:175], v[92:95], v[48:55], v116
    v_exp_f32 v63, v63
    v_exp_f32 v64, v64
    v_exp_f32 v65, v65
    v_smfmac_f32_32x32x32_bf16 v[160:175], v[96:99], v[56:63], v116
    v_exp_f32 v66, v66
    v_exp_f32 v67, v67
    v_exp_f32 v68, v68
    v_mfma_f32_32x32x16_bf16 v[48:63], v[80:83], v[32:35], 0
    v_exp_f32 v69, v69
    v_exp_f32 v70, v70
    v_exp_f32 v71, v71
    v_exp_f32 v72, v72
    v_exp_f32 v73, v73
    v_exp_f32 v74, v74
    v_exp_f32 v75, v75
    v_exp_f32 v76, v76
    v_exp_f32 v77, v77
    v_exp_f32 v78, v78
    v_smfmac_f32_32x32x32_bf16 v[176:191], v[92:95], v[64:71], v116
    v_exp_f32 v79, v79
    v_exp_f32 v48, v48
    v_exp_f32 v49, v49
    v_smfmac_f32_32x32x32_bf16 v[176:191], v[96:99], v[72:79], v116
    v_exp_f32 v50, v50
    v_exp_f32 v51, v51
    v_exp_f32 v52, v52
    v_mfma_f32_32x32x16_bf16 v[64:79], v[80:83], v[36:39], 0
    v_exp_f32 v53, v53
    v_exp_f32 v54, v54
    v_exp_f32 v55, v55
    v_exp_f32 v56, v56
    v_exp_f32 v57, v57
    v_exp_f32 v58, v58
    v_exp_f32 v59, v59
    v_exp_f32 v60, v60
    v_exp_f32 v61, v61
    v_exp_f32 v62, v62
    v_smfmac_f32_32x32x32_bf16 v[192:207], v[92:95], v[48:55], v116
    v_exp_f32 v63, v63
    v_exp_f32 v64, v64
    v_exp_f32 v65, v65
    v_smfmac_f32_32x32x32_bf16 v[192:207], v[96:99], v[56:63], v116
    v_exp_f32 v66, v66
    v_exp_f32 v67, v67
    v_exp_f32 v68, v68
    v_mfma_f32_32x32x16_bf16 v[48:63], v[80:83], v[40:43], 0
    v_exp_f32 v69, v69
    v_exp_f32 v70, v70
    v_exp_f32 v71, v71
    v_exp_f32 v72, v72
    v_exp_f32 v73, v73
    v_exp_f32 v74, v74
    v_exp_f32 v75, v75
    v_exp_f32 v76, v76
    v_exp_f32 v77, v77
    v_exp_f32 v78, v78
    v_smfmac_f32_32x32x32_bf16 v[208:223], v[92:95], v[64:71], v116
    v_exp_f32 v79, v79
    v_exp_f32 v48, v48
    v_exp_f32 v49, v49
    v_smfmac_f32_32x32x32_bf16 v[208:223], v[96:99], v[72:79], v116
    v_exp_f32 v50, v50
    v_exp_f32 v51, v51
    v_exp_f32 v52, v52
    v_mfma_f32_32x32x16_bf16 v[64:79], v[80:83], v[44:47], 0
    v_exp_f32 v53, v53
    v_exp_f32 v54, v54
    v_exp_f32 v55, v55
    v_exp_f32 v56, v56
    v_exp_f32 v57, v57
    v_exp_f32 v58, v58
    v_exp_f32 v59, v59
    v_exp_f32 v60, v60
    v_exp_f32 v61, v61
    v_exp_f32 v62, v62
    v_smfmac_f32_32x32x32_bf16 v[224:239], v[92:95], v[48:55], v116
    v_exp_f32 v63, v63
    v_exp_f32 v64, v64
    v_exp_f32 v65, v65
    v_smfmac_f32_32x32x32_bf16 v[224:239], v[96:99], v[56:63], v116
    v_exp_f32 v66, v66
    v_exp_f32 v67, v67
    v_exp_f32 v68, v68
    s_waitcnt vmcnt(3)
    v_mfma_f32_32x32x16_bf16 v[48:63], v[84:87], v[16:19], 0
    v_exp_f32 v69, v69
    v_exp_f32 v70, v70
    v_exp_f32 v71, v71
    v_exp_f32 v72, v72
    v_exp_f32 v73, v73
    v_exp_f32 v74, v74
    v_exp_f32 v75, v75
    v_exp_f32 v76, v76
    v_exp_f32 v77, v77
    v_exp_f32 v78, v78
    v_smfmac_f32_32x32x32_bf16 v[240:255], v[92:95], v[64:71], v116
    v_exp_f32 v79, v79
    v_exp_f32 v48, v48
    v_exp_f32 v49, v49
    v_smfmac_f32_32x32x32_bf16 v[240:255], v[96:99], v[72:79], v116
    v_exp_f32 v50, v50
    v_exp_f32 v51, v51
    v_exp_f32 v52, v52
    v_mfma_f32_32x32x16_bf16 v[64:79], v[84:87], v[20:23], 0
    v_exp_f32 v53, v53
    v_exp_f32 v54, v54
    v_exp_f32 v55, v55
    v_exp_f32 v56, v56
    buffer_load_dwordx4 v[80:83], v11, s[8:11], s24 offen offset:2048 sc1
    s_mov_b64 exec, s[68:69]
    buffer_load_dwordx4 v[92:95], v117, s[8:11], s24 offen offset:2048 sc1
    buffer_load_dwordx4 v[96:99], v117, s[8:11], s24 offen offset:2560 sc1
    s_mov_b64 exec, -1
    v_exp_f32 v57, v57
    v_exp_f32 v58, v58
    v_exp_f32 v59, v59
    v_exp_f32 v60, v60
    v_exp_f32 v61, v61
    v_exp_f32 v62, v62
    v_smfmac_f32_32x32x32_bf16 v[128:143], v[100:103], v[48:55], v116
    v_exp_f32 v63, v63
    v_exp_f32 v64, v64
    v_exp_f32 v65, v65
    v_smfmac_f32_32x32x32_bf16 v[128:143], v[104:107], v[56:63], v116
    v_exp_f32 v66, v66
    v_exp_f32 v67, v67
    v_exp_f32 v68, v68
    v_mfma_f32_32x32x16_bf16 v[48:63], v[84:87], v[24:27], 0
    v_exp_f32 v69, v69
    v_exp_f32 v70, v70
    v_exp_f32 v71, v71
    v_exp_f32 v72, v72
    v_exp_f32 v73, v73
    v_exp_f32 v74, v74
    v_exp_f32 v75, v75
    v_exp_f32 v76, v76
    v_exp_f32 v77, v77
    v_exp_f32 v78, v78
    v_smfmac_f32_32x32x32_bf16 v[144:159], v[100:103], v[64:71], v116
    v_exp_f32 v79, v79
    v_exp_f32 v48, v48
    v_exp_f32 v49, v49
    v_smfmac_f32_32x32x32_bf16 v[144:159], v[104:107], v[72:79], v116
    v_exp_f32 v50, v50
    v_exp_f32 v51, v51
    v_exp_f32 v52, v52
    v_mfma_f32_32x32x16_bf16 v[64:79], v[84:87], v[28:31], 0
    v_exp_f32 v53, v53
    v_exp_f32 v54, v54
    v_exp_f32 v55, v55
    v_exp_f32 v56, v56
    v_exp_f32 v57, v57
    v_exp_f32 v58, v58
    v_exp_f32 v59, v59
    v_exp_f32 v60, v60
    v_exp_f32 v61, v61
    v_exp_f32 v62, v62
    v_smfmac_f32_32x32x32_bf16 v[160:175], v[100:103], v[48:55], v116
    v_exp_f32 v63, v63
    v_exp_f32 v64, v64
    v_exp_f32 v65, v65
    v_smfmac_f32_32x32x32_bf16 v[160:175], v[104:107], v[56:63], v116
    v_exp_f32 v66, v66
    v_exp_f32 v67, v67
    v_exp_f32 v68, v68
    v_mfma_f32_32x32x16_bf16 v[48:63], v[84:87], v[32:35], 0
    v_exp_f32 v69, v69
    v_exp_f32 v70, v70
    v_exp_f32 v71, v71
    v_exp_f32 v72, v72
    v_exp_f32 v73, v73
    v_exp_f32 v74, v74
    v_exp_f32 v75, v75
    v_exp_f32 v76, v76
    v_exp_f32 v77, v77
    v_exp_f32 v78, v78
    v_smfmac_f32_32x32x32_bf16 v[176:191], v[100:103], v[64:71], v116
    v_exp_f32 v79, v79
    v_exp_f32 v48, v48
    v_exp_f32 v49, v49
    v_smfmac_f32_32x32x32_bf16 v[176:191], v[104:107], v[72:79], v116
    v_exp_f32 v50, v50
    v_exp_f32 v51, v51
    v_exp_f32 v52, v52
    v_mfma_f32_32x32x16_bf16 v[64:79], v[84:87], v[36:39], 0
    v_exp_f32 v53, v53
    v_exp_f32 v54, v54
    v_exp_f32 v55, v55
    v_exp_f32 v56, v56
    v_exp_f32 v57, v57
    v_exp_f32 v58, v58
    v_exp_f32 v59, v59
    v_exp_f32 v60, v60
    v_exp_f32 v61, v61
    v_exp_f32 v62, v62
    v_smfmac_f32_32x32x32_bf16 v[192:207], v[100:103], v[48:55], v116
    v_exp_f32 v63, v63
    v_exp_f32 v64, v64
    v_exp_f32 v65, v65
    v_smfmac_f32_32x32x32_bf16 v[192:207], v[104:107], v[56:63], v116
    v_exp_f32 v66, v66
    v_exp_f32 v67, v67
    v_exp_f32 v68, v68
    v_mfma_f32_32x32x16_bf16 v[48:63], v[84:87], v[40:43], 0
    v_exp_f32 v69, v69
    v_exp_f32 v70, v70
    v_exp_f32 v71, v71
    v_exp_f32 v72, v72
    v_exp_f32 v73, v73
    v_exp_f32 v74, v74
    v_exp_f32 v75, v75
    v_exp_f32 v76, v76
    v_exp_f32 v77, v77
    v_exp_f32 v78, v78
    v_smfmac_f32_32x32x32_bf16 v[208:223], v[100:103], v[64:71], v116
    v_exp_f32 v79, v79
    v_exp_f32 v48, v48
    v_exp_f32 v49, v49
    v_smfmac_f32_32x32x32_bf16 v[208:223], v[104:107], v[72:79], v116
    v_exp_f32 v50, v50
    v_exp_f32 v51, v51
    v_exp_f32 v52, v52
    v_mfma_f32_32x32x16_bf16 v[64:79], v[84:87], v[44:47], 0
    v_exp_f32 v53, v53
    v_exp_f32 v54, v54
    v_exp_f32 v55, v55
    v_exp_f32 v56, v56
    v_exp_f32 v57, v57
    v_exp_f32 v58, v58
    v_exp_f32 v59, v59
    v_exp_f32 v60, v60
    v_exp_f32 v61, v61
    v_exp_f32 v62, v62
    v_smfmac_f32_32x32x32_bf16 v[224:239], v[100:103], v[48:55], v116
    v_exp_f32 v63, v63
    v_exp_f32 v64, v64
    v_exp_f32 v65, v65
    v_smfmac_f32_32x32x32_bf16 v[224:239], v[104:107], v[56:63], v116
    v_exp_f32 v66, v66
    v_exp_f32 v67, v67
    v_exp_f32 v68, v68
    s_waitcnt vmcnt(3)
    v_mfma_f32_32x32x16_bf16 v[48:63], v[88:91], v[16:19], 0
    v_exp_f32 v69, v69
    v_exp_f32 v70, v70
    v_exp_f32 v71, v71
    v_exp_f32 v72, v72
    v_exp_f32 v73, v73
    v_exp_f32 v74, v74
    v_exp_f32 v75, v75
    v_exp_f32 v76, v76
    v_exp_f32 v77, v77
    v_exp_f32 v78, v78
    v_smfmac_f32_32x32x32_bf16 v[240:255], v[100:103], v[64:71], v116
    v_exp_f32 v79, v79
    v_exp_f32 v48, v48
    v_exp_f32 v49, v49
    v_smfmac_f32_32x32x32_bf16 v[240:255], v[104:107], v[72:79], v116
    v_exp_f32 v50, v50
    v_exp_f32 v51, v51
    v_exp_f32 v52, v52
    v_mfma_f32_32x32x16_bf16 v[64:79], v[88:91], v[20:23], 0
    v_exp_f32 v53, v53
    v_exp_f32 v54, v54
    v_exp_f32 v55, v55
    v_exp_f32 v56, v56
    buffer_load_dwordx4 v[84:87], v11, s[8:11], s25 offen offset:0 sc1
    s_mov_b64 exec, s[68:69]
    buffer_load_dwordx4 v[100:103], v117, s[8:11], s25 offen offset:0 sc1
    buffer_load_dwordx4 v[104:107], v117, s[8:11], s25 offen offset:512 sc1
    s_mov_b64 exec, -1
    v_exp_f32 v57, v57
    v_exp_f32 v58, v58
    v_exp_f32 v59, v59
    v_exp_f32 v60, v60
    v_exp_f32 v61, v61
    v_exp_f32 v62, v62
    v_smfmac_f32_32x32x32_bf16 v[128:143], v[108:111], v[48:55], v116
    v_exp_f32 v63, v63
    v_exp_f32 v64, v64
    v_exp_f32 v65, v65
    v_smfmac_f32_32x32x32_bf16 v[128:143], v[112:115], v[56:63], v116
    v_exp_f32 v66, v66
    v_exp_f32 v67, v67
    v_exp_f32 v68, v68
    v_mfma_f32_32x32x16_bf16 v[48:63], v[88:91], v[24:27], 0
    v_exp_f32 v69, v69
    v_exp_f32 v70, v70
    v_exp_f32 v71, v71
    v_exp_f32 v72, v72
    v_exp_f32 v73, v73
    v_exp_f32 v74, v74
    v_exp_f32 v75, v75
    v_exp_f32 v76, v76
    v_exp_f32 v77, v77
    v_exp_f32 v78, v78
    v_smfmac_f32_32x32x32_bf16 v[144:159], v[108:111], v[64:71], v116
    v_exp_f32 v79, v79
    v_exp_f32 v48, v48
    v_exp_f32 v49, v49
    v_smfmac_f32_32x32x32_bf16 v[144:159], v[112:115], v[72:79], v116
    v_exp_f32 v50, v50
    v_exp_f32 v51, v51
    v_exp_f32 v52, v52
    v_mfma_f32_32x32x16_bf16 v[64:79], v[88:91], v[28:31], 0
    v_exp_f32 v53, v53
    v_exp_f32 v54, v54
    v_exp_f32 v55, v55
    v_exp_f32 v56, v56
    v_exp_f32 v57, v57
    v_exp_f32 v58, v58
    v_exp_f32 v59, v59
    v_exp_f32 v60, v60
    v_exp_f32 v61, v61
    v_exp_f32 v62, v62
    v_smfmac_f32_32x32x32_bf16 v[160:175], v[108:111], v[48:55], v116
    v_exp_f32 v63, v63
    v_exp_f32 v64, v64
    v_exp_f32 v65, v65
    v_smfmac_f32_32x32x32_bf16 v[160:175], v[112:115], v[56:63], v116
    v_exp_f32 v66, v66
    v_exp_f32 v67, v67
    v_exp_f32 v68, v68
    v_mfma_f32_32x32x16_bf16 v[48:63], v[88:91], v[32:35], 0
    v_exp_f32 v69, v69
    v_exp_f32 v70, v70
    v_exp_f32 v71, v71
    v_exp_f32 v72, v72
    v_exp_f32 v73, v73
    v_exp_f32 v74, v74
    v_exp_f32 v75, v75
    v_exp_f32 v76, v76
    v_exp_f32 v77, v77
    v_exp_f32 v78, v78
    v_smfmac_f32_32x32x32_bf16 v[176:191], v[108:111], v[64:71], v116
    v_exp_f32 v79, v79
    v_exp_f32 v48, v48
    v_exp_f32 v49, v49
    v_smfmac_f32_32x32x32_bf16 v[176:191], v[112:115], v[72:79], v116
    v_exp_f32 v50, v50
    v_exp_f32 v51, v51
    v_exp_f32 v52, v52
    v_mfma_f32_32x32x16_bf16 v[64:79], v[88:91], v[36:39], 0
    v_exp_f32 v53, v53
    v_exp_f32 v54, v54
    v_exp_f32 v55, v55
    v_exp_f32 v56, v56
    v_exp_f32 v57, v57
    v_exp_f32 v58, v58
    v_exp_f32 v59, v59
    v_exp_f32 v60, v60
    v_exp_f32 v61, v61
    v_exp_f32 v62, v62
    v_smfmac_f32_32x32x32_bf16 v[192:207], v[108:111], v[48:55], v116
    v_exp_f32 v63, v63
    v_exp_f32 v64, v64
    v_exp_f32 v65, v65
    v_smfmac_f32_32x32x32_bf16 v[192:207], v[112:115], v[56:63], v116
    v_exp_f32 v66, v66
    v_exp_f32 v67, v67
    v_exp_f32 v68, v68
    v_mfma_f32_32x32x16_bf16 v[48:63], v[88:91], v[40:43], 0
    v_exp_f32 v69, v69
    v_exp_f32 v70, v70
    v_exp_f32 v71, v71
    v_exp_f32 v72, v72
    v_exp_f32 v73, v73
    v_exp_f32 v74, v74
    v_exp_f32 v75, v75
    v_exp_f32 v76, v76
    v_exp_f32 v77, v77
    v_exp_f32 v78, v78
    v_smfmac_f32_32x32x32_bf16 v[208:223], v[108:111], v[64:71], v116
    v_exp_f32 v79, v79
    v_exp_f32 v48, v48
    v_exp_f32 v49, v49
    v_smfmac_f32_32x32x32_bf16 v[208:223], v[112:115], v[72:79], v116
    v_exp_f32 v50, v50
    v_exp_f32 v51, v51
    v_exp_f32 v52, v52
    v_mfma_f32_32x32x16_bf16 v[64:79], v[88:91], v[44:47], 0
    v_exp_f32 v53, v53
    v_exp_f32 v54, v54
    v_exp_f32 v55, v55
    v_exp_f32 v56, v56
    v_exp_f32 v57, v57
    v_exp_f32 v58, v58
    v_exp_f32 v59, v59
    v_exp_f32 v60, v60
    v_exp_f32 v61, v61
    v_exp_f32 v62, v62
    v_smfmac_f32_32x32x32_bf16 v[224:239], v[108:111], v[48:55], v116
    v_exp_f32 v63, v63
    v_exp_f32 v64, v64
    v_exp_f32 v65, v65
    v_smfmac_f32_32x32x32_bf16 v[224:239], v[112:115], v[56:63], v116
    v_exp_f32 v66, v66
    v_exp_f32 v67, v67
    v_exp_f32 v68, v68
    s_waitcnt vmcnt(3)
    v_mfma_f32_32x32x16_bf16 v[48:63], v[80:83], v[16:19], 0
    v_exp_f32 v69, v69
    v_exp_f32 v70, v70
    v_exp_f32 v71, v71
    v_exp_f32 v72, v72
    v_exp_f32 v73, v73
    v_exp_f32 v74, v74
    v_exp_f32 v75, v75
    v_exp_f32 v76, v76
    v_exp_f32 v77, v77
    v_exp_f32 v78, v78
    v_smfmac_f32_32x32x32_bf16 v[240:255], v[108:111], v[64:71], v116
    v_exp_f32 v79, v79
    s_buffer_load_dwordx2 s[98:99], s[8:11], s60 offset:60
    s_buffer_load_dwordx2 s[98:99], s[8:11], s60 offset:188
    s_buffer_load_dwordx2 s[98:99], s[8:11], s60 offset:316
    s_buffer_load_dwordx2 s[98:99], s[8:11], s60 offset:444
    s_buffer_load_dwordx2 s[98:99], s[8:11], s60 offset:572
    s_buffer_load_dwordx2 s[98:99], s[8:11], s60 offset:700
    v_exp_f32 v48, v48
    v_exp_f32 v49, v49
    v_smfmac_f32_32x32x32_bf16 v[240:255], v[112:115], v[72:79], v116
    v_exp_f32 v50, v50
    v_exp_f32 v51, v51
    v_exp_f32 v52, v52
    v_mfma_f32_32x32x16_bf16 v[64:79], v[80:83], v[20:23], 0
    v_exp_f32 v53, v53
    v_exp_f32 v54, v54
    v_exp_f32 v55, v55
    v_exp_f32 v56, v56
    buffer_load_dwordx4 v[88:91], v11, s[8:11], s25 offen offset:2048 sc1
    s_mov_b64 exec, s[68:69]
    buffer_load_dwordx4 v[108:111], v117, s[8:11], s25 offen offset:2048 sc1
    buffer_load_dwordx4 v[112:115], v117, s[8:11], s25 offen offset:2560 sc1
    s_mov_b64 exec, -1
    v_exp_f32 v57, v57
    v_exp_f32 v58, v58
    v_exp_f32 v59, v59
    v_exp_f32 v60, v60
    v_exp_f32 v61, v61
    v_exp_f32 v62, v62
    v_smfmac_f32_32x32x32_bf16 v[128:143], v[92:95], v[48:55], v116
    v_exp_f32 v63, v63
    v_exp_f32 v64, v64
    v_exp_f32 v65, v65
    v_smfmac_f32_32x32x32_bf16 v[128:143], v[96:99], v[56:63], v116
    v_exp_f32 v66, v66
    v_exp_f32 v67, v67
    v_exp_f32 v68, v68
    v_mfma_f32_32x32x16_bf16 v[48:63], v[80:83], v[24:27], 0
    v_exp_f32 v69, v69
    v_exp_f32 v70, v70
    v_exp_f32 v71, v71
    v_exp_f32 v72, v72
    v_exp_f32 v73, v73
    v_exp_f32 v74, v74
    v_exp_f32 v75, v75
    v_exp_f32 v76, v76
    v_exp_f32 v77, v77
    v_exp_f32 v78, v78
    v_smfmac_f32_32x32x32_bf16 v[144:159], v[92:95], v[64:71], v116
    v_exp_f32 v79, v79
    v_exp_f32 v48, v48
    v_exp_f32 v49, v49
    v_smfmac_f32_32x32x32_bf16 v[144:159], v[96:99], v[72:79], v116
    v_exp_f32 v50, v50
    v_exp_f32 v51, v51
    v_exp_f32 v52, v52
    v_mfma_f32_32x32x16_bf16 v[64:79], v[80:83], v[28:31], 0
    v_exp_f32 v53, v53
    v_exp_f32 v54, v54
    v_exp_f32 v55, v55
    v_exp_f32 v56, v56
    v_exp_f32 v57, v57
    v_exp_f32 v58, v58
    v_exp_f32 v59, v59
    v_exp_f32 v60, v60
    v_exp_f32 v61, v61
    v_exp_f32 v62, v62
    v_smfmac_f32_32x32x32_bf16 v[160:175], v[92:95], v[48:55], v116
    v_exp_f32 v63, v63
    v_exp_f32 v64, v64
    v_exp_f32 v65, v65
    v_smfmac_f32_32x32x32_bf16 v[160:175], v[96:99], v[56:63], v116
    v_exp_f32 v66, v66
    v_exp_f32 v67, v67
    v_exp_f32 v68, v68
    v_mfma_f32_32x32x16_bf16 v[48:63], v[80:83], v[32:35], 0
    v_exp_f32 v69, v69
    v_exp_f32 v70, v70
    v_exp_f32 v71, v71
    v_exp_f32 v72, v72
    v_exp_f32 v73, v73
    v_exp_f32 v74, v74
    v_exp_f32 v75, v75
    v_exp_f32 v76, v76
    v_exp_f32 v77, v77
    v_exp_f32 v78, v78
    v_smfmac_f32_32x32x32_bf16 v[176:191], v[92:95], v[64:71], v116
    v_exp_f32 v79, v79
    v_exp_f32 v48, v48
    v_exp_f32 v49, v49
    v_smfmac_f32_32x32x32_bf16 v[176:191], v[96:99], v[72:79], v116
    v_exp_f32 v50, v50
    v_exp_f32 v51, v51
    v_exp_f32 v52, v52
    v_mfma_f32_32x32x16_bf16 v[64:79], v[80:83], v[36:39], 0
    v_exp_f32 v53, v53
    v_exp_f32 v54, v54
    v_exp_f32 v55, v55
    v_exp_f32 v56, v56
    v_exp_f32 v57, v57
    v_exp_f32 v58, v58
    v_exp_f32 v59, v59
    v_exp_f32 v60, v60
    v_exp_f32 v61, v61
    v_exp_f32 v62, v62
    v_smfmac_f32_32x32x32_bf16 v[192:207], v[92:95], v[48:55], v116
    v_exp_f32 v63, v63
    v_exp_f32 v64, v64
    v_exp_f32 v65, v65
    v_smfmac_f32_32x32x32_bf16 v[192:207], v[96:99], v[56:63], v116
    v_exp_f32 v66, v66
    v_exp_f32 v67, v67
    v_exp_f32 v68, v68
    v_mfma_f32_32x32x16_bf16 v[48:63], v[80:83], v[40:43], 0
    v_exp_f32 v69, v69
    v_exp_f32 v70, v70
    v_exp_f32 v71, v71
    v_exp_f32 v72, v72
    v_exp_f32 v73, v73
    v_exp_f32 v74, v74
    v_exp_f32 v75, v75
    v_exp_f32 v76, v76
    v_exp_f32 v77, v77
    v_exp_f32 v78, v78
    v_smfmac_f32_32x32x32_bf16 v[208:223], v[92:95], v[64:71], v116
    v_exp_f32 v79, v79
    v_exp_f32 v48, v48
    v_exp_f32 v49, v49
    v_smfmac_f32_32x32x32_bf16 v[208:223], v[96:99], v[72:79], v116
    v_exp_f32 v50, v50
    v_exp_f32 v51, v51
    v_exp_f32 v52, v52
    v_mfma_f32_32x32x16_bf16 v[64:79], v[80:83], v[44:47], 0
    v_exp_f32 v53, v53
    v_exp_f32 v54, v54
    v_exp_f32 v55, v55
    v_exp_f32 v56, v56
    v_exp_f32 v57, v57
    v_exp_f32 v58, v58
    v_exp_f32 v59, v59
    v_exp_f32 v60, v60
    v_exp_f32 v61, v61
    v_exp_f32 v62, v62
    v_smfmac_f32_32x32x32_bf16 v[224:239], v[92:95], v[48:55], v116
    v_exp_f32 v63, v63
    v_exp_f32 v64, v64
    v_exp_f32 v65, v65
    v_smfmac_f32_32x32x32_bf16 v[224:239], v[96:99], v[56:63], v116
    v_exp_f32 v66, v66
    v_exp_f32 v67, v67
    v_exp_f32 v68, v68
    s_waitcnt vmcnt(3)
    v_mfma_f32_32x32x16_bf16 v[48:63], v[84:87], v[16:19], 0
    v_exp_f32 v69, v69
    v_exp_f32 v70, v70
    v_exp_f32 v71, v71
    v_exp_f32 v72, v72
    v_exp_f32 v73, v73
    v_exp_f32 v74, v74
    v_exp_f32 v75, v75
    v_exp_f32 v76, v76
    v_exp_f32 v77, v77
    v_exp_f32 v78, v78
    v_smfmac_f32_32x32x32_bf16 v[240:255], v[92:95], v[64:71], v116
    v_exp_f32 v79, v79
    v_exp_f32 v48, v48
    v_exp_f32 v49, v49
    v_smfmac_f32_32x32x32_bf16 v[240:255], v[96:99], v[72:79], v116
    v_exp_f32 v50, v50
    v_exp_f32 v51, v51
    v_exp_f32 v52, v52
    v_mfma_f32_32x32x16_bf16 v[64:79], v[84:87], v[20:23], 0
    v_exp_f32 v53, v53
    v_exp_f32 v54, v54
    v_exp_f32 v55, v55
    v_exp_f32 v56, v56
    buffer_load_dwordx4 v[80:83], v11, s[8:11], s26 offen offset:0 sc1
    s_mov_b64 exec, s[68:69]
    buffer_load_dwordx4 v[92:95], v117, s[8:11], s26 offen offset:0 sc1
    buffer_load_dwordx4 v[96:99], v117, s[8:11], s26 offen offset:512 sc1
    s_mov_b64 exec, -1
    v_exp_f32 v57, v57
    v_exp_f32 v58, v58
    v_exp_f32 v59, v59
    v_exp_f32 v60, v60
    v_exp_f32 v61, v61
    v_exp_f32 v62, v62
    v_smfmac_f32_32x32x32_bf16 v[128:143], v[100:103], v[48:55], v116
    v_exp_f32 v63, v63
    v_exp_f32 v64, v64
    v_exp_f32 v65, v65
    v_smfmac_f32_32x32x32_bf16 v[128:143], v[104:107], v[56:63], v116
    v_exp_f32 v66, v66
    v_exp_f32 v67, v67
    v_exp_f32 v68, v68
    v_mfma_f32_32x32x16_bf16 v[48:63], v[84:87], v[24:27], 0
    v_exp_f32 v69, v69
    v_exp_f32 v70, v70
    v_exp_f32 v71, v71
    v_exp_f32 v72, v72
    v_exp_f32 v73, v73
    v_exp_f32 v74, v74
    v_exp_f32 v75, v75
    v_exp_f32 v76, v76
    v_exp_f32 v77, v77
    v_exp_f32 v78, v78
    v_smfmac_f32_32x32x32_bf16 v[144:159], v[100:103], v[64:71], v116
    v_exp_f32 v79, v79
    v_exp_f32 v48, v48
    v_exp_f32 v49, v49
    v_smfmac_f32_32x32x32_bf16 v[144:159], v[104:107], v[72:79], v116
    v_exp_f32 v50, v50
    v_exp_f32 v51, v51
    v_exp_f32 v52, v52
    v_mfma_f32_32x32x16_bf16 v[64:79], v[84:87], v[28:31], 0
    v_exp_f32 v53, v53
    v_exp_f32 v54, v54
    v_exp_f32 v55, v55
    v_exp_f32 v56, v56
    v_exp_f32 v57, v57
    v_exp_f32 v58, v58
    v_exp_f32 v59, v59
    v_exp_f32 v60, v60
    v_exp_f32 v61, v61
    v_exp_f32 v62, v62
    v_smfmac_f32_32x32x32_bf16 v[160:175], v[100:103], v[48:55], v116
    v_exp_f32 v63, v63
    v_exp_f32 v64, v64
    v_exp_f32 v65, v65
    v_smfmac_f32_32x32x32_bf16 v[160:175], v[104:107], v[56:63], v116
    v_exp_f32 v66, v66
    v_exp_f32 v67, v67
    v_exp_f32 v68, v68
    v_mfma_f32_32x32x16_bf16 v[48:63], v[84:87], v[32:35], 0
    v_exp_f32 v69, v69
    v_exp_f32 v70, v70
    v_exp_f32 v71, v71
    v_exp_f32 v72, v72
    v_exp_f32 v73, v73
    v_exp_f32 v74, v74
    v_exp_f32 v75, v75
    v_exp_f32 v76, v76
    v_exp_f32 v77, v77
    v_exp_f32 v78, v78
    v_smfmac_f32_32x32x32_bf16 v[176:191], v[100:103], v[64:71], v116
    v_exp_f32 v79, v79
    v_exp_f32 v48, v48
    v_exp_f32 v49, v49
    v_smfmac_f32_32x32x32_bf16 v[176:191], v[104:107], v[72:79], v116
    v_exp_f32 v50, v50
    v_exp_f32 v51, v51
    v_exp_f32 v52, v52
    v_mfma_f32_32x32x16_bf16 v[64:79], v[84:87], v[36:39], 0
    v_exp_f32 v53, v53
    v_exp_f32 v54, v54
    v_exp_f32 v55, v55
    v_exp_f32 v56, v56
    v_exp_f32 v57, v57
    v_exp_f32 v58, v58
    v_exp_f32 v59, v59
    v_exp_f32 v60, v60
    v_exp_f32 v61, v61
    v_exp_f32 v62, v62
    v_smfmac_f32_32x32x32_bf16 v[192:207], v[100:103], v[48:55], v116
    v_exp_f32 v63, v63
    v_exp_f32 v64, v64
    v_exp_f32 v65, v65
    v_smfmac_f32_32x32x32_bf16 v[192:207], v[104:107], v[56:63], v116
    v_exp_f32 v66, v66
    v_exp_f32 v67, v67
    v_exp_f32 v68, v68
    v_mfma_f32_32x32x16_bf16 v[48:63], v[84:87], v[40:43], 0
    v_exp_f32 v69, v69
    v_exp_f32 v70, v70
    v_exp_f32 v71, v71
    v_exp_f32 v72, v72
    v_exp_f32 v73, v73
    v_exp_f32 v74, v74
    v_exp_f32 v75, v75
    v_exp_f32 v76, v76
    v_exp_f32 v77, v77
    v_exp_f32 v78, v78
    v_smfmac_f32_32x32x32_bf16 v[208:223], v[100:103], v[64:71], v116
    v_exp_f32 v79, v79
    v_exp_f32 v48, v48
    v_exp_f32 v49, v49
    v_smfmac_f32_32x32x32_bf16 v[208:223], v[104:107], v[72:79], v116
    v_exp_f32 v50, v50
    v_exp_f32 v51, v51
    v_exp_f32 v52, v52
    v_mfma_f32_32x32x16_bf16 v[64:79], v[84:87], v[44:47], 0
    v_exp_f32 v53, v53
    v_exp_f32 v54, v54
    v_exp_f32 v55, v55
    v_exp_f32 v56, v56
    v_exp_f32 v57, v57
    v_exp_f32 v58, v58
    v_exp_f32 v59, v59
    v_exp_f32 v60, v60
    v_exp_f32 v61, v61
    v_exp_f32 v62, v62
    v_smfmac_f32_32x32x32_bf16 v[224:239], v[100:103], v[48:55], v116
    v_exp_f32 v63, v63
    v_exp_f32 v64, v64
    v_exp_f32 v65, v65
    v_smfmac_f32_32x32x32_bf16 v[224:239], v[104:107], v[56:63], v116
    v_exp_f32 v66, v66
    v_exp_f32 v67, v67
    v_exp_f32 v68, v68
    s_waitcnt vmcnt(3)
    v_mfma_f32_32x32x16_bf16 v[48:63], v[88:91], v[16:19], 0
    v_exp_f32 v69, v69
    v_exp_f32 v70, v70
    v_exp_f32 v71, v71
    v_exp_f32 v72, v72
    v_exp_f32 v73, v73
    v_exp_f32 v74, v74
    v_exp_f32 v75, v75
    v_exp_f32 v76, v76
    v_exp_f32 v77, v77
    v_exp_f32 v78, v78
    v_smfmac_f32_32x32x32_bf16 v[240:255], v[100:103], v[64:71], v116
    v_exp_f32 v79, v79
    s_buffer_load_dwordx2 s[98:99], s[8:11], s60 offset:828
    s_buffer_load_dwordx2 s[98:99], s[8:11], s60 offset:956
    s_buffer_load_dwordx2 s[98:99], s[8:11], s60 offset:1084
    s_buffer_load_dwordx2 s[98:99], s[8:11], s60 offset:1212
    s_buffer_load_dwordx2 s[98:99], s[8:11], s60 offset:1340
    s_buffer_load_dwordx2 s[98:99], s[8:11], s60 offset:1468
    v_exp_f32 v48, v48
    v_exp_f32 v49, v49
    v_smfmac_f32_32x32x32_bf16 v[240:255], v[104:107], v[72:79], v116
    v_exp_f32 v50, v50
    v_exp_f32 v51, v51
    v_exp_f32 v52, v52
    v_mfma_f32_32x32x16_bf16 v[64:79], v[88:91], v[20:23], 0
    v_exp_f32 v53, v53
    v_exp_f32 v54, v54
    v_exp_f32 v55, v55
    v_exp_f32 v56, v56
    buffer_load_dwordx4 v[84:87], v11, s[8:11], s26 offen offset:2048 sc1
    s_mov_b64 exec, s[68:69]
    buffer_load_dwordx4 v[100:103], v117, s[8:11], s26 offen offset:2048 sc1
    buffer_load_dwordx4 v[104:107], v117, s[8:11], s26 offen offset:2560 sc1
    s_mov_b64 exec, -1
    v_exp_f32 v57, v57
    v_exp_f32 v58, v58
    v_exp_f32 v59, v59
    v_exp_f32 v60, v60
    v_exp_f32 v61, v61
    v_exp_f32 v62, v62
    v_smfmac_f32_32x32x32_bf16 v[128:143], v[108:111], v[48:55], v116
    v_exp_f32 v63, v63
    v_exp_f32 v64, v64
    v_exp_f32 v65, v65
    v_smfmac_f32_32x32x32_bf16 v[128:143], v[112:115], v[56:63], v116
    v_exp_f32 v66, v66
    v_exp_f32 v67, v67
    v_exp_f32 v68, v68
    v_mfma_f32_32x32x16_bf16 v[48:63], v[88:91], v[24:27], 0
    v_exp_f32 v69, v69
    v_exp_f32 v70, v70
    v_exp_f32 v71, v71
    v_exp_f32 v72, v72
    v_exp_f32 v73, v73
    v_exp_f32 v74, v74
    v_exp_f32 v75, v75
    v_exp_f32 v76, v76
    v_exp_f32 v77, v77
    v_exp_f32 v78, v78
    v_smfmac_f32_32x32x32_bf16 v[144:159], v[108:111], v[64:71], v116
    v_exp_f32 v79, v79
    v_exp_f32 v48, v48
    v_exp_f32 v49, v49
    v_smfmac_f32_32x32x32_bf16 v[144:159], v[112:115], v[72:79], v116
    v_exp_f32 v50, v50
    v_exp_f32 v51, v51
    v_exp_f32 v52, v52
    v_mfma_f32_32x32x16_bf16 v[64:79], v[88:91], v[28:31], 0
    v_exp_f32 v53, v53
    v_exp_f32 v54, v54
    v_exp_f32 v55, v55
    v_exp_f32 v56, v56
    v_exp_f32 v57, v57
    v_exp_f32 v58, v58
    v_exp_f32 v59, v59
    v_exp_f32 v60, v60
    v_exp_f32 v61, v61
    v_exp_f32 v62, v62
    v_smfmac_f32_32x32x32_bf16 v[160:175], v[108:111], v[48:55], v116
    v_exp_f32 v63, v63
    v_exp_f32 v64, v64
    v_exp_f32 v65, v65
    v_smfmac_f32_32x32x32_bf16 v[160:175], v[112:115], v[56:63], v116
    v_exp_f32 v66, v66
    v_exp_f32 v67, v67
    v_exp_f32 v68, v68
    v_mfma_f32_32x32x16_bf16 v[48:63], v[88:91], v[32:35], 0
    v_exp_f32 v69, v69
    v_exp_f32 v70, v70
    v_exp_f32 v71, v71
    v_exp_f32 v72, v72
    v_exp_f32 v73, v73
    v_exp_f32 v74, v74
    v_exp_f32 v75, v75
    v_exp_f32 v76, v76
    v_exp_f32 v77, v77
    v_exp_f32 v78, v78
    v_smfmac_f32_32x32x32_bf16 v[176:191], v[108:111], v[64:71], v116
    v_exp_f32 v79, v79
    v_exp_f32 v48, v48
    v_exp_f32 v49, v49
    v_smfmac_f32_32x32x32_bf16 v[176:191], v[112:115], v[72:79], v116
    v_exp_f32 v50, v50
    v_exp_f32 v51, v51
    v_exp_f32 v52, v52
    v_mfma_f32_32x32x16_bf16 v[64:79], v[88:91], v[36:39], 0
    v_exp_f32 v53, v53
    v_exp_f32 v54, v54
    v_exp_f32 v55, v55
    v_exp_f32 v56, v56
    v_exp_f32 v57, v57
    v_exp_f32 v58, v58
    v_exp_f32 v59, v59
    v_exp_f32 v60, v60
    v_exp_f32 v61, v61
    v_exp_f32 v62, v62
    v_smfmac_f32_32x32x32_bf16 v[192:207], v[108:111], v[48:55], v116
    v_exp_f32 v63, v63
    v_exp_f32 v64, v64
    v_exp_f32 v65, v65
    v_smfmac_f32_32x32x32_bf16 v[192:207], v[112:115], v[56:63], v116
    v_exp_f32 v66, v66
    v_exp_f32 v67, v67
    v_exp_f32 v68, v68
    v_mfma_f32_32x32x16_bf16 v[48:63], v[88:91], v[40:43], 0
    v_exp_f32 v69, v69
    v_exp_f32 v70, v70
    v_exp_f32 v71, v71
    v_exp_f32 v72, v72
    v_exp_f32 v73, v73
    v_exp_f32 v74, v74
    v_exp_f32 v75, v75
    v_exp_f32 v76, v76
    v_exp_f32 v77, v77
    v_exp_f32 v78, v78
    v_smfmac_f32_32x32x32_bf16 v[208:223], v[108:111], v[64:71], v116
    v_exp_f32 v79, v79
    v_exp_f32 v48, v48
    v_exp_f32 v49, v49
    v_smfmac_f32_32x32x32_bf16 v[208:223], v[112:115], v[72:79], v116
    v_exp_f32 v50, v50
    v_exp_f32 v51, v51
    v_exp_f32 v52, v52
    v_mfma_f32_32x32x16_bf16 v[64:79], v[88:91], v[44:47], 0
    v_exp_f32 v53, v53
    v_exp_f32 v54, v54
    v_exp_f32 v55, v55
    v_exp_f32 v56, v56
    v_exp_f32 v57, v57
    v_exp_f32 v58, v58
    v_exp_f32 v59, v59
    v_exp_f32 v60, v60
    v_exp_f32 v61, v61
    v_exp_f32 v62, v62
    v_smfmac_f32_32x32x32_bf16 v[224:239], v[108:111], v[48:55], v116
    v_exp_f32 v63, v63
    v_exp_f32 v64, v64
    v_exp_f32 v65, v65
    v_smfmac_f32_32x32x32_bf16 v[224:239], v[112:115], v[56:63], v116
    v_exp_f32 v66, v66
    v_exp_f32 v67, v67
    v_exp_f32 v68, v68
    s_waitcnt vmcnt(3)
    v_mfma_f32_32x32x16_bf16 v[48:63], v[80:83], v[16:19], 0
    v_exp_f32 v69, v69
    v_exp_f32 v70, v70
    v_exp_f32 v71, v71
    v_exp_f32 v72, v72
    v_exp_f32 v73, v73
    v_exp_f32 v74, v74
    v_exp_f32 v75, v75
    v_exp_f32 v76, v76
    v_exp_f32 v77, v77
    v_exp_f32 v78, v78
    v_smfmac_f32_32x32x32_bf16 v[240:255], v[108:111], v[64:71], v116
    v_exp_f32 v79, v79
    v_exp_f32 v48, v48
    v_exp_f32 v49, v49
    v_smfmac_f32_32x32x32_bf16 v[240:255], v[112:115], v[72:79], v116
    v_exp_f32 v50, v50
    v_exp_f32 v51, v51
    v_exp_f32 v52, v52
    v_mfma_f32_32x32x16_bf16 v[64:79], v[80:83], v[20:23], 0
    v_exp_f32 v53, v53
    v_exp_f32 v54, v54
    v_exp_f32 v55, v55
    v_exp_f32 v56, v56
    buffer_load_dwordx4 v[88:91], v11, s[8:11], s27 offen offset:0 sc1
    s_mov_b64 exec, s[68:69]
    buffer_load_dwordx4 v[108:111], v117, s[8:11], s27 offen offset:0 sc1
    buffer_load_dwordx4 v[112:115], v117, s[8:11], s27 offen offset:512 sc1
    s_mov_b64 exec, -1
    v_exp_f32 v57, v57
    v_exp_f32 v58, v58
    v_exp_f32 v59, v59
    v_exp_f32 v60, v60
    v_exp_f32 v61, v61
    v_exp_f32 v62, v62
    v_smfmac_f32_32x32x32_bf16 v[128:143], v[92:95], v[48:55], v116
    v_exp_f32 v63, v63
    v_exp_f32 v64, v64
    v_exp_f32 v65, v65
    v_smfmac_f32_32x32x32_bf16 v[128:143], v[96:99], v[56:63], v116
    v_exp_f32 v66, v66
    v_exp_f32 v67, v67
    v_exp_f32 v68, v68
    v_mfma_f32_32x32x16_bf16 v[48:63], v[80:83], v[24:27], 0
    v_exp_f32 v69, v69
    v_exp_f32 v70, v70
    v_exp_f32 v71, v71
    v_exp_f32 v72, v72
    v_exp_f32 v73, v73
    v_exp_f32 v74, v74
    v_exp_f32 v75, v75
    v_exp_f32 v76, v76
    v_exp_f32 v77, v77
    v_exp_f32 v78, v78
    v_smfmac_f32_32x32x32_bf16 v[144:159], v[92:95], v[64:71], v116
    v_exp_f32 v79, v79
    v_exp_f32 v48, v48
    v_exp_f32 v49, v49
    v_smfmac_f32_32x32x32_bf16 v[144:159], v[96:99], v[72:79], v116
    v_exp_f32 v50, v50
    v_exp_f32 v51, v51
    v_exp_f32 v52, v52
    v_mfma_f32_32x32x16_bf16 v[64:79], v[80:83], v[28:31], 0
    v_exp_f32 v53, v53
    v_exp_f32 v54, v54
    v_exp_f32 v55, v55
    v_exp_f32 v56, v56
    v_exp_f32 v57, v57
    v_exp_f32 v58, v58
    v_exp_f32 v59, v59
    v_exp_f32 v60, v60
    v_exp_f32 v61, v61
    v_exp_f32 v62, v62
    v_smfmac_f32_32x32x32_bf16 v[160:175], v[92:95], v[48:55], v116
    v_exp_f32 v63, v63
    v_exp_f32 v64, v64
    v_exp_f32 v65, v65
    v_smfmac_f32_32x32x32_bf16 v[160:175], v[96:99], v[56:63], v116
    v_exp_f32 v66, v66
    v_exp_f32 v67, v67
    v_exp_f32 v68, v68
    v_mfma_f32_32x32x16_bf16 v[48:63], v[80:83], v[32:35], 0
    v_exp_f32 v69, v69
    v_exp_f32 v70, v70
    v_exp_f32 v71, v71
    v_exp_f32 v72, v72
    v_exp_f32 v73, v73
    v_exp_f32 v74, v74
    v_exp_f32 v75, v75
    v_exp_f32 v76, v76
    v_exp_f32 v77, v77
    v_exp_f32 v78, v78
    v_smfmac_f32_32x32x32_bf16 v[176:191], v[92:95], v[64:71], v116
    v_exp_f32 v79, v79
    v_exp_f32 v48, v48
    v_exp_f32 v49, v49
    v_smfmac_f32_32x32x32_bf16 v[176:191], v[96:99], v[72:79], v116
    v_exp_f32 v50, v50
    v_exp_f32 v51, v51
    v_exp_f32 v52, v52
    v_mfma_f32_32x32x16_bf16 v[64:79], v[80:83], v[36:39], 0
    v_exp_f32 v53, v53
    v_exp_f32 v54, v54
    v_exp_f32 v55, v55
    v_exp_f32 v56, v56
    v_exp_f32 v57, v57
    v_exp_f32 v58, v58
    v_exp_f32 v59, v59
    v_exp_f32 v60, v60
    v_exp_f32 v61, v61
    v_exp_f32 v62, v62
    v_smfmac_f32_32x32x32_bf16 v[192:207], v[92:95], v[48:55], v116
    v_exp_f32 v63, v63
    v_exp_f32 v64, v64
    v_exp_f32 v65, v65
    v_smfmac_f32_32x32x32_bf16 v[192:207], v[96:99], v[56:63], v116
    v_exp_f32 v66, v66
    v_exp_f32 v67, v67
    v_exp_f32 v68, v68
    v_mfma_f32_32x32x16_bf16 v[48:63], v[80:83], v[40:43], 0
    v_exp_f32 v69, v69
    v_exp_f32 v70, v70
    v_exp_f32 v71, v71
    v_exp_f32 v72, v72
    v_exp_f32 v73, v73
    v_exp_f32 v74, v74
    v_exp_f32 v75, v75
    v_exp_f32 v76, v76
    v_exp_f32 v77, v77
    v_exp_f32 v78, v78
    v_smfmac_f32_32x32x32_bf16 v[208:223], v[92:95], v[64:71], v116
    v_exp_f32 v79, v79
    v_exp_f32 v48, v48
    v_exp_f32 v49, v49
    v_smfmac_f32_32x32x32_bf16 v[208:223], v[96:99], v[72:79], v116
    v_exp_f32 v50, v50
    v_exp_f32 v51, v51
    v_exp_f32 v52, v52
    v_mfma_f32_32x32x16_bf16 v[64:79], v[80:83], v[44:47], 0
    v_exp_f32 v53, v53
    v_exp_f32 v54, v54
    v_exp_f32 v55, v55
    v_exp_f32 v56, v56
    v_exp_f32 v57, v57
    v_exp_f32 v58, v58
    v_exp_f32 v59, v59
    v_exp_f32 v60, v60
    v_exp_f32 v61, v61
    v_exp_f32 v62, v62
    v_smfmac_f32_32x32x32_bf16 v[224:239], v[92:95], v[48:55], v116
    v_exp_f32 v63, v63
    v_exp_f32 v64, v64
    v_exp_f32 v65, v65
    v_smfmac_f32_32x32x32_bf16 v[224:239], v[96:99], v[56:63], v116
    v_exp_f32 v66, v66
    v_exp_f32 v67, v67
    v_exp_f32 v68, v68
    s_waitcnt vmcnt(3)
    v_mfma_f32_32x32x16_bf16 v[48:63], v[84:87], v[16:19], 0
    v_exp_f32 v69, v69
    v_exp_f32 v70, v70
    v_exp_f32 v71, v71
    v_exp_f32 v72, v72
    v_exp_f32 v73, v73
    v_exp_f32 v74, v74
    v_exp_f32 v75, v75
    v_exp_f32 v76, v76
    v_exp_f32 v77, v77
    v_exp_f32 v78, v78
    v_smfmac_f32_32x32x32_bf16 v[240:255], v[92:95], v[64:71], v116
    v_exp_f32 v79, v79
    s_buffer_load_dwordx2 s[98:99], s[8:11], s60 offset:1596
    s_buffer_load_dwordx2 s[98:99], s[8:11], s60 offset:1724
    s_buffer_load_dwordx2 s[98:99], s[8:11], s60 offset:1852
    s_buffer_load_dwordx2 s[98:99], s[8:11], s60 offset:1980
    v_exp_f32 v48, v48
    v_exp_f32 v49, v49
    v_smfmac_f32_32x32x32_bf16 v[240:255], v[96:99], v[72:79], v116
    v_exp_f32 v50, v50
    v_exp_f32 v51, v51
    v_exp_f32 v52, v52
    v_mfma_f32_32x32x16_bf16 v[64:79], v[84:87], v[20:23], 0
    v_exp_f32 v53, v53
    v_exp_f32 v54, v54
    v_exp_f32 v55, v55
    v_exp_f32 v56, v56
    buffer_load_dwordx4 v[80:83], v11, s[8:11], s27 offen offset:2048 sc1
    s_mov_b64 exec, s[68:69]
    buffer_load_dwordx4 v[92:95], v117, s[8:11], s27 offen offset:2048 sc1
    buffer_load_dwordx4 v[96:99], v117, s[8:11], s27 offen offset:2560 sc1
    s_mov_b64 exec, -1
    v_exp_f32 v57, v57
    v_exp_f32 v58, v58
    v_exp_f32 v59, v59
    v_exp_f32 v60, v60
    v_exp_f32 v61, v61
    v_exp_f32 v62, v62
    v_smfmac_f32_32x32x32_bf16 v[128:143], v[100:103], v[48:55], v116
    v_exp_f32 v63, v63
    v_exp_f32 v64, v64
    v_exp_f32 v65, v65
    v_smfmac_f32_32x32x32_bf16 v[128:143], v[104:107], v[56:63], v116
    v_exp_f32 v66, v66
    v_exp_f32 v67, v67
    v_exp_f32 v68, v68
    v_mfma_f32_32x32x16_bf16 v[48:63], v[84:87], v[24:27], 0
    v_exp_f32 v69, v69
    v_exp_f32 v70, v70
    v_exp_f32 v71, v71
    v_exp_f32 v72, v72
    v_exp_f32 v73, v73
    v_exp_f32 v74, v74
    v_exp_f32 v75, v75
    v_exp_f32 v76, v76
    v_exp_f32 v77, v77
    v_exp_f32 v78, v78
    v_smfmac_f32_32x32x32_bf16 v[144:159], v[100:103], v[64:71], v116
    v_exp_f32 v79, v79
    v_exp_f32 v48, v48
    v_exp_f32 v49, v49
    v_smfmac_f32_32x32x32_bf16 v[144:159], v[104:107], v[72:79], v116
    v_exp_f32 v50, v50
    v_exp_f32 v51, v51
    v_exp_f32 v52, v52
    v_mfma_f32_32x32x16_bf16 v[64:79], v[84:87], v[28:31], 0
    v_exp_f32 v53, v53
    v_exp_f32 v54, v54
    v_exp_f32 v55, v55
    v_exp_f32 v56, v56
    v_exp_f32 v57, v57
    v_exp_f32 v58, v58
    v_exp_f32 v59, v59
    v_exp_f32 v60, v60
    v_exp_f32 v61, v61
    v_exp_f32 v62, v62
    v_smfmac_f32_32x32x32_bf16 v[160:175], v[100:103], v[48:55], v116
    v_exp_f32 v63, v63
    v_exp_f32 v64, v64
    v_exp_f32 v65, v65
    v_smfmac_f32_32x32x32_bf16 v[160:175], v[104:107], v[56:63], v116
    v_exp_f32 v66, v66
    v_exp_f32 v67, v67
    v_exp_f32 v68, v68
    v_mfma_f32_32x32x16_bf16 v[48:63], v[84:87], v[32:35], 0
    v_exp_f32 v69, v69
    v_exp_f32 v70, v70
    v_exp_f32 v71, v71
    v_exp_f32 v72, v72
    v_exp_f32 v73, v73
    v_exp_f32 v74, v74
    v_exp_f32 v75, v75
    v_exp_f32 v76, v76
    v_exp_f32 v77, v77
    v_exp_f32 v78, v78
    v_smfmac_f32_32x32x32_bf16 v[176:191], v[100:103], v[64:71], v116
    v_exp_f32 v79, v79
    v_exp_f32 v48, v48
    v_exp_f32 v49, v49
    v_smfmac_f32_32x32x32_bf16 v[176:191], v[104:107], v[72:79], v116
    v_exp_f32 v50, v50
    v_exp_f32 v51, v51
    v_exp_f32 v52, v52
    v_mfma_f32_32x32x16_bf16 v[64:79], v[84:87], v[36:39], 0
    v_exp_f32 v53, v53
    v_exp_f32 v54, v54
    v_exp_f32 v55, v55
    v_exp_f32 v56, v56
    v_exp_f32 v57, v57
    v_exp_f32 v58, v58
    v_exp_f32 v59, v59
    v_exp_f32 v60, v60
    v_exp_f32 v61, v61
    v_exp_f32 v62, v62
    v_smfmac_f32_32x32x32_bf16 v[192:207], v[100:103], v[48:55], v116
    v_exp_f32 v63, v63
    v_exp_f32 v64, v64
    v_exp_f32 v65, v65
    v_smfmac_f32_32x32x32_bf16 v[192:207], v[104:107], v[56:63], v116
    v_exp_f32 v66, v66
    v_exp_f32 v67, v67
    v_exp_f32 v68, v68
    v_mfma_f32_32x32x16_bf16 v[48:63], v[84:87], v[40:43], 0
    v_exp_f32 v69, v69
    v_exp_f32 v70, v70
    v_exp_f32 v71, v71
    v_exp_f32 v72, v72
    v_exp_f32 v73, v73
    v_exp_f32 v74, v74
    v_exp_f32 v75, v75
    v_exp_f32 v76, v76
    v_exp_f32 v77, v77
    v_exp_f32 v78, v78
    v_smfmac_f32_32x32x32_bf16 v[208:223], v[100:103], v[64:71], v116
    v_exp_f32 v79, v79
    v_exp_f32 v48, v48
    v_exp_f32 v49, v49
    v_smfmac_f32_32x32x32_bf16 v[208:223], v[104:107], v[72:79], v116
    v_exp_f32 v50, v50
    v_exp_f32 v51, v51
    v_exp_f32 v52, v52
    v_mfma_f32_32x32x16_bf16 v[64:79], v[84:87], v[44:47], 0
    v_exp_f32 v53, v53
    v_exp_f32 v54, v54
    v_exp_f32 v55, v55
    v_exp_f32 v56, v56
    v_exp_f32 v57, v57
    v_exp_f32 v58, v58
    v_exp_f32 v59, v59
    v_exp_f32 v60, v60
    v_exp_f32 v61, v61
    v_exp_f32 v62, v62
    v_smfmac_f32_32x32x32_bf16 v[224:239], v[100:103], v[48:55], v116
    v_exp_f32 v63, v63
    v_exp_f32 v64, v64
    v_exp_f32 v65, v65
    v_smfmac_f32_32x32x32_bf16 v[224:239], v[104:107], v[56:63], v116
    v_exp_f32 v66, v66
    v_exp_f32 v67, v67
    v_exp_f32 v68, v68
    s_waitcnt vmcnt(3)
    v_mfma_f32_32x32x16_bf16 v[48:63], v[88:91], v[16:19], 0
    v_exp_f32 v69, v69
    v_exp_f32 v70, v70
    v_exp_f32 v71, v71
    v_exp_f32 v72, v72
    v_exp_f32 v73, v73
    v_exp_f32 v74, v74
    v_exp_f32 v75, v75
    v_exp_f32 v76, v76
    v_exp_f32 v77, v77
    v_exp_f32 v78, v78
    v_smfmac_f32_32x32x32_bf16 v[240:255], v[100:103], v[64:71], v116
    v_exp_f32 v79, v79
    v_exp_f32 v48, v48
    v_exp_f32 v49, v49
    v_smfmac_f32_32x32x32_bf16 v[240:255], v[104:107], v[72:79], v116
    v_exp_f32 v50, v50
    v_exp_f32 v51, v51
    v_exp_f32 v52, v52
    v_mfma_f32_32x32x16_bf16 v[64:79], v[88:91], v[20:23], 0
    v_exp_f32 v53, v53
    v_exp_f32 v54, v54
    v_exp_f32 v55, v55
    v_exp_f32 v56, v56
    v_exp_f32 v57, v57
    v_exp_f32 v58, v58
    v_exp_f32 v59, v59
    v_exp_f32 v60, v60
    v_exp_f32 v61, v61
    v_exp_f32 v62, v62
    v_smfmac_f32_32x32x32_bf16 v[128:143], v[108:111], v[48:55], v116
    v_exp_f32 v63, v63
    v_exp_f32 v64, v64
    v_exp_f32 v65, v65
    v_smfmac_f32_32x32x32_bf16 v[128:143], v[112:115], v[56:63], v116
    v_exp_f32 v66, v66
    v_exp_f32 v67, v67
    v_exp_f32 v68, v68
    v_mfma_f32_32x32x16_bf16 v[48:63], v[88:91], v[24:27], 0
    v_exp_f32 v69, v69
    v_exp_f32 v70, v70
    v_exp_f32 v71, v71
    v_exp_f32 v72, v72
    v_exp_f32 v73, v73
    v_exp_f32 v74, v74
    v_exp_f32 v75, v75
    v_exp_f32 v76, v76
    v_exp_f32 v77, v77
    v_exp_f32 v78, v78
    v_smfmac_f32_32x32x32_bf16 v[144:159], v[108:111], v[64:71], v116
    v_exp_f32 v79, v79
    v_exp_f32 v48, v48
    v_exp_f32 v49, v49
    v_smfmac_f32_32x32x32_bf16 v[144:159], v[112:115], v[72:79], v116
    v_exp_f32 v50, v50
    v_exp_f32 v51, v51
    v_exp_f32 v52, v52
    v_mfma_f32_32x32x16_bf16 v[64:79], v[88:91], v[28:31], 0
    v_exp_f32 v53, v53
    v_exp_f32 v54, v54
    v_exp_f32 v55, v55
    v_exp_f32 v56, v56
    v_exp_f32 v57, v57
    v_exp_f32 v58, v58
    v_exp_f32 v59, v59
    v_exp_f32 v60, v60
    v_exp_f32 v61, v61
    v_exp_f32 v62, v62
    v_smfmac_f32_32x32x32_bf16 v[160:175], v[108:111], v[48:55], v116
    v_exp_f32 v63, v63
    v_exp_f32 v64, v64
    v_exp_f32 v65, v65
    v_smfmac_f32_32x32x32_bf16 v[160:175], v[112:115], v[56:63], v116
    v_exp_f32 v66, v66
    v_exp_f32 v67, v67
    v_exp_f32 v68, v68
    v_mfma_f32_32x32x16_bf16 v[48:63], v[88:91], v[32:35], 0
    v_exp_f32 v69, v69
    v_exp_f32 v70, v70
    v_exp_f32 v71, v71
    v_exp_f32 v72, v72
    v_exp_f32 v73, v73
    v_exp_f32 v74, v74
    v_exp_f32 v75, v75
    v_exp_f32 v76, v76
    v_exp_f32 v77, v77
    v_exp_f32 v78, v78
    v_smfmac_f32_32x32x32_bf16 v[176:191], v[108:111], v[64:71], v116
    v_exp_f32 v79, v79
    v_exp_f32 v48, v48
    v_exp_f32 v49, v49
    v_smfmac_f32_32x32x32_bf16 v[176:191], v[112:115], v[72:79], v116
    v_exp_f32 v50, v50
    v_exp_f32 v51, v51
    v_exp_f32 v52, v52
    v_mfma_f32_32x32x16_bf16 v[64:79], v[88:91], v[36:39], 0
    v_exp_f32 v53, v53
    v_exp_f32 v54, v54
    v_exp_f32 v55, v55
    v_exp_f32 v56, v56
    v_exp_f32 v57, v57
    v_exp_f32 v58, v58
    v_exp_f32 v59, v59
    v_exp_f32 v60, v60
    v_exp_f32 v61, v61
    v_exp_f32 v62, v62
    v_smfmac_f32_32x32x32_bf16 v[192:207], v[108:111], v[48:55], v116
    v_exp_f32 v63, v63
    v_exp_f32 v64, v64
    v_exp_f32 v65, v65
    v_smfmac_f32_32x32x32_bf16 v[192:207], v[112:115], v[56:63], v116
    v_exp_f32 v66, v66
    v_exp_f32 v67, v67
    v_exp_f32 v68, v68
    v_mfma_f32_32x32x16_bf16 v[48:63], v[88:91], v[40:43], 0
    v_exp_f32 v69, v69
    v_exp_f32 v70, v70
    v_exp_f32 v71, v71
    v_exp_f32 v72, v72
    v_exp_f32 v73, v73
    v_exp_f32 v74, v74
    v_exp_f32 v75, v75
    v_exp_f32 v76, v76
    v_exp_f32 v77, v77
    v_exp_f32 v78, v78
    v_smfmac_f32_32x32x32_bf16 v[208:223], v[108:111], v[64:71], v116
    v_exp_f32 v79, v79
    v_exp_f32 v48, v48
    v_exp_f32 v49, v49
    v_smfmac_f32_32x32x32_bf16 v[208:223], v[112:115], v[72:79], v116
    v_exp_f32 v50, v50
    v_exp_f32 v51, v51
    v_exp_f32 v52, v52
    v_mfma_f32_32x32x16_bf16 v[64:79], v[88:91], v[44:47], 0
    v_exp_f32 v53, v53
    v_exp_f32 v54, v54
    v_exp_f32 v55, v55
    v_exp_f32 v56, v56
    v_exp_f32 v57, v57
    v_exp_f32 v58, v58
    v_exp_f32 v59, v59
    v_exp_f32 v60, v60
    v_exp_f32 v61, v61
    v_exp_f32 v62, v62
    v_smfmac_f32_32x32x32_bf16 v[224:239], v[108:111], v[48:55], v116
    v_exp_f32 v63, v63
    v_exp_f32 v64, v64
    v_exp_f32 v65, v65
    v_smfmac_f32_32x32x32_bf16 v[224:239], v[112:115], v[56:63], v116
    v_exp_f32 v66, v66
    v_exp_f32 v67, v67
    v_exp_f32 v68, v68
    s_waitcnt vmcnt(0)
    v_mfma_f32_32x32x16_bf16 v[48:63], v[80:83], v[16:19], 0
    v_exp_f32 v69, v69
    v_exp_f32 v70, v70
    v_exp_f32 v71, v71
    v_exp_f32 v72, v72
    v_exp_f32 v73, v73
    v_exp_f32 v74, v74
    v_exp_f32 v75, v75
    v_exp_f32 v76, v76
    v_exp_f32 v77, v77
    v_exp_f32 v78, v78
    v_smfmac_f32_32x32x32_bf16 v[240:255], v[108:111], v[64:71], v116
    v_exp_f32 v79, v79
L_att_x:
    v_exp_f32 v48, v48
    v_exp_f32 v49, v49
    v_smfmac_f32_32x32x32_bf16 v[240:255], v[112:115], v[72:79], v116
    v_exp_f32 v50, v50
    v_exp_f32 v51, v51
    v_exp_f32 v52, v52
    v_mfma_f32_32x32x16_bf16 v[64:79], v[80:83], v[20:23], 0
    v_exp_f32 v53, v53
    v_exp_f32 v54, v54
    v_exp_f32 v55, v55
    v_exp_f32 v56, v56
    v_exp_f32 v57, v57
    v_exp_f32 v58, v58
    v_exp_f32 v59, v59
    v_exp_f32 v60, v60
    v_exp_f32 v61, v61
    v_exp_f32 v62, v62
    v_smfmac_f32_32x32x32_bf16 v[128:143], v[92:95], v[48:55], v116
    v_exp_f32 v63, v63
    v_exp_f32 v64, v64
    v_exp_f32 v65, v65
    v_smfmac_f32_32x32x32_bf16 v[128:143], v[96:99], v[56:63], v116
    v_exp_f32 v66, v66
    v_exp_f32 v67, v67
    v_exp_f32 v68, v68
    v_mfma_f32_32x32x16_bf16 v[48:63], v[80:83], v[24:27], 0
    v_exp_f32 v69, v69
    v_exp_f32 v70, v70
    v_exp_f32 v71, v71
    v_exp_f32 v72, v72
    v_exp_f32 v73, v73
    v_exp_f32 v74, v74
    v_exp_f32 v75, v75
    v_exp_f32 v76, v76
    v_exp_f32 v77, v77
    v_exp_f32 v78, v78
    v_smfmac_f32_32x32x32_bf16 v[144:159], v[92:95], v[64:71], v116
    v_exp_f32 v79, v79
    v_exp_f32 v48, v48
    v_exp_f32 v49, v49
    v_smfmac_f32_32x32x32_bf16 v[144:159], v[96:99], v[72:79], v116
    v_exp_f32 v50, v50
    v_exp_f32 v51, v51
    v_exp_f32 v52, v52
    v_mfma_f32_32x32x16_bf16 v[64:79], v[80:83], v[28:31], 0
    v_exp_f32 v53, v53
    v_exp_f32 v54, v54
    v_exp_f32 v55, v55
    v_exp_f32 v56, v56
    v_exp_f32 v57, v57
    v_exp_f32 v58, v58
    v_exp_f32 v59, v59
    v_exp_f32 v60, v60
    v_exp_f32 v61, v61
    v_exp_f32 v62, v62
    v_smfmac_f32_32x32x32_bf16 v[160:175], v[92:95], v[48:55], v116
    v_exp_f32 v63, v63
    v_exp_f32 v64, v64
    v_exp_f32 v65, v65
    v_smfmac_f32_32x32x32_bf16 v[160:175], v[96:99], v[56:63], v116
    v_exp_f32 v66, v66
    v_exp_f32 v67, v67
    v_exp_f32 v68, v68
    v_mfma_f32_32x32x16_bf16 v[48:63], v[80:83], v[32:35], 0
    v_exp_f32 v69, v69
    v_exp_f32 v70, v70
    v_exp_f32 v71, v71
    v_exp_f32 v72, v72
    v_exp_f32 v73, v73
    v_exp_f32 v74, v74
    v_exp_f32 v75, v75
    v_exp_f32 v76, v76
    v_exp_f32 v77, v77
    v_exp_f32 v78, v78
    v_smfmac_f32_32x32x32_bf16 v[176:191], v[92:95], v[64:71], v116
    v_exp_f32 v79, v79
    ds_read_b64 v[6:7], v12 offset:8
    v_exp_f32 v48, v48
    v_exp_f32 v49, v49
    v_smfmac_f32_32x32x32_bf16 v[176:191], v[96:99], v[72:79], v116
    v_exp_f32 v50, v50
    v_exp_f32 v51, v51
    v_exp_f32 v52, v52
    v_mfma_f32_32x32x16_bf16 v[64:79], v[80:83], v[36:39], 0
    v_exp_f32 v53, v53
    v_exp_f32 v54, v54
    v_exp_f32 v55, v55
    v_exp_f32 v56, v56
    v_exp_f32 v57, v57
    v_exp_f32 v58, v58
    v_exp_f32 v59, v59
    v_exp_f32 v60, v60
    v_exp_f32 v61, v61
    v_exp_f32 v62, v62
    v_smfmac_f32_32x32x32_bf16 v[192:207], v[92:95], v[48:55], v116
    v_exp_f32 v63, v63
    s_waitcnt lgkmcnt(0)
    v_readfirstlane_b32 s55, v6
    v_readfirstlane_b32 s101, v7
    s_mov_b32 s54, 1048576
    s_cmp_ge_u32 s55, 4
    s_cbranch_scc1 L_gd_7
L_gw_6:
    s_sleep 1
    ds_read_b64 v[6:7], v12 offset:8
    s_waitcnt lgkmcnt(0)
    v_readfirstlane_b32 s55, v6
    v_readfirstlane_b32 s101, v7
    s_sub_u32 s54, s54, 1
    s_cselect_b32 s55, 4, s55
    s_cmp_lt_u32 s55, 4
    s_cbranch_scc1 L_gw_6
L_gd_7:
    v_exp_f32 v64, v64
    v_exp_f32 v65, v65
    v_smfmac_f32_32x32x32_bf16 v[192:207], v[96:99], v[56:63], v116
    v_exp_f32 v66, v66
    ds_write_b128 v118, v[128:131] offset:0
    v_exp_f32 v67, v67
    v_exp_f32 v68, v68
    v_mfma_f32_32x32x16_bf16 v[48:63], v[80:83], v[40:43], 0
    v_exp_f32 v69, v69
    ds_write_b128 v118, v[132:135] offset:1024
    v_exp_f32 v70, v70
    v_exp_f32 v71, v71
    ds_write_b128 v118, v[144:147] offset:2048
    v_exp_f32 v72, v72
    v_exp_f32 v73, v73
    ds_write_b128 v118, v[148:151] offset:3072
    v_exp_f32 v74, v74
    v_exp_f32 v75, v75
    ds_write2st64_b32 v121, v136, v152 offset1:1
    v_exp_f32 v76, v76
    v_exp_f32 v77, v77
    v_exp_f32 v78, v78
    v_smfmac_f32_32x32x32_bf16 v[208:223], v[92:95], v[64:71], v116
    v_exp_f32 v79, v79
    v_exp_f32 v48, v48
    v_exp_f32 v49, v49
    v_smfmac_f32_32x32x32_bf16 v[208:223], v[96:99], v[72:79], v116
    v_exp_f32 v50, v50
    ds_write_b128 v119, v[160:163] offset:0
    v_exp_f32 v51, v51
    v_exp_f32 v52, v52
    v_mfma_f32_32x32x16_bf16 v[64:79], v[80:83], v[44:47], 0
    v_exp_f32 v53, v53
    ds_write_b128 v119, v[164:167] offset:1024
    v_exp_f32 v54, v54
    v_exp_f32 v55, v55
    ds_write_b128 v119, v[176:179] offset:2048
    v_exp_f32 v56, v56
    v_exp_f32 v57, v57
    ds_write_b128 v119, v[180:183] offset:3072
    v_exp_f32 v58, v58
    v_exp_f32 v59, v59
    ds_write2st64_b32 v122, v168, v184 offset1:1
    v_exp_f32 v60, v60
    v_exp_f32 v61, v61
    v_exp_f32 v62, v62
    v_smfmac_f32_32x32x32_bf16 v[224:239], v[92:95], v[48:55], v116
    v_exp_f32 v63, v63
    v_exp_f32 v64, v64
    v_exp_f32 v65, v65
    v_smfmac_f32_32x32x32_bf16 v[224:239], v[96:99], v[56:63], v116
    v_exp_f32 v66, v66
    ds_write_b128 v120, v[192:195] offset:0
    v_exp_f32 v67, v67
    v_exp_f32 v68, v68
    v_exp_f32 v69, v69
    ds_write_b128 v120, v[196:199] offset:1024
    v_exp_f32 v70, v70
    v_exp_f32 v71, v71
    ds_write_b128 v120, v[208:211] offset:2048
    v_exp_f32 v72, v72
    v_exp_f32 v73, v73
    ds_write_b128 v120, v[212:215] offset:3072
    v_exp_f32 v74, v74
    v_exp_f32 v75, v75
    ds_write2st64_b32 v123, v200, v216 offset1:1
    v_exp_f32 v76, v76
    v_exp_f32 v77, v77
    v_exp_f32 v78, v78
    v_smfmac_f32_32x32x32_bf16 v[240:255], v[92:95], v[64:71], v116
    v_exp_f32 v79, v79
    s_nop 1
    v_smfmac_f32_32x32x32_bf16 v[240:255], v[96:99], v[72:79], v116
    s_mul_i32 s3, s53, 13824
    s_add_u32 s3, s3, 0
    v_add_u32 v3, s3, v2
    s_add_u32 s3, s3, 4096
    v_lshl_add_u32 v4, v1, 2, s3
    s_lshl_b32 s56, s45, 16
    s_lshl_b32 s3, s46, 2
    s_add_u32 s59, s3, s53
    s_lshl_b32 s3, s59, 11
    s_add_u32 s56, s56, s3
    s_add_u32 s56, s56, 262144
    s_mov_b32 s57, 0
L_att_join:
    s_waitcnt lgkmcnt(0)
    s_barrier
    ds_read_b32 v6, v12 offset:24
    ds_read_b128 v[48:51], v3 offset:0
    ds_read_b128 v[52:55], v3 offset:1024
    ds_read_b128 v[56:59], v3 offset:2048
    ds_read_b128 v[60:63], v3 offset:3072
    ds_read2st64_b32 v[64:65], v4 offset0:0 offset1:1
    ds_read_b128 v[66:69], v3 offset:4608
    ds_read_b128 v[70:73], v3 offset:5632
    ds_read_b128 v[74:77], v3 offset:6656
    ds_read_b128 v[78:81], v3 offset:7680
    ds_read2st64_b32 v[82:83], v4 offset0:18 offset1:19
    s_waitcnt lgkmcnt(10)
    v_readfirstlane_b32 s3, v6
    s_cmp_gt_u32 s3, s57
    s_cbranch_scc1 L_slow
    ds_read_b128 v[128:131], v3 offset:9216
    ds_read_b128 v[132:135], v3 offset:10240
    ds_read_b128 v[136:139], v3 offset:11264
    ds_read_b128 v[140:143], v3 offset:12288
    ds_read2st64_b32 v[144:145], v4 offset0:36 offset1:37
    s_waitcnt lgkmcnt(10)
    v_add_f32 v232, v232, v64
    v_add_f32 v248, v248, v65
    v_pk_add_f32 v[224:225], v[224:225], v[48:49]
    v_pk_add_f32 v[226:227], v[226:227], v[50:51]
    v_pk_add_f32 v[228:229], v[228:229], v[52:53]
    v_pk_add_f32 v[230:231], v[230:231], v[54:55]
    v_pk_add_f32 v[240:241], v[240:241], v[56:57]
    v_pk_add_f32 v[242:243], v[242:243], v[58:59]
    v_pk_add_f32 v[244:245], v[244:245], v[60:61]
    v_pk_add_f32 v[246:247], v[246:247], v[62:63]
    s_waitcnt lgkmcnt(5)
    v_add_f32 v232, v232, v82
    v_add_f32 v248, v248, v83
    v_pk_add_f32 v[224:225], v[224:225], v[66:67]
    v_pk_add_f32 v[226:227], v[226:227], v[68:69]
    v_pk_add_f32 v[228:229], v[228:229], v[70:71]
    v_pk_add_f32 v[230:231], v[230:231], v[72:73]
    v_pk_add_f32 v[240:241], v[240:241], v[74:75]
    v_pk_add_f32 v[242:243], v[242:243], v[76:77]
    v_pk_add_f32 v[244:245], v[244:245], v[78:79]
    v_pk_add_f32 v[246:247], v[246:247], v[80:81]
    s_waitcnt lgkmcnt(0)
    v_add_f32 v232, v232, v144
    v_add_f32 v248, v248, v145
    v_rcp_f32 v8, v232
    v_rcp_f32 v10, v248
    v_pk_add_f32 v[224:225], v[224:225], v[128:129]
    v_pk_add_f32 v[226:227], v[226:227], v[130:131]
    v_pk_add_f32 v[228:229], v[228:229], v[132:133]
    v_pk_add_f32 v[230:231], v[230:231], v[134:135]
    v_pk_add_f32 v[240:241], v[240:241], v[136:137]
    v_pk_add_f32 v[242:243], v[242:243], v[138:139]
    v_pk_add_f32 v[244:245], v[244:245], v[140:141]
    v_pk_add_f32 v[246:247], v[246:247], v[142:143]
    v_pk_mul_f32 v[224:225], v[224:225], v[8:9] op_sel_hi:[1,0]
    v_pk_mul_f32 v[226:227], v[226:227], v[8:9] op_sel_hi:[1,0]
    v_pk_mul_f32 v[228:229], v[228:229], v[8:9] op_sel_hi:[1,0]
    v_pk_mul_f32 v[230:231], v[230:231], v[8:9] op_sel_hi:[1,0]
    v_cvt_pk_bf16_f32 v96, v224, v225
    v_cvt_pk_bf16_f32 v97, v226, v227
    v_cvt_pk_bf16_f32 v98, v228, v229
    v_cvt_pk_bf16_f32 v99, v230, v231
    s_cmp_lg_u32 s101, 0
    s_cbranch_scc0 L_ds_8
    buffer_store_dwordx4 v[96:99], v2, s[8:11], s56 offen offset:0
L_de_9:
    v_pk_mul_f32 v[240:241], v[240:241], v[10:11] op_sel_hi:[1,0]
    v_pk_mul_f32 v[242:243], v[242:243], v[10:11] op_sel_hi:[1,0]
    v_pk_mul_f32 v[244:245], v[244:245], v[10:11] op_sel_hi:[1,0]
    v_pk_mul_f32 v[246:247], v[246:247], v[10:11] op_sel_hi:[1,0]
    v_cvt_pk_bf16_f32 v100, v240, v241
    v_cvt_pk_bf16_f32 v101, v242, v243
    v_cvt_pk_bf16_f32 v102, v244, v245
    v_cvt_pk_bf16_f32 v103, v246, v247
    s_cmp_lg_u32 s101, 0
    s_cbranch_scc0 L_ds_10
    buffer_store_dwordx4 v[100:103], v2, s[8:11], s56 offen offset:1024
L_de_11:
    s_lshl_b32 s56, s45, 7
    s_lshl_b32 s59, s59, 2
    s_add_u32 s56, s56, s59
    s_add_u32 s56, s56, 12288
    v_mov_b32 v6, s47
    v_mov_b32 v7, 0
    s_waitcnt vmcnt(0)
    s_mov_b64 exec, 1
    s_cmp_lg_u32 s101, 0
    s_cbranch_scc0 L_ds_12
    buffer_store_dword v6, v7, s[8:11], s56 offen
L_de_13:
    s_or_b32 s3, s2, s44
    s_cmp_lg_u32 s3, 0
    s_cbranch_scc1 L_noE
    buffer_store_dword v6, v7, s[8:11], 0 offen sc1
L_noE:
    s_mov_b64 exec, -1
    s_branch L_finish
L_slow:
    s_waitcnt lgkmcnt(0)
    v_mov_b32 v128, 0
    v_mov_b32 v129, 0
    v_mov_b32 v130, 0
    v_mov_b32 v131, 0
    v_mov_b32 v132, 0
    v_mov_b32 v133, 0
    v_mov_b32 v134, 0
    v_mov_b32 v135, 0
    v_mov_b32 v136, 0
    v_mov_b32 v137, 0
    v_mov_b32 v138, 0
    v_mov_b32 v139, 0
    v_mov_b32 v140, 0
    v_mov_b32 v141, 0
    v_mov_b32 v142, 0
    v_mov_b32 v143, 0
    v_mov_b32 v144, 0
    v_mov_b32 v145, 0
    v_mov_b32 v146, 0
    v_mov_b32 v147, 0
    v_mov_b32 v148, 0
    v_mov_b32 v149, 0
    v_mov_b32 v150, 0
    v_mov_b32 v151, 0
    v_mov_b32 v152, 0
    v_mov_b32 v153, 0
    v_mov_b32 v154, 0
    v_mov_b32 v155, 0
    v_mov_b32 v156, 0
    v_mov_b32 v157, 0
    v_mov_b32 v158, 0
    v_mov_b32 v159, 0
    v_mov_b32 v160, 0
    v_mov_b32 v161, 0
    v_mov_b32 v162, 0
    v_mov_b32 v163, 0
    v_mov_b32 v164, 0
    v_mov_b32 v165, 0
    v_mov_b32 v166, 0
    v_mov_b32 v167, 0
    v_mov_b32 v168, 0
    v_mov_b32 v169, 0
    v_mov_b32 v170, 0
    v_mov_b32 v171, 0
    v_mov_b32 v172, 0
    v_mov_b32 v173, 0
    v_mov_b32 v174, 0
    v_mov_b32 v175, 0
    v_mov_b32 v176, 0
    v_mov_b32 v177, 0
    v_mov_b32 v178, 0
    v_mov_b32 v179, 0
    v_mov_b32 v180, 0
    v_mov_b32 v181, 0
    v_mov_b32 v182, 0
    v_mov_b32 v183, 0
    v_mov_b32 v184, 0
    v_mov_b32 v185, 0
    v_mov_b32 v186, 0
    v_mov_b32 v187, 0
    v_mov_b32 v188, 0
    v_mov_b32 v189, 0
    v_mov_b32 v190, 0
    v_mov_b32 v191, 0
    v_mov_b32 v192, 0
    v_mov_b32 v193, 0
    v_mov_b32 v194, 0
    v_mov_b32 v195, 0
    v_mov_b32 v196, 0
    v_mov_b32 v197, 0
    v_mov_b32 v198, 0
    v_mov_b32 v199, 0
    v_mov_b32 v200, 0
    v_mov_b32 v201, 0
    v_mov_b32 v202, 0
    v_mov_b32 v203, 0
    v_mov_b32 v204, 0
    v_mov_b32 v205, 0
    v_mov_b32 v206, 0
    v_mov_b32 v207, 0
    v_mov_b32 v208, 0
    v_mov_b32 v209, 0
    v_mov_b32 v210, 0
    v_mov_b32 v211, 0
    v_mov_b32 v212, 0
    v_mov_b32 v213, 0
    v_mov_b32 v214, 0
    v_mov_b32 v215, 0
    v_mov_b32 v216, 0
    v_mov_b32 v217, 0
    v_mov_b32 v218, 0
    v_mov_b32 v219, 0
    v_mov_b32 v220, 0
    v_mov_b32 v221, 0
    v_mov_b32 v222, 0
    v_mov_b32 v223, 0
    v_mov_b32 v224, 0
    v_mov_b32 v225, 0
    v_mov_b32 v226, 0
    v_mov_b32 v227, 0
    v_mov_b32 v228, 0
    v_mov_b32 v229, 0
    v_mov_b32 v230, 0
    v_mov_b32 v231, 0
    v_mov_b32 v232, 0
    v_mov_b32 v233, 0
    v_mov_b32 v234, 0
    v_mov_b32 v235, 0
    v_mov_b32 v236, 0
    v_mov_b32 v237, 0
    v_mov_b32 v238, 0
    v_mov_b32 v239, 0
    v_mov_b32 v240, 0
    v_mov_b32 v241, 0
    v_mov_b32 v242, 0
    v_mov_b32 v243, 0
    v_mov_b32 v244, 0
    v_mov_b32 v245, 0
    v_mov_b32 v246, 0
    v_mov_b32 v247, 0
    v_mov_b32 v248, 0
    v_mov_b32 v249, 0
    v_mov_b32 v250, 0
    v_mov_b32 v251, 0
    v_mov_b32 v252, 0
    v_mov_b32 v253, 0
    v_mov_b32 v254, 0
    v_mov_b32 v255, 0
    v_mov_b32 v108, 0xff800000
    v_mov_b32 v109, 0xff800000
    v_mov_b32 v110, 0xff800000
    v_mov_b32 v111, 0xff800000
    v_mov_b32 v112, 0xff800000
    v_mov_b32 v113, 0xff800000
    v_mov_b32 v114, 0xff800000
    v_mov_b32 v115, 0xff800000
    s_mov_b32 s58, 0
L_slow_max:
    buffer_load_dwordx4 v[84:87], v11, s[8:11], s58 offen sc1
    s_waitcnt vmcnt(0)
    v_mfma_f32_32x32x16_bf16 v[48:63], v[84:87], v[16:19], 0
    v_mfma_f32_32x32x16_bf16 v[64:79], v[84:87], v[20:23], 0
    s_nop 10
    v_max3_f32 v108, v48, v49, v108
    v_max3_f32 v108, v50, v51, v108
    v_max3_f32 v108, v52, v53, v108
    v_max3_f32 v108, v54, v55, v108
    v_max3_f32 v108, v56, v57, v108
    v_max3_f32 v108, v58, v59, v108
    v_max3_f32 v108, v60, v61, v108
    v_max3_f32 v108, v62, v63, v108
    v_mfma_f32_32x32x16_bf16 v[48:63], v[84:87], v[24:27], 0
    v_max3_f32 v109, v64, v65, v109
    v_max3_f32 v109, v66, v67, v109
    v_max3_f32 v109, v68, v69, v109
    v_max3_f32 v109, v70, v71, v109
    v_max3_f32 v109, v72, v73, v109
    v_max3_f32 v109, v74, v75, v109
    v_max3_f32 v109, v76, v77, v109
    v_max3_f32 v109, v78, v79, v109
    v_mfma_f32_32x32x16_bf16 v[64:79], v[84:87], v[28:31], 0
    s_nop 2
    v_max3_f32 v110, v48, v49, v110
    v_max3_f32 v110, v50, v51, v110
    v_max3_f32 v110, v52, v53, v110
    v_max3_f32 v110, v54, v55, v110
    v_max3_f32 v110, v56, v57, v110
    v_max3_f32 v110, v58, v59, v110
    v_max3_f32 v110, v60, v61, v110
    v_max3_f32 v110, v62, v63, v110
    v_mfma_f32_32x32x16_bf16 v[48:63], v[84:87], v[32:35], 0
    v_max3_f32 v111, v64, v65, v111
    v_max3_f32 v111, v66, v67, v111
    v_max3_f32 v111, v68, v69, v111
    v_max3_f32 v111, v70, v71, v111
    v_max3_f32 v111, v72, v73, v111
    v_max3_f32 v111, v74, v75, v111
    v_max3_f32 v111, v76, v77, v111
    v_max3_f32 v111, v78, v79, v111
    v_mfma_f32_32x32x16_bf16 v[64:79], v[84:87], v[36:39], 0
    s_nop 2
    v_max3_f32 v112, v48, v49, v112
    v_max3_f32 v112, v50, v51, v112
    v_max3_f32 v112, v52, v53, v112
    v_max3_f32 v112, v54, v55, v112
    v_max3_f32 v112, v56, v57, v112
    v_max3_f32 v112, v58, v59, v112
    v_max3_f32 v112, v60, v61, v112
    v_max3_f32 v112, v62, v63, v112
    v_mfma_f32_32x32x16_bf16 v[48:63], v[84:87], v[40:43], 0
    v_max3_f32 v113, v64, v65, v113
    v_max3_f32 v113, v66, v67, v113
    v_max3_f32 v113, v68, v69, v113
    v_max3_f32 v113, v70, v71, v113
    v_max3_f32 v113, v72, v73, v113
    v_max3_f32 v113, v74, v75, v113
    v_max3_f32 v113, v76, v77, v113
    v_max3_f32 v113, v78, v79, v113
    v_mfma_f32_32x32x16_bf16 v[64:79], v[84:87], v[44:47], 0
    s_nop 2
    v_max3_f32 v114, v48, v49, v114
    v_max3_f32 v114, v50, v51, v114
    v_max3_f32 v114, v52, v53, v114
    v_max3_f32 v114, v54, v55, v114
    v_max3_f32 v114, v56, v57, v114
    v_max3_f32 v114, v58, v59, v114
    v_max3_f32 v114, v60, v61, v114
    v_max3_f32 v114, v62, v63, v114
    s_nop 0
    v_max3_f32 v115, v64, v65, v115
    v_max3_f32 v115, v66, v67, v115
    v_max3_f32 v115, v68, v69, v115
    v_max3_f32 v115, v70, v71, v115
    v_max3_f32 v115, v72, v73, v115
    v_max3_f32 v115, v74, v75, v115
    v_max3_f32 v115, v76, v77, v115
    v_max3_f32 v115, v78, v79, v115
    s_add_u32 s58, s58, 2048
    s_cmp_lt_u32 s58, 32768
    s_cbranch_scc1 L_slow_max
    v_mov_b32 v6, v108
    s_nop 1
    v_permlane32_swap_b32 v6, v108
    v_max_f32 v108, v6, v108
    v_mov_b32 v6, v109
    s_nop 1
    v_permlane32_swap_b32 v6, v109
    v_max_f32 v109, v6, v109
    v_mov_b32 v6, v110
    s_nop 1
    v_permlane32_swap_b32 v6, v110
    v_max_f32 v110, v6, v110
    v_mov_b32 v6, v111
    s_nop 1
    v_permlane32_swap_b32 v6, v111
    v_max_f32 v111, v6, v111
    v_mov_b32 v6, v112
    s_nop 1
    v_permlane32_swap_b32 v6, v112
    v_max_f32 v112, v6, v112
    v_mov_b32 v6, v113
    s_nop 1
    v_permlane32_swap_b32 v6, v113
    v_max_f32 v113, v6, v113
    v_mov_b32 v6, v114
    s_nop 1
    v_permlane32_swap_b32 v6, v114
    v_max_f32 v114, v6, v114
    v_mov_b32 v6, v115
    s_nop 1
    v_permlane32_swap_b32 v6, v115
    v_max_f32 v115, v6, v115
    s_lshl_b32 s58, s53, 11
    s_add_u32 s3, s53, 1
    s_and_b32 s3, s3, 3
    s_lshl_b32 s3, s3, 9
    s_add_u32 s3, s3, 148480
    v_lshl_add_u32 v48, v1, 2, s3
    v_add_u32 v6, s58, v48
    ds_write2st64_b32 v6, v108, v109 offset1:1
    s_add_u32 s3, s53, 2
    s_and_b32 s3, s3, 3
    s_lshl_b32 s3, s3, 9
    s_add_u32 s3, s3, 148480
    v_lshl_add_u32 v49, v1, 2, s3
    v_add_u32 v6, s58, v49
    ds_write2st64_b32 v6, v110, v111 offset1:1
    s_add_u32 s3, s53, 3
    s_and_b32 s3, s3, 3
    s_lshl_b32 s3, s3, 9
    s_add_u32 s3, s3, 148480
    v_lshl_add_u32 v50, v1, 2, s3
    v_add_u32 v6, s58, v50
    ds_write2st64_b32 v6, v112, v113 offset1:1
    s_add_u32 s3, s53, 4
    s_and_b32 s3, s3, 3
    s_lshl_b32 s3, s3, 9
    s_add_u32 s3, s3, 148480
    v_lshl_add_u32 v51, v1, 2, s3
    v_add_u32 v6, s58, v51
    ds_write2st64_b32 v6, v114, v115 offset1:1
    s_waitcnt lgkmcnt(0)
    s_barrier
    ds_read2st64_b32 v[64:65], v48 offset0:0 offset1:1
    ds_read2st64_b32 v[66:67], v48 offset0:8 offset1:9
    ds_read2st64_b32 v[68:69], v48 offset0:16 offset1:17
    ds_read2st64_b32 v[70:71], v48 offset0:24 offset1:25
    s_waitcnt lgkmcnt(0)
    v_max3_f32 v108, v64, v66, v68
    v_max_f32 v108, v108, v70
    v_max3_f32 v109, v65, v67, v69
    v_max_f32 v109, v109, v71
    ds_read2st64_b32 v[64:65], v49 offset0:0 offset1:1
    ds_read2st64_b32 v[66:67], v49 offset0:8 offset1:9
    ds_read2st64_b32 v[68:69], v49 offset0:16 offset1:17
    ds_read2st64_b32 v[70:71], v49 offset0:24 offset1:25
    s_waitcnt lgkmcnt(0)
    v_max3_f32 v110, v64, v66, v68
    v_max_f32 v110, v110, v70
    v_max3_f32 v111, v65, v67, v69
    v_max_f32 v111, v111, v71
    ds_read2st64_b32 v[64:65], v50 offset0:0 offset1:1
    ds_read2st64_b32 v[66:67], v50 offset0:8 offset1:9
    ds_read2st64_b32 v[68:69], v50 offset0:16 offset1:17
    ds_read2st64_b32 v[70:71], v50 offset0:24 offset1:25
    s_waitcnt lgkmcnt(0)
    v_max3_f32 v112, v64, v66, v68
    v_max_f32 v112, v112, v70
    v_max3_f32 v113, v65, v67, v69
    v_max_f32 v113, v113, v71
    ds_read2st64_b32 v[64:65], v51 offset0:0 offset1:1
    ds_read2st64_b32 v[66:67], v51 offset0:8 offset1:9
    ds_read2st64_b32 v[68:69], v51 offset0:16 offset1:17
    ds_read2st64_b32 v[70:71], v51 offset0:24 offset1:25
    s_waitcnt lgkmcnt(0)
    v_max3_f32 v114, v64, v66, v68
    v_max_f32 v114, v114, v70
    v_max3_f32 v115, v65, v67, v69
    v_max_f32 v115, v115, v71
    s_mov_b32 s57, 0
    s_mov_b32 s58, 32768
L_slow_pv:
    buffer_load_dwordx4 v[80:83], v11, s[8:11], s57 offen sc1
    s_mov_b64 exec, s[68:69]
    buffer_load_dwordx4 v[92:95], v117, s[8:11], s57 offen sc1
    buffer_load_dwordx4 v[96:99], v117, s[8:11], s57 offen offset:512 sc1
    s_mov_b64 exec, -1
    s_waitcnt vmcnt(0)
    v_mfma_f32_32x32x16_bf16 v[48:63], v[80:83], v[16:19], 0
    s_nop 11
    v_sub_f32 v48, v48, v108
    v_sub_f32 v49, v49, v108
    v_sub_f32 v50, v50, v108
    v_sub_f32 v51, v51, v108
    v_sub_f32 v52, v52, v108
    v_sub_f32 v53, v53, v108
    v_sub_f32 v54, v54, v108
    v_sub_f32 v55, v55, v108
    v_sub_f32 v56, v56, v108
    v_sub_f32 v57, v57, v108
    v_sub_f32 v58, v58, v108
    v_sub_f32 v59, v59, v108
    v_sub_f32 v60, v60, v108
    v_sub_f32 v61, v61, v108
    v_sub_f32 v62, v62, v108
    v_sub_f32 v63, v63, v108
    v_exp_f32 v48, v48
    v_exp_f32 v49, v49
    v_exp_f32 v50, v50
    v_exp_f32 v51, v51
    v_exp_f32 v52, v52
    v_exp_f32 v53, v53
    v_exp_f32 v54, v54
    v_exp_f32 v55, v55
    v_exp_f32 v56, v56
    v_exp_f32 v57, v57
    v_exp_f32 v58, v58
    v_exp_f32 v59, v59
    v_exp_f32 v60, v60
    v_exp_f32 v61, v61
    v_exp_f32 v62, v62
    v_exp_f32 v63, v63
    v_smfmac_f32_32x32x32_bf16 v[128:143], v[92:95], v[48:55], v116
    s_nop 0
    v_smfmac_f32_32x32x32_bf16 v[128:143], v[96:99], v[56:63], v116
    v_mfma_f32_32x32x16_bf16 v[48:63], v[80:83], v[20:23], 0
    s_nop 11
    v_sub_f32 v48, v48, v109
    v_sub_f32 v49, v49, v109
    v_sub_f32 v50, v50, v109
    v_sub_f32 v51, v51, v109
    v_sub_f32 v52, v52, v109
    v_sub_f32 v53, v53, v109
    v_sub_f32 v54, v54, v109
    v_sub_f32 v55, v55, v109
    v_sub_f32 v56, v56, v109
    v_sub_f32 v57, v57, v109
    v_sub_f32 v58, v58, v109
    v_sub_f32 v59, v59, v109
    v_sub_f32 v60, v60, v109
    v_sub_f32 v61, v61, v109
    v_sub_f32 v62, v62, v109
    v_sub_f32 v63, v63, v109
    v_exp_f32 v48, v48
    v_exp_f32 v49, v49
    v_exp_f32 v50, v50
    v_exp_f32 v51, v51
    v_exp_f32 v52, v52
    v_exp_f32 v53, v53
    v_exp_f32 v54, v54
    v_exp_f32 v55, v55
    v_exp_f32 v56, v56
    v_exp_f32 v57, v57
    v_exp_f32 v58, v58
    v_exp_f32 v59, v59
    v_exp_f32 v60, v60
    v_exp_f32 v61, v61
    v_exp_f32 v62, v62
    v_exp_f32 v63, v63
    v_smfmac_f32_32x32x32_bf16 v[144:159], v[92:95], v[48:55], v116
    s_nop 0
    v_smfmac_f32_32x32x32_bf16 v[144:159], v[96:99], v[56:63], v116
    v_mfma_f32_32x32x16_bf16 v[48:63], v[80:83], v[24:27], 0
    s_nop 11
    v_sub_f32 v48, v48, v110
    v_sub_f32 v49, v49, v110
    v_sub_f32 v50, v50, v110
    v_sub_f32 v51, v51, v110
    v_sub_f32 v52, v52, v110
    v_sub_f32 v53, v53, v110
    v_sub_f32 v54, v54, v110
    v_sub_f32 v55, v55, v110
    v_sub_f32 v56, v56, v110
    v_sub_f32 v57, v57, v110
    v_sub_f32 v58, v58, v110
    v_sub_f32 v59, v59, v110
    v_sub_f32 v60, v60, v110
    v_sub_f32 v61, v61, v110
    v_sub_f32 v62, v62, v110
    v_sub_f32 v63, v63, v110
    v_exp_f32 v48, v48
    v_exp_f32 v49, v49
    v_exp_f32 v50, v50
    v_exp_f32 v51, v51
    v_exp_f32 v52, v52
    v_exp_f32 v53, v53
    v_exp_f32 v54, v54
    v_exp_f32 v55, v55
    v_exp_f32 v56, v56
    v_exp_f32 v57, v57
    v_exp_f32 v58, v58
    v_exp_f32 v59, v59
    v_exp_f32 v60, v60
    v_exp_f32 v61, v61
    v_exp_f32 v62, v62
    v_exp_f32 v63, v63
    v_smfmac_f32_32x32x32_bf16 v[160:175], v[92:95], v[48:55], v116
    s_nop 0
    v_smfmac_f32_32x32x32_bf16 v[160:175], v[96:99], v[56:63], v116
    v_mfma_f32_32x32x16_bf16 v[48:63], v[80:83], v[28:31], 0
    s_nop 11
    v_sub_f32 v48, v48, v111
    v_sub_f32 v49, v49, v111
    v_sub_f32 v50, v50, v111
    v_sub_f32 v51, v51, v111
    v_sub_f32 v52, v52, v111
    v_sub_f32 v53, v53, v111
    v_sub_f32 v54, v54, v111
    v_sub_f32 v55, v55, v111
    v_sub_f32 v56, v56, v111
    v_sub_f32 v57, v57, v111
    v_sub_f32 v58, v58, v111
    v_sub_f32 v59, v59, v111
    v_sub_f32 v60, v60, v111
    v_sub_f32 v61, v61, v111
    v_sub_f32 v62, v62, v111
    v_sub_f32 v63, v63, v111
    v_exp_f32 v48, v48
    v_exp_f32 v49, v49
    v_exp_f32 v50, v50
    v_exp_f32 v51, v51
    v_exp_f32 v52, v52
    v_exp_f32 v53, v53
    v_exp_f32 v54, v54
    v_exp_f32 v55, v55
    v_exp_f32 v56, v56
    v_exp_f32 v57, v57
    v_exp_f32 v58, v58
    v_exp_f32 v59, v59
    v_exp_f32 v60, v60
    v_exp_f32 v61, v61
    v_exp_f32 v62, v62
    v_exp_f32 v63, v63
    v_smfmac_f32_32x32x32_bf16 v[176:191], v[92:95], v[48:55], v116
    s_nop 0
    v_smfmac_f32_32x32x32_bf16 v[176:191], v[96:99], v[56:63], v116
    v_mfma_f32_32x32x16_bf16 v[48:63], v[80:83], v[32:35], 0
    s_nop 11
    v_sub_f32 v48, v48, v112
    v_sub_f32 v49, v49, v112
    v_sub_f32 v50, v50, v112
    v_sub_f32 v51, v51, v112
    v_sub_f32 v52, v52, v112
    v_sub_f32 v53, v53, v112
    v_sub_f32 v54, v54, v112
    v_sub_f32 v55, v55, v112
    v_sub_f32 v56, v56, v112
    v_sub_f32 v57, v57, v112
    v_sub_f32 v58, v58, v112
    v_sub_f32 v59, v59, v112
    v_sub_f32 v60, v60, v112
    v_sub_f32 v61, v61, v112
    v_sub_f32 v62, v62, v112
    v_sub_f32 v63, v63, v112
    v_exp_f32 v48, v48
    v_exp_f32 v49, v49
    v_exp_f32 v50, v50
    v_exp_f32 v51, v51
    v_exp_f32 v52, v52
    v_exp_f32 v53, v53
    v_exp_f32 v54, v54
    v_exp_f32 v55, v55
    v_exp_f32 v56, v56
    v_exp_f32 v57, v57
    v_exp_f32 v58, v58
    v_exp_f32 v59, v59
    v_exp_f32 v60, v60
    v_exp_f32 v61, v61
    v_exp_f32 v62, v62
    v_exp_f32 v63, v63
    v_smfmac_f32_32x32x32_bf16 v[192:207], v[92:95], v[48:55], v116
    s_nop 0
    v_smfmac_f32_32x32x32_bf16 v[192:207], v[96:99], v[56:63], v116
    v_mfma_f32_32x32x16_bf16 v[48:63], v[80:83], v[36:39], 0
    s_nop 11
    v_sub_f32 v48, v48, v113
    v_sub_f32 v49, v49, v113
    v_sub_f32 v50, v50, v113
    v_sub_f32 v51, v51, v113
    v_sub_f32 v52, v52, v113
    v_sub_f32 v53, v53, v113
    v_sub_f32 v54, v54, v113
    v_sub_f32 v55, v55, v113
    v_sub_f32 v56, v56, v113
    v_sub_f32 v57, v57, v113
    v_sub_f32 v58, v58, v113
    v_sub_f32 v59, v59, v113
    v_sub_f32 v60, v60, v113
    v_sub_f32 v61, v61, v113
    v_sub_f32 v62, v62, v113
    v_sub_f32 v63, v63, v113
    v_exp_f32 v48, v48
    v_exp_f32 v49, v49
    v_exp_f32 v50, v50
    v_exp_f32 v51, v51
    v_exp_f32 v52, v52
    v_exp_f32 v53, v53
    v_exp_f32 v54, v54
    v_exp_f32 v55, v55
    v_exp_f32 v56, v56
    v_exp_f32 v57, v57
    v_exp_f32 v58, v58
    v_exp_f32 v59, v59
    v_exp_f32 v60, v60
    v_exp_f32 v61, v61
    v_exp_f32 v62, v62
    v_exp_f32 v63, v63
    v_smfmac_f32_32x32x32_bf16 v[208:223], v[92:95], v[48:55], v116
    s_nop 0
    v_smfmac_f32_32x32x32_bf16 v[208:223], v[96:99], v[56:63], v116
    v_mfma_f32_32x32x16_bf16 v[48:63], v[80:83], v[40:43], 0
    s_nop 11
    v_sub_f32 v48, v48, v114
    v_sub_f32 v49, v49, v114
    v_sub_f32 v50, v50, v114
    v_sub_f32 v51, v51, v114
    v_sub_f32 v52, v52, v114
    v_sub_f32 v53, v53, v114
    v_sub_f32 v54, v54, v114
    v_sub_f32 v55, v55, v114
    v_sub_f32 v56, v56, v114
    v_sub_f32 v57, v57, v114
    v_sub_f32 v58, v58, v114
    v_sub_f32 v59, v59, v114
    v_sub_f32 v60, v60, v114
    v_sub_f32 v61, v61, v114
    v_sub_f32 v62, v62, v114
    v_sub_f32 v63, v63, v114
    v_exp_f32 v48, v48
    v_exp_f32 v49, v49
    v_exp_f32 v50, v50
    v_exp_f32 v51, v51
    v_exp_f32 v52, v52
    v_exp_f32 v53, v53
    v_exp_f32 v54, v54
    v_exp_f32 v55, v55
    v_exp_f32 v56, v56
    v_exp_f32 v57, v57
    v_exp_f32 v58, v58
    v_exp_f32 v59, v59
    v_exp_f32 v60, v60
    v_exp_f32 v61, v61
    v_exp_f32 v62, v62
    v_exp_f32 v63, v63
    v_smfmac_f32_32x32x32_bf16 v[224:239], v[92:95], v[48:55], v116
    s_nop 0
    v_smfmac_f32_32x32x32_bf16 v[224:239], v[96:99], v[56:63], v116
    v_mfma_f32_32x32x16_bf16 v[48:63], v[80:83], v[44:47], 0
    s_nop 11
    v_sub_f32 v48, v48, v115
    v_sub_f32 v49, v49, v115
    v_sub_f32 v50, v50, v115
    v_sub_f32 v51, v51, v115
    v_sub_f32 v52, v52, v115
    v_sub_f32 v53, v53, v115
    v_sub_f32 v54, v54, v115
    v_sub_f32 v55, v55, v115
    v_sub_f32 v56, v56, v115
    v_sub_f32 v57, v57, v115
    v_sub_f32 v58, v58, v115
    v_sub_f32 v59, v59, v115
    v_sub_f32 v60, v60, v115
    v_sub_f32 v61, v61, v115
    v_sub_f32 v62, v62, v115
    v_sub_f32 v63, v63, v115
    v_exp_f32 v48, v48
    v_exp_f32 v49, v49
    v_exp_f32 v50, v50
    v_exp_f32 v51, v51
    v_exp_f32 v52, v52
    v_exp_f32 v53, v53
    v_exp_f32 v54, v54
    v_exp_f32 v55, v55
    v_exp_f32 v56, v56
    v_exp_f32 v57, v57
    v_exp_f32 v58, v58
    v_exp_f32 v59, v59
    v_exp_f32 v60, v60
    v_exp_f32 v61, v61
    v_exp_f32 v62, v62
    v_exp_f32 v63, v63
    v_smfmac_f32_32x32x32_bf16 v[240:255], v[92:95], v[48:55], v116
    s_nop 0
    v_smfmac_f32_32x32x32_bf16 v[240:255], v[96:99], v[56:63], v116
    s_add_u32 s57, s57, 2048
    s_cmp_lt_u32 s57, s58
    s_cbranch_scc1 L_slow_pv
    ds_write_b128 v118, v[128:131] offset:0
    ds_write_b128 v118, v[132:135] offset:1024
    ds_write_b128 v118, v[144:147] offset:2048
    ds_write_b128 v118, v[148:151] offset:3072
    ds_write2st64_b32 v121, v136, v152 offset1:1
    ds_write_b128 v119, v[160:163] offset:0
    ds_write_b128 v119, v[164:167] offset:1024
    ds_write_b128 v119, v[176:179] offset:2048
    ds_write_b128 v119, v[180:183] offset:3072
    ds_write2st64_b32 v122, v168, v184 offset1:1
    ds_write_b128 v120, v[192:195] offset:0
    ds_write_b128 v120, v[196:199] offset:1024
    ds_write_b128 v120, v[208:211] offset:2048
    ds_write_b128 v120, v[212:215] offset:3072
    ds_write2st64_b32 v123, v200, v216 offset1:1
    s_mov_b32 s57, -1
    s_branch L_att_join
L_G:
    v_lshrrev_b32 v3, 2, v1
    v_and_b32 v3, 4, v3
    v_xor_b32 v14, v3, v5
    v_lshlrev_b32 v9, 10, v15
    v_lshl_add_u32 v9, v14, 4, v9
    s_lshl_b32 s3, s46, 7
    v_add_u32 v9, s3, v9
    v_lshlrev_b32 v62, 11, v1
    s_barrier
    s_cmp_eq_u32 s44, 7
    s_cbranch_scc1 L_kvwave
    s_and_b32 s56, s2, 7
    s_lshl_b32 s56, s56, 2
    s_add_u32 s56, s56, s53
    s_lshl_b32 s56, s56, 10
    s_mov_b32 s55, s56
    s_add_u32 m0, s55, 66560
    s_lshl_b32 s54, s55, 3
    s_nop 0
    buffer_load_dwordx4 v9, s[12:15], s54 offen lds
    s_add_u32 s55, s55, 3072
    s_and_b32 s55, s55, 0x7fff
    s_add_u32 m0, s55, 66560
    s_lshl_b32 s54, s55, 3
    s_nop 0
    buffer_load_dwordx4 v9, s[12:15], s54 offen lds
    s_add_u32 s55, s55, 3072
    s_and_b32 s55, s55, 0x7fff
    s_add_u32 m0, s55, 66560
    s_lshl_b32 s54, s55, 3
    s_nop 0
    buffer_load_dwordx4 v9, s[12:15], s54 offen lds
    s_add_u32 s55, s55, 3072
    s_and_b32 s55, s55, 0x7fff
    s_add_u32 m0, s55, 66560
    s_lshl_b32 s54, s55, 3
    s_nop 0
    buffer_load_dwordx4 v9, s[12:15], s54 offen lds
    s_add_u32 s55, s55, 3072
    s_and_b32 s55, s55, 0x7fff
    s_add_u32 m0, s55, 66560
    s_lshl_b32 s54, s55, 3
    s_nop 0
    buffer_load_dwordx4 v9, s[12:15], s54 offen lds
    s_add_u32 s55, s55, 3072
    s_and_b32 s55, s55, 0x7fff
    s_add_u32 m0, s55, 66560
    s_lshl_b32 s54, s55, 3
    s_nop 0
    buffer_load_dwordx4 v9, s[12:15], s54 offen lds
    s_add_u32 s55, s55, 3072
    s_and_b32 s55, s55, 0x7fff
    s_add_u32 m0, s55, 66560
    s_lshl_b32 s54, s55, 3
    s_nop 0
    buffer_load_dwordx4 v9, s[12:15], s54 offen lds
    s_add_u32 s55, s55, 3072
    s_and_b32 s55, s55, 0x7fff
    s_add_u32 m0, s55, 66560
    s_lshl_b32 s54, s55, 3
    s_nop 0
    buffer_load_dwordx4 v9, s[12:15], s54 offen lds
    s_add_u32 s55, s55, 3072
    s_and_b32 s55, s55, 0x7fff
    s_waitcnt vmcnt(8) lgkmcnt(0)
    s_add_u32 s47, s47, 0x9e3779b9
    v_dot2_f32_bf16 v64, v16, s64, 0
    v_dot2_f32_bf16 v65, v16, v16, 0
    v_dot2_f32_bf16 v64, v17, s64, v64
    v_dot2_f32_bf16 v65, v17, v17, v65
    v_dot2_f32_bf16 v64, v18, s64, v64
    v_dot2_f32_bf16 v65, v18, v18, v65
    s_add_u32 m0, s55, 66560
    s_lshl_b32 s54, s55, 3
    s_nop 0
    buffer_load_dwordx4 v9, s[12:15], s54 offen lds
    s_add_u32 s55, s55, 3072
    s_and_b32 s55, s55, 0x7fff
    v_dot2_f32_bf16 v64, v19, s64, v64
    v_dot2_f32_bf16 v65, v19, v19, v65
    v_dot2_f32_bf16 v64, v20, s64, v64
    v_dot2_f32_bf16 v65, v20, v20, v65
    v_dot2_f32_bf16 v64, v21, s64, v64
    v_dot2_f32_bf16 v65, v21, v21, v65
    s_add_u32 m0, s55, 66560
    s_lshl_b32 s54, s55, 3
    s_nop 0
    buffer_load_dwordx4 v9, s[12:15], s54 offen lds
    s_add_u32 s55, s55, 3072
    s_and_b32 s55, s55, 0x7fff
    v_dot2_f32_bf16 v64, v22, s64, v64
    v_dot2_f32_bf16 v65, v22, v22, v65
    v_dot2_f32_bf16 v64, v23, s64, v64
    v_dot2_f32_bf16 v65, v23, v23, v65
    v_dot2_f32_bf16 v64, v24, s64, v64
    v_dot2_f32_bf16 v65, v24, v24, v65
    s_add_u32 m0, s55, 66560
    s_lshl_b32 s54, s55, 3
    s_nop 0
    buffer_load_dwordx4 v9, s[12:15], s54 offen lds
    s_add_u32 s55, s55, 3072
    s_and_b32 s55, s55, 0x7fff
    v_dot2_f32_bf16 v64, v25, s64, v64
    v_dot2_f32_bf16 v65, v25, v25, v65
    v_dot2_f32_bf16 v64, v26, s64, v64
    v_dot2_f32_bf16 v65, v26, v26, v65
    v_dot2_f32_bf16 v64, v27, s64, v64
    v_dot2_f32_bf16 v65, v27, v27, v65
    s_mov_b32 s55, s56
    s_add_u32 m0, s55, 99328
    s_lshl_b32 s54, s55, 3
    s_add_u32 s54, s54, 262144
    buffer_load_dwordx4 v9, s[12:15], s54 offen lds
    s_add_u32 s55, s55, 3072
    s_and_b32 s55, s55, 0x7fff
    v_dot2_f32_bf16 v64, v28, s64, v64
    v_dot2_f32_bf16 v65, v28, v28, v65
    v_dot2_f32_bf16 v64, v29, s64, v64
    v_dot2_f32_bf16 v65, v29, v29, v65
    v_dot2_f32_bf16 v64, v30, s64, v64
    v_dot2_f32_bf16 v65, v30, v30, v65
    s_add_u32 m0, s55, 99328
    s_lshl_b32 s54, s55, 3
    s_add_u32 s54, s54, 262144
    buffer_load_dwordx4 v9, s[12:15], s54 offen lds
    s_add_u32 s55, s55, 3072
    s_and_b32 s55, s55, 0x7fff
    v_dot2_f32_bf16 v64, v31, s64, v64
    v_dot2_f32_bf16 v65, v31, v31, v65
    s_nop 1
    v_add_f32_dpp v64, v64, v64 quad_perm:[1,0,3,2] row_mask:0xf bank_mask:0xf
    v_add_f32_dpp v65, v65, v65 quad_perm:[1,0,3,2] row_mask:0xf bank_mask:0xf
    s_nop 0
    v_add_f32_dpp v64, v64, v64 quad_perm:[2,3,0,1] row_mask:0xf bank_mask:0xf
    v_add_f32_dpp v65, v65, v65 quad_perm:[2,3,0,1] row_mask:0xf bank_mask:0xf
    s_add_u32 m0, s55, 99328
    s_lshl_b32 s54, s55, 3
    s_add_u32 s54, s54, 262144
    buffer_load_dwordx4 v9, s[12:15], s54 offen lds
    s_add_u32 s55, s55, 3072
    s_and_b32 s55, s55, 0x7fff
    v_add_f32_dpp v64, v64, v64 row_half_mirror row_mask:0xf bank_mask:0xf
    v_add_f32_dpp v65, v65, v65 row_half_mirror row_mask:0xf bank_mask:0xf
    s_nop 0
    v_add_f32_dpp v64, v64, v64 row_mirror row_mask:0xf bank_mask:0xf
    v_add_f32_dpp v65, v65, v65 row_mirror row_mask:0xf bank_mask:0xf
    v_mul_f32 v64, 0xbb000000, v64
    v_mul_f32 v65, 0x3b000000, v65
    s_add_u32 m0, s55, 99328
    s_lshl_b32 s54, s55, 3
    s_add_u32 s54, s54, 262144
    buffer_load_dwordx4 v9, s[12:15], s54 offen lds
    s_add_u32 s55, s55, 3072
    s_and_b32 s55, s55, 0x7fff
    v_dot2_f32_bf16 v66, v16, s65, v64
    v_dot2_f32_bf16 v67, v16, s66, v64
    v_dot2_f32_bf16 v68, v17, s65, v64
    v_dot2_f32_bf16 v69, v17, s66, v64
    v_dot2_f32_bf16 v70, v18, s65, v64
    v_dot2_f32_bf16 v71, v18, s66, v64
    s_add_u32 m0, s55, 99328
    s_lshl_b32 s54, s55, 3
    s_add_u32 s54, s54, 262144
    buffer_load_dwordx4 v9, s[12:15], s54 offen lds
    s_add_u32 s55, s55, 3072
    s_and_b32 s55, s55, 0x7fff
    v_dot2_f32_bf16 v72, v19, s65, v64
    v_dot2_f32_bf16 v73, v19, s66, v64
    v_dot2_f32_bf16 v74, v20, s65, v64
    v_dot2_f32_bf16 v75, v20, s66, v64
    v_dot2_f32_bf16 v76, v21, s65, v64
    v_dot2_f32_bf16 v77, v21, s66, v64
    s_add_u32 m0, s55, 99328
    s_lshl_b32 s54, s55, 3
    s_add_u32 s54, s54, 262144
    buffer_load_dwordx4 v9, s[12:15], s54 offen lds
    s_add_u32 s55, s55, 3072
    s_and_b32 s55, s55, 0x7fff
    v_dot2_f32_bf16 v78, v22, s65, v64
    v_dot2_f32_bf16 v79, v22, s66, v64
    v_dot2_f32_bf16 v80, v23, s65, v64
    v_dot2_f32_bf16 v81, v23, s66, v64
    v_fma_f32 v65, -v64, v64, v65
    v_max_f32 v65, 0, v65
    s_add_u32 m0, s55, 99328
    s_lshl_b32 s54, s55, 3
    s_add_u32 s54, s54, 262144
    buffer_load_dwordx4 v9, s[12:15], s54 offen lds
    s_add_u32 s55, s55, 3072
    s_and_b32 s55, s55, 0x7fff
    v_add_f32 v82, 0x3727c5ac, v65
    v_cvt_pk_bf16_f32 v16, v66, v67
    v_cvt_pk_bf16_f32 v17, v68, v69
    v_cvt_pk_bf16_f32 v18, v70, v71
    v_cvt_pk_bf16_f32 v19, v72, v73
    ds_write_b128 v10, v[16:19] offset:0
    v_dot2_f32_bf16 v66, v24, s65, v64
    v_dot2_f32_bf16 v67, v24, s66, v64
    v_dot2_f32_bf16 v68, v25, s65, v64
    v_dot2_f32_bf16 v69, v25, s66, v64
    v_dot2_f32_bf16 v70, v26, s65, v64
    v_dot2_f32_bf16 v71, v26, s66, v64
    s_add_u32 m0, s55, 99328
    s_lshl_b32 s54, s55, 3
    s_add_u32 s54, s54, 262144
    buffer_load_dwordx4 v9, s[12:15], s54 offen lds
    s_add_u32 s55, s55, 3072
    s_and_b32 s55, s55, 0x7fff
    v_dot2_f32_bf16 v72, v27, s65, v64
    v_dot2_f32_bf16 v73, v27, s66, v64
    v_rsq_f32 v82, v82
    s_nop 0
    v_mul_f32 v65, v82, v65
    v_cvt_pk_bf16_f32 v20, v74, v75
    v_cvt_pk_bf16_f32 v21, v76, v77
    s_add_u32 m0, s55, 99328
    s_lshl_b32 s54, s55, 3
    s_add_u32 s54, s54, 262144
    buffer_load_dwordx4 v9, s[12:15], s54 offen lds
    s_add_u32 s55, s55, 3072
    s_and_b32 s55, s55, 0x7fff
    v_cvt_pk_bf16_f32 v22, v78, v79
    v_cvt_pk_bf16_f32 v23, v80, v81
    ds_write_b128 v10, v[20:23] offset:256
    v_dot2_f32_bf16 v74, v28, s65, v64
    v_dot2_f32_bf16 v75, v28, s66, v64
    v_dot2_f32_bf16 v76, v29, s65, v64
    s_add_u32 m0, s55, 99328
    s_lshl_b32 s54, s55, 3
    s_add_u32 s54, s54, 262144
    buffer_load_dwordx4 v9, s[12:15], s54 offen lds
    s_add_u32 s55, s55, 3072
    s_and_b32 s55, s55, 0x7fff
    v_dot2_f32_bf16 v77, v29, s66, v64
    v_dot2_f32_bf16 v78, v30, s65, v64
    v_dot2_f32_bf16 v79, v30, s66, v64
    v_dot2_f32_bf16 v80, v31, s65, v64
    v_dot2_f32_bf16 v81, v31, s66, v64
    v_mul_f32 v65, v82, v65
    s_add_u32 m0, s55, 99328
    s_lshl_b32 s54, s55, 3
    s_add_u32 s54, s54, 262144
    buffer_load_dwordx4 v9, s[12:15], s54 offen lds
    s_add_u32 s55, s55, 3072
    s_and_b32 s55, s55, 0x7fff
    v_add_f32 v65, 0x3727c5ac, v65
    v_rsq_f32 v65, v65
    v_cvt_pk_bf16_f32 v24, v66, v67
    v_cvt_pk_bf16_f32 v25, v68, v69
    v_cvt_pk_bf16_f32 v26, v70, v71
    v_cvt_pk_bf16_f32 v27, v72, v73
    ds_write_b128 v10, v[24:27] offset:512
    v_mul_f32 v65, v82, v65
    v_cvt_pk_bf16_f32 v28, v74, v75
    v_cvt_pk_bf16_f32 v29, v76, v77
    v_cvt_pk_bf16_f32 v30, v78, v79
    v_cvt_pk_bf16_f32 v31, v80, v81
    ds_write_b128 v10, v[28:31] offset:768
    s_mov_b32 exec_lo, 0x00010001
    s_mov_b32 exec_hi, 0x00010001
    ds_write2st64_b32 v11, v82, v65 offset1:1
    s_mov_b64 exec, -1
    s_waitcnt vmcnt(11) lgkmcnt(0)
    s_barrier
    s_branch L_gb1
L_kvwave:
    s_setprio 3
    v_lshrrev_b32 v3, 4, v1
    v_lshlrev_b32 v3, 8, v3
    v_lshl_add_u32 v3, v4, 3, v3
    v_add_u32 v3, 132096, v3
    s_waitcnt vmcnt(4) lgkmcnt(0)
    s_add_u32 s47, s47, 0x9e3779b9
    ds_read_b64_tr_b16 v[128:129], v3 offset:0
    ds_read_b64_tr_b16 v[130:131], v3 offset:128
    ds_read_b64_tr_b16 v[132:133], v3 offset:1024
    ds_read_b64_tr_b16 v[134:135], v3 offset:1152
    ds_read_b64_tr_b16 v[136:137], v3 offset:2048
    ds_read_b64_tr_b16 v[138:139], v3 offset:2176
    ds_read_b64_tr_b16 v[140:141], v3 offset:3072
    ds_read_b64_tr_b16 v[142:143], v3 offset:3200
    ds_read_b64_tr_b16 v[144:145], v3 offset:4096
    ds_read_b64_tr_b16 v[146:147], v3 offset:4224
    ds_read_b64_tr_b16 v[148:149], v3 offset:5120
    ds_read_b64_tr_b16 v[150:151], v3 offset:5248
    ds_read_b64_tr_b16 v[152:153], v3 offset:6144
    ds_read_b64_tr_b16 v[154:155], v3 offset:6272
    ds_read_b64_tr_b16 v[156:157], v3 offset:7168
    ds_read_b64_tr_b16 v[158:159], v3 offset:7296
    ds_read_b64_tr_b16 v[160:161], v3 offset:8192
    ds_read_b64_tr_b16 v[162:163], v3 offset:8320
    ds_read_b64_tr_b16 v[164:165], v3 offset:9216
    ds_read_b64_tr_b16 v[166:167], v3 offset:9344
    ds_read_b64_tr_b16 v[168:169], v3 offset:10240
    ds_read_b64_tr_b16 v[170:171], v3 offset:10368
    ds_read_b64_tr_b16 v[172:173], v3 offset:11264
    ds_read_b64_tr_b16 v[174:175], v3 offset:11392
    ds_read_b64_tr_b16 v[176:177], v3 offset:12288
    ds_read_b64_tr_b16 v[178:179], v3 offset:12416
    ds_read_b64_tr_b16 v[180:181], v3 offset:13312
    ds_read_b64_tr_b16 v[182:183], v3 offset:13440
    ds_read_b64_tr_b16 v[184:185], v3 offset:14336
    ds_read_b64_tr_b16 v[186:187], v3 offset:14464
    ds_read_b64_tr_b16 v[188:189], v3 offset:15360
    ds_read_b64_tr_b16 v[190:191], v3 offset:15488
    s_mov_b32 s54, 1048576
L_cw_14:
    ds_read_b32 v7, v12 offset:16
    s_waitcnt lgkmcnt(0)
    v_readfirstlane_b32 s55, v7
    s_cmp_ge_u32 s55, 4
    s_cbranch_scc1 L_cd_15
    s_sub_u32 s54, s54, 1
    s_cmp_lg_u32 s54, 0
    s_cbranch_scc1 L_cw_14
L_cd_15:
    v_and_b32 v4, 15, v1
    v_lshrrev_b32 v5, 4, v1
    s_mul_i32 s3, s52, 16640
    v_mul_u32_u24 v3, 1040, v4
    v_lshl_add_u32 v3, v5, 4, v3
    v_add_u32 v3, s3, v3
    ds_read_b128 v[192:195], v3 offset:0
    ds_read_b128 v[196:199], v3 offset:64
    ds_read_b128 v[200:203], v3 offset:128
    ds_read_b128 v[204:207], v3 offset:192
    ds_read_b128 v[208:211], v3 offset:256
    ds_read_b128 v[212:215], v3 offset:320
    ds_read_b128 v[216:219], v3 offset:384
    ds_read_b128 v[220:223], v3 offset:448
    ds_read_b128 v[224:227], v3 offset:512
    ds_read_b128 v[228:231], v3 offset:576
    ds_read_b128 v[232:235], v3 offset:640
    ds_read_b128 v[236:239], v3 offset:704
    ds_read_b128 v[240:243], v3 offset:768
    ds_read_b128 v[244:247], v3 offset:832
    ds_read_b128 v[248:251], v3 offset:896
    ds_read_b128 v[252:255], v3 offset:960
    s_lshl_b32 s54, s1, 12
    s_lshr_b32 s3, s52, 1
    s_lshl_b32 s3, s3, 11
    s_add_u32 s54, s54, s3
    s_add_u32 s54, s54, 65536
    s_and_b32 s55, s52, 1
    s_lshl_b32 s56, s52, 6
    s_add_u32 s56, s56, 156672
    s_and_b32 s3, s46, 1
    s_cmp_eq_u32 s3, 1
    s_cbranch_scc1 L_vjob
    v_lshl_add_u32 v7, v4, 2, s56
    ds_read_b32 v52, v7
    s_waitcnt lgkmcnt(14)
    v_mfma_f32_16x16x32_bf16 v[48:51], v[128:131], v[192:195], 0
    v_mfma_f32_16x16x32_bf16 v[48:51], v[132:135], v[196:199], v[48:51]
    v_mfma_f32_16x16x32_bf16 v[48:51], v[136:139], v[200:203], v[48:51]
    s_waitcnt lgkmcnt(13)
    v_mfma_f32_16x16x32_bf16 v[48:51], v[140:143], v[204:207], v[48:51]
    s_waitcnt lgkmcnt(12)
    v_mfma_f32_16x16x32_bf16 v[48:51], v[144:147], v[208:211], v[48:51]
    s_waitcnt lgkmcnt(11)
    v_mfma_f32_16x16x32_bf16 v[48:51], v[148:151], v[212:215], v[48:51]
    s_waitcnt lgkmcnt(10)
    v_mfma_f32_16x16x32_bf16 v[48:51], v[152:155], v[216:219], v[48:51]
    s_waitcnt lgkmcnt(9)
    v_mfma_f32_16x16x32_bf16 v[48:51], v[156:159], v[220:223], v[48:51]
    s_waitcnt lgkmcnt(8)
    v_mfma_f32_16x16x32_bf16 v[48:51], v[160:163], v[224:227], v[48:51]
    s_waitcnt lgkmcnt(7)
    v_mfma_f32_16x16x32_bf16 v[48:51], v[164:167], v[228:231], v[48:51]
    s_waitcnt lgkmcnt(6)
    v_mfma_f32_16x16x32_bf16 v[48:51], v[168:171], v[232:235], v[48:51]
    s_waitcnt lgkmcnt(5)
    v_mfma_f32_16x16x32_bf16 v[48:51], v[172:175], v[236:239], v[48:51]
    s_waitcnt lgkmcnt(4)
    v_mfma_f32_16x16x32_bf16 v[48:51], v[176:179], v[240:243], v[48:51]
    s_waitcnt lgkmcnt(3)
    v_mfma_f32_16x16x32_bf16 v[48:51], v[180:183], v[244:247], v[48:51]
    s_waitcnt lgkmcnt(2)
    v_mfma_f32_16x16x32_bf16 v[48:51], v[184:187], v[248:251], v[48:51]
    s_waitcnt lgkmcnt(1)
    v_mfma_f32_16x16x32_bf16 v[48:51], v[188:191], v[252:255], v[48:51]
    v_and_b32 v7, 1, v5
    v_lshlrev_b32 v7, 9, v7
    v_lshl_add_u32 v7, v4, 4, v7
    v_lshrrev_b32 v6, 1, v5
    v_lshl_add_u32 v7, v6, 3, v7
    s_lshl_b32 s55, s55, 8
    s_add_u32 s54, s54, s55
    s_waitcnt lgkmcnt(0)
    v_mul_f32 v48, v52, v48
    v_mul_f32 v49, v52, v49
    v_mul_f32 v50, v52, v50
    v_mul_f32 v51, v52, v51
    v_cvt_pk_bf16_f32 v54, v48, v49
    v_cvt_pk_bf16_f32 v55, v50, v51
    buffer_store_dwordx2 v[54:55], v7, s[8:11], s54 offen sc1
    v_dot2_f32_bf16 v57, v54, v54, 0
    v_dot2_f32_bf16 v57, v55, v55, v57
    s_nop 2
    v_mov_b32 v58, v57
    s_nop 1
    v_permlane16_swap_b32 v57, v58
    v_add_f32 v57, v57, v58
    v_mov_b32 v58, v57
    s_nop 1
    v_permlane32_swap_b32 v57, v58
    v_add_f32 v57, v57, v58
    s_branch L_kvpub
L_vjob:
    v_lshl_add_u32 v7, v5, 4, s56
    ds_read_b128 v[52:55], v7
    s_waitcnt lgkmcnt(14)
    v_mfma_f32_16x16x32_bf16 v[48:51], v[192:195], v[128:131], 0
    v_mfma_f32_16x16x32_bf16 v[48:51], v[196:199], v[132:135], v[48:51]
    v_mfma_f32_16x16x32_bf16 v[48:51], v[200:203], v[136:139], v[48:51]
    s_waitcnt lgkmcnt(13)
    v_mfma_f32_16x16x32_bf16 v[48:51], v[204:207], v[140:143], v[48:51]
    s_waitcnt lgkmcnt(12)
    v_mfma_f32_16x16x32_bf16 v[48:51], v[208:211], v[144:147], v[48:51]
    s_waitcnt lgkmcnt(11)
    v_mfma_f32_16x16x32_bf16 v[48:51], v[212:215], v[148:151], v[48:51]
    s_waitcnt lgkmcnt(10)
    v_mfma_f32_16x16x32_bf16 v[48:51], v[216:219], v[152:155], v[48:51]
    s_waitcnt lgkmcnt(9)
    v_mfma_f32_16x16x32_bf16 v[48:51], v[220:223], v[156:159], v[48:51]
    s_waitcnt lgkmcnt(8)
    v_mfma_f32_16x16x32_bf16 v[48:51], v[224:227], v[160:163], v[48:51]
    s_waitcnt lgkmcnt(7)
    v_mfma_f32_16x16x32_bf16 v[48:51], v[228:231], v[164:167], v[48:51]
    s_waitcnt lgkmcnt(6)
    v_mfma_f32_16x16x32_bf16 v[48:51], v[232:235], v[168:171], v[48:51]
    s_waitcnt lgkmcnt(5)
    v_mfma_f32_16x16x32_bf16 v[48:51], v[236:239], v[172:175], v[48:51]
    s_waitcnt lgkmcnt(4)
    v_mfma_f32_16x16x32_bf16 v[48:51], v[240:243], v[176:179], v[48:51]
    s_waitcnt lgkmcnt(3)
    v_mfma_f32_16x16x32_bf16 v[48:51], v[244:247], v[180:183], v[48:51]
    s_waitcnt lgkmcnt(2)
    v_mfma_f32_16x16x32_bf16 v[48:51], v[248:251], v[184:187], v[48:51]
    s_waitcnt lgkmcnt(1)
    v_mfma_f32_16x16x32_bf16 v[48:51], v[252:255], v[188:191], v[48:51]
    v_lshrrev_b32 v7, 1, v5
    v_lshlrev_b32 v7, 8, v7
    v_lshl_add_u32 v7, v4, 4, v7
    v_and_b32 v6, 1, v5
    v_lshl_add_u32 v7, v6, 3, v7
    s_lshl_b32 s55, s55, 9
    s_add_u32 s54, s54, s55
    s_add_u32 s54, s54, 1024
    s_waitcnt lgkmcnt(0)
    v_mul_f32 v48, v52, v48
    v_mul_f32 v49, v53, v49
    v_mul_f32 v50, v54, v50
    v_mul_f32 v51, v55, v51
    v_cvt_pk_bf16_f32 v54, v48, v49
    v_cvt_pk_bf16_f32 v55, v50, v51
    buffer_store_dwordx2 v[54:55], v7, s[8:11], s54 offen sc1
    v_max3_f32 v57, |v48|, |v49|, |v50|
    v_max_f32 v57, v57, |v51|
    v_mov_b32 v58, v57
    s_nop 1
    v_permlane16_swap_b32 v57, v58
    v_max_f32 v57, v57, v58
    v_mov_b32 v58, v57
    s_nop 1
    v_permlane32_swap_b32 v57, v58
    v_max_f32 v57, v57, v58
L_kvpub:
    s_nop 1
    v_max_u32_dpp v57, v57, v57 quad_perm:[1,0,3,2] row_mask:0xf bank_mask:0xf
    s_nop 1
    v_max_u32_dpp v57, v57, v57 quad_perm:[2,3,0,1] row_mask:0xf bank_mask:0xf
    s_nop 1
    v_max_u32_dpp v57, v57, v57 row_half_mirror row_mask:0xf bank_mask:0xf
    s_nop 1
    v_max_u32_dpp v57, v57, v57 row_mirror row_mask:0xf bank_mask:0xf
    v_add_u32 v57, 16, v57
    v_and_b32 v57, -16, v57
    v_or_b32 v61, s100, v57
    v_mov_b32 v60, s47
    s_lshl_b32 s58, s1, 3
    s_add_u32 s58, s58, s46
    s_lshl_b32 s58, s58, 3
    s_add_u32 s58, s58, 16384
    s_waitcnt vmcnt(1)
    v_dot2_f32_bf16 v64, v16, s64, 0
    v_dot2_f32_bf16 v65, v16, v16, 0
    v_dot2_f32_bf16 v64, v17, s64, v64
    v_dot2_f32_bf16 v65, v17, v17, v65
    v_dot2_f32_bf16 v64, v18, s64, v64
    v_dot2_f32_bf16 v65, v18, v18, v65
    v_dot2_f32_bf16 v64, v19, s64, v64
    v_dot2_f32_bf16 v65, v19, v19, v65
    v_dot2_f32_bf16 v64, v20, s64, v64
    v_dot2_f32_bf16 v65, v20, v20, v65
    v_dot2_f32_bf16 v64, v21, s64, v64
    v_dot2_f32_bf16 v65, v21, v21, v65
    v_dot2_f32_bf16 v64, v22, s64, v64
    v_dot2_f32_bf16 v65, v22, v22, v65
    v_dot2_f32_bf16 v64, v23, s64, v64
    v_dot2_f32_bf16 v65, v23, v23, v65
    v_dot2_f32_bf16 v64, v24, s64, v64
    v_dot2_f32_bf16 v65, v24, v24, v65
    v_dot2_f32_bf16 v64, v25, s64, v64
    v_dot2_f32_bf16 v65, v25, v25, v65
    v_dot2_f32_bf16 v64, v26, s64, v64
    v_dot2_f32_bf16 v65, v26, v26, v65
    v_dot2_f32_bf16 v64, v27, s64, v64
    v_dot2_f32_bf16 v65, v27, v27, v65
    v_dot2_f32_bf16 v64, v28, s64, v64
    v_dot2_f32_bf16 v65, v28, v28, v65
    v_dot2_f32_bf16 v64, v29, s64, v64
    v_dot2_f32_bf16 v65, v29, v29, v65
    v_dot2_f32_bf16 v64, v30, s64, v64
    v_dot2_f32_bf16 v65, v30, v30, v65
    v_dot2_f32_bf16 v64, v31, s64, v64
    v_dot2_f32_bf16 v65, v31, v31, v65
    s_nop 1
    v_add_f32_dpp v64, v64, v64 quad_perm:[1,0,3,2] row_mask:0xf bank_mask:0xf
    v_add_f32_dpp v65, v65, v65 quad_perm:[1,0,3,2] row_mask:0xf bank_mask:0xf
    s_nop 0
    v_add_f32_dpp v64, v64, v64 quad_perm:[2,3,0,1] row_mask:0xf bank_mask:0xf
    v_add_f32_dpp v65, v65, v65 quad_perm:[2,3,0,1] row_mask:0xf bank_mask:0xf
    s_nop 0
    v_add_f32_dpp v64, v64, v64 row_half_mirror row_mask:0xf bank_mask:0xf
    v_add_f32_dpp v65, v65, v65 row_half_mirror row_mask:0xf bank_mask:0xf
    s_nop 0
    v_add_f32_dpp v64, v64, v64 row_mirror row_mask:0xf bank_mask:0xf
    v_add_f32_dpp v65, v65, v65 row_mirror row_mask:0xf bank_mask:0xf
    v_mul_f32 v64, 0xbb000000, v64
    v_mul_f32 v65, 0x3b000000, v65
    v_dot2_f32_bf16 v66, v16, s65, v64
    v_dot2_f32_bf16 v67, v16, s66, v64
    v_dot2_f32_bf16 v68, v17, s65, v64
    v_dot2_f32_bf16 v69, v17, s66, v64
    v_dot2_f32_bf16 v70, v18, s65, v64
    v_dot2_f32_bf16 v71, v18, s66, v64
    v_dot2_f32_bf16 v72, v19, s65, v64
    v_dot2_f32_bf16 v73, v19, s66, v64
    v_dot2_f32_bf16 v74, v20, s65, v64
    v_dot2_f32_bf16 v75, v20, s66, v64
    v_dot2_f32_bf16 v76, v21, s65, v64
    v_dot2_f32_bf16 v77, v21, s66, v64
    v_dot2_f32_bf16 v78, v22, s65, v64
    v_dot2_f32_bf16 v79, v22, s66, v64
    v_dot2_f32_bf16 v80, v23, s65, v64
    v_dot2_f32_bf16 v81, v23, s66, v64
    v_fma_f32 v65, -v64, v64, v65
    v_max_f32 v65, 0, v65
    v_add_f32 v82, 0x3727c5ac, v65
    v_cvt_pk_bf16_f32 v16, v66, v67
    v_cvt_pk_bf16_f32 v17, v68, v69
    v_cvt_pk_bf16_f32 v18, v70, v71
    v_cvt_pk_bf16_f32 v19, v72, v73
    ds_write_b128 v10, v[16:19] offset:0
    v_dot2_f32_bf16 v66, v24, s65, v64
    v_dot2_f32_bf16 v67, v24, s66, v64
    v_dot2_f32_bf16 v68, v25, s65, v64
    v_dot2_f32_bf16 v69, v25, s66, v64
    v_dot2_f32_bf16 v70, v26, s65, v64
    v_dot2_f32_bf16 v71, v26, s66, v64
    v_dot2_f32_bf16 v72, v27, s65, v64
    v_dot2_f32_bf16 v73, v27, s66, v64
    v_rsq_f32 v82, v82
    s_nop 0
    v_mul_f32 v65, v82, v65
    v_cvt_pk_bf16_f32 v20, v74, v75
    v_cvt_pk_bf16_f32 v21, v76, v77
    v_cvt_pk_bf16_f32 v22, v78, v79
    v_cvt_pk_bf16_f32 v23, v80, v81
    ds_write_b128 v10, v[20:23] offset:256
    v_dot2_f32_bf16 v74, v28, s65, v64
    v_dot2_f32_bf16 v75, v28, s66, v64
    v_dot2_f32_bf16 v76, v29, s65, v64
    v_dot2_f32_bf16 v77, v29, s66, v64
    v_dot2_f32_bf16 v78, v30, s65, v64
    v_dot2_f32_bf16 v79, v30, s66, v64
    v_dot2_f32_bf16 v80, v31, s65, v64
    v_dot2_f32_bf16 v81, v31, s66, v64
    v_mul_f32 v65, v82, v65
    v_add_f32 v65, 0x3727c5ac, v65
    v_rsq_f32 v65, v65
    v_cvt_pk_bf16_f32 v24, v66, v67
    v_cvt_pk_bf16_f32 v25, v68, v69
    v_cvt_pk_bf16_f32 v26, v70, v71
    v_cvt_pk_bf16_f32 v27, v72, v73
    ds_write_b128 v10, v[24:27] offset:512
    v_mul_f32 v65, v82, v65
    v_cvt_pk_bf16_f32 v28, v74, v75
    v_cvt_pk_bf16_f32 v29, v76, v77
    v_cvt_pk_bf16_f32 v30, v78, v79
    v_cvt_pk_bf16_f32 v31, v80, v81
    ds_write_b128 v10, v[28:31] offset:768
    s_mov_b32 exec_lo, 0x00010001
    s_mov_b32 exec_hi, 0x00010001
    ds_write2st64_b32 v11, v82, v65 offset1:1
    s_mov_b64 exec, -1
    s_waitcnt lgkmcnt(0)
    s_barrier
    s_waitcnt vmcnt(0)
    s_mov_b64 exec, 0xff
    buffer_store_dwordx2 v[60:61], v62, s[8:11], s58 offen sc1
    s_mov_b64 exec, -1
    s_setprio 0
L_gb1:
    s_mov_b32 s59, 302777856
    s_cmp_ge_u32 s46, 4
    s_cselect_b32 s59, 639704087, s59
    s_lshl_b32 s3, s46, 3
    s_lshr_b32 s59, s59, s3
    s_and_b32 s59, s59, 0xff
    s_lshr_b32 s61, 255, s46
    s_and_b32 s61, s61, 1
    s_lshr_b32 s62, 7, s46
    s_and_b32 s62, s62, 1
    s_cmp_lt_u32 s53, 2
    s_cselect_b32 s60, s61, s62
    s_add_u32 s61, s61, 2
    s_cmp_lt_u32 s53, 2
    s_cselect_b32 s61, 0, s61
    s_add_u32 s59, s59, s61
    s_and_b32 s3, s53, 1
    s_and_b32 s61, s60, s3
    s_add_u32 s59, s59, s61
    s_add_u32 s61, s59, s3
    s_xor_b32 s3, s3, 1
    s_add_u32 s62, s59, s3
    v_lshrrev_b32 v133, 2, v1
    v_and_b32 v133, 8, v133
    v_lshrrev_b32 v136, 4, v1
    v_lshlrev_b32 v136, 3, v136
    s_lshl_b32 s54, s61, 6
    s_lshl_b32 s55, s62, 6
    s_lshl_b32 s48, s46, 7
    buffer_load_dwordx2 v[112:113], v133, s[32:35], s54 offen offset:0
    buffer_load_dwordx2 v[114:115], v133, s[32:35], s54 offen offset:16
    buffer_load_dwordx2 v[116:117], v133, s[32:35], s54 offen offset:32
    buffer_load_dwordx2 v[118:119], v133, s[32:35], s54 offen offset:48
    buffer_load_dwordx2 v[120:121], v133, s[32:35], s55 offen offset:0
    buffer_load_dwordx2 v[122:123], v133, s[32:35], s55 offen offset:16
    buffer_load_dwordx2 v[124:125], v133, s[32:35], s55 offen offset:32
    buffer_load_dwordx2 v[126:127], v133, s[32:35], s55 offen offset:48
    buffer_load_dwordx2 v[144:145], v136, s[36:39], s48 offen offset:0
    buffer_load_dwordx2 v[146:147], v136, s[36:39], s48 offen offset:32
    buffer_load_dwordx2 v[148:149], v136, s[36:39], s48 offen offset:64
    buffer_load_dwordx2 v[150:151], v136, s[36:39], s48 offen offset:96
    s_cmp_eq_u32 s44, 7
    s_cbranch_scc1 L_gb2
    s_waitcnt vmcnt(12)
L_gb2:
    s_barrier
    s_setprio 1
    s_and_b32 s56, s53, 1
    s_xor_b32 s57, s56, 1
    v_and_b32 v5, 31, v1
    v_lshrrev_b32 v6, 5, v1
    s_lshl_b32 s3, s56, 5
    v_add_u32 v7, s3, v5
    v_mul_u32_u24 v3, 1040, v7
    v_lshl_add_u32 v3, v6, 4, v3
    v_lshlrev_b32 v128, 2, v7
    s_lshl_b32 s3, s57, 5
    v_add_u32 v7, s3, v5
    v_mul_u32_u24 v4, 1040, v7
    v_lshl_add_u32 v4, v6, 4, v4
    v_lshlrev_b32 v129, 2, v7
    v_add_u32 v128, 156928, v128
    v_add_u32 v129, 156928, v129
    s_lshl_b32 s63, s53, 14
    s_add_u32 s63, s63, 66560
    v_mul_u32_u24 v7, 2752, v15
    v_lshl_add_u32 v7, v14, 4, v7
    s_lshl_b32 s3, s59, 6
    v_add_u32 v7, s3, v7
    v_and_b32 v132, 7, v1
    v_lshlrev_b32 v132, 3, v132
    s_lshl_b32 s3, s1, 6
    s_and_b32 s54, s2, 7
    s_lshl_b32 s54, s54, 11
    s_add_u32 s3, s3, s54
    s_add_u32 s3, s3, 16384
    v_add_u32 v132, s3, v132
    v_lshrrev_b32 v6, 1, v1
    v_and_b32 v6, 1, v6
    v_lshrrev_b32 v8, 3, v1
    v_and_b32 v5, 2, v8
    v_or_b32 v6, v6, v5
    v_and_b32 v8, 1, v8
    v_lshl_or_b32 v6, v8, 2, v6
    v_lshlrev_b32 v6, 4, v6
    v_and_b32 v8, 1, v1
    v_lshl_or_b32 v6, v8, 3, v6
    v_bfe_u32 v8, v1, 2, 2
    v_lshl_or_b32 v6, v8, 7, v6
    v_lshrrev_b32 v8, 5, v1
    v_lshl_or_b32 v6, v8, 10, v6
    v_add_u32 v5, s63, v6
    s_lshl_b32 s3, s56, 6
    v_xor_b32 v5, s3, v5
    v_xor_b32 v6, 64, v5
    s_lshl_b32 s58, s53, 12
    s_add_u32 s58, s58, 132096
    s_sub_u32 s3, s58, s63
    v_add_u32 v130, s3, v5
    v_add_u32 v131, s3, v6
    s_and_b32 s0, s2, 7
    s_lshr_b32 s3, s2, 6
    s_mul_i32 s3, s3, 2
    s_add_u32 s3, s3, s0
    s_and_b32 s3, s3, 7
    s_mul_i32 s50, s3, 176128
    s_lshl_b32 s68, s3, 7
    v_add_u32 v140, s68, v3
    v_add_u32 v141, s68, v4
    s_mul_i32 s51, s53, 22
    s_cmp_eq_u32 s53, 3
    s_cselect_b32 s51, 65, s51
    s_cmp_ge_u32 s53, 2
    s_cselect_b32 s69, 21, 22
    s_add_u32 s69, s69, s51
    s_lshl_b32 s69, s69, 14
    s_lshl_b32 s52, s51, 14
    s_add_u32 s3, s0, s46
    s_and_b32 s3, s3, 7
    s_mul_i32 s3, s3, 21
    s_lshr_b32 s3, s3, 3
    s_lshr_b32 s54, s2, 6
    s_mul_i32 s54, s54, 5
    s_add_u32 s3, s3, s54
    s_cmp_ge_u32 s3, 21
    s_cselect_b32 s54, 21, 0
    s_sub_u32 s3, s3, s54
    s_add_u32 s51, s51, s3
    s_lshl_b32 s67, s51, 11
    s_lshl_b32 s51, s51, 14
    v_lshrrev_b32 v8, 2, v14
    v_cmp_eq_u32 s[96:97], s56, v8
    s_cmp_lg_u32 s60, 0
    s_cselect_b64 s[16:17], -1, s[96:97]
    s_mul_i32 s99, s45, 176128
    s_add_u32 s99, s99, 2359296
    s_add_u32 s67, s67, s99
    s_lshl_b32 s3, s61, 12
    s_add_u32 s97, s99, s3
    s_lshl_b32 s3, s56, 10
    s_add_u32 s96, s97, s3
    s_lshl_b32 s98, s62, 12
    s_add_u32 s98, s98, s99
    s_add_u32 s98, s98, s3
    s_lshl_b32 s3, s57, 10
    s_add_u32 s97, s97, s3
    s_mov_b64 exec, s[16:17]
    s_add_u32 m0, s58, 0
    s_nop 0
    buffer_load_dwordx4 v7, s[20:23], s50 offen lds
    s_add_u32 s50, s50, 22016
    s_add_u32 m0, s58, 1024
    s_nop 0
    buffer_load_dwordx4 v7, s[20:23], s50 offen lds
    s_add_u32 s50, s50, 22016
    s_mov_b64 exec, -1
    s_mov_b64 exec, s[16:17]
    s_add_u32 m0, s58, 2048
    s_nop 0
    buffer_load_dwordx4 v7, s[20:23], s50 offen lds
    s_add_u32 s50, s50, 22016
    s_add_u32 m0, s58, 3072
    s_nop 0
    buffer_load_dwordx4 v7, s[20:23], s50 offen lds
    s_add_u32 s50, s50, 22016
    s_mov_b64 exec, -1
    ds_read_b32 v10, v128
    ds_read_b32 v14, v129
    v_lshrrev_b32 v233, 1, v1
    v_and_b32 v233, 1, v233
    v_lshrrev_b32 v8, 3, v1
    v_and_b32 v232, 2, v8
    v_or_b32 v233, v233, v232
    v_and_b32 v8, 1, v8
    v_lshl_or_b32 v233, v8, 2, v233
    v_lshlrev_b32 v233, 4, v233
    v_and_b32 v8, 1, v1
    v_lshl_or_b32 v233, v8, 3, v233
    v_bfe_u32 v8, v1, 2, 2
    v_lshl_or_b32 v233, v8, 7, v233
    v_lshrrev_b32 v8, 5, v1
    v_lshl_or_b32 v233, v8, 9, v233
    v_add_u32 v232, s63, v233
    v_xor_b32 v233, 64, v232
    s_mul_i32 s55, s53, 16640
    s_sub_u32 s3, s55, s63
    v_add_u32 v234, s3, v232
    v_add_u32 v235, s3, v233
    v_and_b32 v236, 6, v15
    v_and_b32 v8, 7, v1
    v_xor_b32 v236, v236, v8
    v_lshlrev_b32 v236, 4, v236
    v_lshl_add_u32 v236, v15, 10, v236
    s_lshl_b32 s3, s46, 7
    v_add_u32 v236, s3, v236
    v_and_b32 v8, 31, v1
    v_lshlrev_b32 v237, 2, v8
    v_mov_b32 v238, s47
    v_mov_b32 v239, 0
    v_and_b32 v11, 15, v1
    v_lshrrev_b32 v240, 5, v1
    v_xor_b32 v240, v240, v11
    v_lshlrev_b32 v240, 4, v240
    v_lshl_add_u32 v240, v8, 8, v240
    v_add_u32 v240, s55, v240
    v_lshrrev_b32 v8, 4, v1
    v_xor_b32 v241, v8, v11
    v_lshlrev_b32 v241, 4, v241
    v_lshl_add_u32 v241, v11, 8, v241
    s_lshl_b32 s54, s53, 12
    v_add_u32 v241, s54, v241
    v_lshlrev_b32 v242, 3, v8
    s_lshl_b32 s54, s53, 14
    v_lshl_add_u32 v243, v11, 10, v242
    v_add_u32 v243, s54, v243
    s_lshl_b32 s54, s45, 16
    s_add_u32 s54, s54, s3
    v_add_u32 v243, s54, v243
    v_and_b32 v242, 1, v8
    v_lshlrev_b32 v242, 9, v242
    v_lshrrev_b32 v8, 1, v8
    v_lshl_add_u32 v242, v8, 11, v242
    v_lshl_add_u32 v242, v11, 4, v242
    s_lshr_b32 s3, s53, 1
    s_lshl_b32 s3, s3, 10
    s_and_b32 s54, s53, 1
    s_lshl_b32 s54, s54, 8
    s_add_u32 s3, s3, s54
    v_add_u32 v242, s3, v242
    v_bfe_u32 v8, v1, 2, 3
    v_lshlrev_b32 v244, 7, v8
    v_lshrrev_b32 v8, 1, v8
    v_lshl_or_b32 v244, v8, 5, v244
    v_and_b32 v8, 3, v1
    v_lshl_or_b32 v244, v8, 3, v244
    v_lshrrev_b32 v8, 5, v1
    v_lshl_or_b32 v244, v8, 11, v244
    v_add_u32 v244, 66560, v244
    v_xor_b32 v245, 32, v244
    v_xor_b32 v246, 64, v244
    v_xor_b32 v247, 96, v244
    v_mov_b32 v128, 0xc0135761
    v_mov_b32 v129, 0xc0135761
    s_waitcnt vmcnt(5)
    v_lshlrev_b32 v16, 16, v112
    v_and_b32 v17, 0xffff0000, v112
    v_lshlrev_b32 v18, 16, v113
    v_and_b32 v19, 0xffff0000, v113
    v_lshlrev_b32 v20, 16, v114
    v_and_b32 v21, 0xffff0000, v114
    v_lshlrev_b32 v22, 16, v115
    v_and_b32 v23, 0xffff0000, v115
    v_lshlrev_b32 v24, 16, v116
    v_and_b32 v25, 0xffff0000, v116
    v_lshlrev_b32 v26, 16, v117
    v_and_b32 v27, 0xffff0000, v117
    v_lshlrev_b32 v28, 16, v118
    v_and_b32 v29, 0xffff0000, v118
    v_lshlrev_b32 v30, 16, v119
    v_and_b32 v31, 0xffff0000, v119
    v_lshlrev_b32 v32, 16, v120
    v_and_b32 v33, 0xffff0000, v120
    v_lshlrev_b32 v34, 16, v121
    v_and_b32 v35, 0xffff0000, v121
    v_lshlrev_b32 v36, 16, v122
    v_and_b32 v37, 0xffff0000, v122
    v_lshlrev_b32 v38, 16, v123
    v_and_b32 v39, 0xffff0000, v123
    v_lshlrev_b32 v40, 16, v124
    v_and_b32 v41, 0xffff0000, v124
    v_lshlrev_b32 v42, 16, v125
    v_and_b32 v43, 0xffff0000, v125
    v_lshlrev_b32 v44, 16, v126
    v_and_b32 v45, 0xffff0000, v126
    v_lshlrev_b32 v46, 16, v127
    v_and_b32 v47, 0xffff0000, v127
    s_waitcnt vmcnt(4)
    v_lshlrev_b32 v208, 16, v144
    v_and_b32 v209, 0xffff0000, v144
    v_lshlrev_b32 v210, 16, v145
    v_and_b32 v211, 0xffff0000, v145
    v_lshlrev_b32 v212, 16, v146
    v_and_b32 v213, 0xffff0000, v146
    v_lshlrev_b32 v214, 16, v147
    v_and_b32 v215, 0xffff0000, v147
    v_lshlrev_b32 v216, 16, v148
    v_and_b32 v217, 0xffff0000, v148
    v_lshlrev_b32 v218, 16, v149
    v_and_b32 v219, 0xffff0000, v149
    v_lshlrev_b32 v220, 16, v150
    v_and_b32 v221, 0xffff0000, v150
    v_lshlrev_b32 v222, 16, v151
    v_and_b32 v223, 0xffff0000, v151
    v_add_u32 v144, s68, v3
    v_add_u32 v145, s68, v4
    s_add_u32 s68, s68, 128
    s_and_b32 s68, s68, 1023
    v_add_u32 v146, s68, v3
    v_add_u32 v147, s68, v4
    s_add_u32 s68, s68, 128
    s_and_b32 s68, s68, 1023
    v_add_u32 v148, s68, v3
    v_add_u32 v149, s68, v4
    s_add_u32 s68, s68, 128
    s_and_b32 s68, s68, 1023
    v_add_u32 v150, s68, v3
    v_add_u32 v151, s68, v4
    s_add_u32 s68, s68, 128
    s_and_b32 s68, s68, 1023
    v_add_u32 v152, s68, v3
    v_add_u32 v153, s68, v4
    s_add_u32 s68, s68, 128
    s_and_b32 s68, s68, 1023
    v_add_u32 v154, s68, v3
    v_add_u32 v155, s68, v4
    s_add_u32 s68, s68, 128
    s_and_b32 s68, s68, 1023
    v_add_u32 v156, s68, v3
    v_add_u32 v157, s68, v4
    s_add_u32 s68, s68, 128
    s_and_b32 s68, s68, 1023
    v_add_u32 v158, s68, v3
    v_add_u32 v159, s68, v4
    s_add_u32 s68, s68, 128
    s_and_b32 s68, s68, 1023
    v_xor_b32 v248, 32, v240
    v_xor_b32 v249, 64, v240
    v_xor_b32 v250, 96, v240
    v_xor_b32 v251, 128, v240
    v_xor_b32 v252, 160, v240
    v_xor_b32 v253, 192, v240
    v_xor_b32 v254, 224, v240
    s_mov_b32 s54, 1048576
L_cw_16:
    ds_read_b32 v8, v12 offset:0
    s_waitcnt lgkmcnt(0)
    v_readfirstlane_b32 s55, v8
    s_cmp_ge_u32 s55, 4
    s_cbranch_scc1 L_cd_17
    s_sleep 1
    s_sub_u32 s54, s54, 1
    s_cmp_lg_u32 s54, 0
    s_cbranch_scc1 L_cw_16
L_cd_17:
L_g_main:
    s_setprio 0
    s_cmp_lg_u32 s60, 0
    s_cselect_b64 vcc, -1, 0
    s_mov_b64 exec, s[16:17]
    s_add_u32 m0, s63, 0
    s_nop 0
    buffer_load_dwordx4 v7, s[20:23], s50 offen lds
    s_add_u32 s50, s50, 22016
    s_add_u32 m0, s63, 1024
    s_nop 0
    buffer_load_dwordx4 v7, s[20:23], s50 offen lds
    s_add_u32 s50, s50, 22016
    s_mov_b64 exec, -1
    s_mov_b64 exec, s[16:17]
    s_add_u32 m0, s63, 2048
    s_nop 0
    buffer_load_dwordx4 v7, s[20:23], s50 offen lds
    s_add_u32 s50, s50, 22016
    s_add_u32 m0, s63, 3072
    s_nop 0
    buffer_load_dwordx4 v7, s[20:23], s50 offen lds
    s_add_u32 s50, s50, 22016
    s_cmp_eq_u32 s50, 1409024
    s_cselect_b32 s50, 0, s50
    s_mov_b64 exec, -1
    s_waitcnt vmcnt(6)
    ds_read_b64_tr_b16 v[96:97], v130 offset:0
    ds_read_b64_tr_b16 v[98:99], v130 offset:512
    ds_read_b128 v[104:107], v144 offset:0
    ds_read_b128 v[108:111], v145 offset:0
    ds_read_b64_tr_b16 v[100:101], v131 offset:0
    ds_read_b64_tr_b16 v[102:103], v131 offset:512
    s_waitcnt vmcnt(4)
    ds_read_b64_tr_b16 v[112:113], v130 offset:2048
    ds_read_b64_tr_b16 v[114:115], v130 offset:2560
    ds_read_b128 v[120:123], v144 offset:32
    ds_read_b128 v[124:127], v145 offset:32
    ds_read_b64_tr_b16 v[116:117], v131 offset:2048
    ds_read_b64_tr_b16 v[118:119], v131 offset:2560
    s_waitcnt lgkmcnt(6)
    s_mov_b64 exec, s[16:17]
    s_add_u32 m0, s63, 4096
    s_nop 0
    buffer_load_dwordx4 v7, s[20:23], s50 offen lds
    s_add_u32 s50, s50, 22016
    s_add_u32 m0, s63, 5120
    s_nop 0
    buffer_load_dwordx4 v7, s[20:23], s50 offen lds
    s_add_u32 s50, s50, 22016
    s_mov_b64 exec, -1
    v_mfma_f32_32x32x16_bf16 v[48:63], v[96:99], v[104:107], 0
    v_mfma_f32_32x32x16_bf16 v[64:79], v[96:99], v[108:111], 0
    s_cbranch_vccz L_s3_18
    v_mfma_f32_32x32x16_bf16 v[80:95], v[100:103], v[104:107], 0
L_s3_18:
    s_waitcnt vmcnt(4)
    ds_read_b64_tr_b16 v[96:97], v5 offset:0
    ds_read_b64_tr_b16 v[98:99], v5 offset:512
    ds_read_b128 v[104:107], v144 offset:64
    ds_read_b128 v[108:111], v145 offset:64
    ds_read_b64_tr_b16 v[100:101], v6 offset:0
    ds_read_b64_tr_b16 v[102:103], v6 offset:512
    s_waitcnt lgkmcnt(6)
    s_mov_b64 exec, s[16:17]
    s_add_u32 m0, s63, 6144
    s_nop 0
    buffer_load_dwordx4 v7, s[20:23], s50 offen lds
    s_add_u32 s50, s50, 22016
    s_add_u32 m0, s63, 7168
    s_nop 0
    buffer_load_dwordx4 v7, s[20:23], s50 offen lds
    s_add_u32 s50, s50, 22016
    s_mov_b64 exec, -1
    v_mfma_f32_32x32x16_bf16 v[48:63], v[112:115], v[120:123], v[48:63]
    v_mfma_f32_32x32x16_bf16 v[64:79], v[112:115], v[124:127], v[64:79]
    s_cbranch_vccz L_s3_19
    v_mfma_f32_32x32x16_bf16 v[80:95], v[116:119], v[120:123], v[80:95]
L_s3_19:
    s_waitcnt vmcnt(4)
    ds_read_b64_tr_b16 v[112:113], v5 offset:2048
    ds_read_b64_tr_b16 v[114:115], v5 offset:2560
    ds_read_b128 v[120:123], v144 offset:96
    ds_read_b128 v[124:127], v145 offset:96
    ds_read_b64_tr_b16 v[116:117], v6 offset:2048
    ds_read_b64_tr_b16 v[118:119], v6 offset:2560
    s_waitcnt lgkmcnt(6)
    s_mov_b64 exec, s[16:17]
    s_add_u32 m0, s63, 8192
    s_nop 0
    buffer_load_dwordx4 v7, s[20:23], s50 offen lds
    s_add_u32 s50, s50, 22016
    s_add_u32 m0, s63, 9216
    s_nop 0
    buffer_load_dwordx4 v7, s[20:23], s50 offen lds
    s_add_u32 s50, s50, 22016
    s_mov_b64 exec, -1
    v_mfma_f32_32x32x16_bf16 v[48:63], v[96:99], v[104:107], v[48:63]
    v_mfma_f32_32x32x16_bf16 v[64:79], v[96:99], v[108:111], v[64:79]
    s_cbranch_vccz L_s3_20
    v_mfma_f32_32x32x16_bf16 v[80:95], v[100:103], v[104:107], v[80:95]
L_s3_20:
    s_waitcnt vmcnt(4)
    ds_read_b64_tr_b16 v[96:97], v5 offset:4096
    ds_read_b64_tr_b16 v[98:99], v5 offset:4608
    ds_read_b128 v[104:107], v146 offset:0
    ds_read_b128 v[108:111], v147 offset:0
    ds_read_b64_tr_b16 v[100:101], v6 offset:4096
    ds_read_b64_tr_b16 v[102:103], v6 offset:4608
    s_waitcnt lgkmcnt(6)
    s_mov_b64 exec, s[16:17]
    s_add_u32 m0, s63, 10240
    s_nop 0
    buffer_load_dwordx4 v7, s[20:23], s50 offen lds
    s_add_u32 s50, s50, 22016
    s_add_u32 m0, s63, 11264
    s_nop 0
    buffer_load_dwordx4 v7, s[20:23], s50 offen lds
    s_add_u32 s50, s50, 22016
    s_cmp_eq_u32 s50, 1409024
    s_cselect_b32 s50, 0, s50
    s_mov_b64 exec, -1
    v_mfma_f32_32x32x16_bf16 v[48:63], v[112:115], v[120:123], v[48:63]
    v_mfma_f32_32x32x16_bf16 v[64:79], v[112:115], v[124:127], v[64:79]
    s_cbranch_vccz L_s3_21
    v_mfma_f32_32x32x16_bf16 v[80:95], v[116:119], v[120:123], v[80:95]
L_s3_21:
    s_waitcnt vmcnt(4)
    ds_read_b64_tr_b16 v[112:113], v5 offset:6144
    ds_read_b64_tr_b16 v[114:115], v5 offset:6656
    ds_read_b128 v[120:123], v146 offset:32
    ds_read_b128 v[124:127], v147 offset:32
    ds_read_b64_tr_b16 v[116:117], v6 offset:6144
    ds_read_b64_tr_b16 v[118:119], v6 offset:6656
    s_waitcnt lgkmcnt(6)
    s_mov_b64 exec, s[16:17]
    s_add_u32 m0, s63, 12288
    s_nop 0
    buffer_load_dwordx4 v7, s[20:23], s50 offen lds
    s_add_u32 s50, s50, 22016
    s_add_u32 m0, s63, 13312
    s_nop 0
    buffer_load_dwordx4 v7, s[20:23], s50 offen lds
    s_add_u32 s50, s50, 22016
    s_mov_b64 exec, -1
    v_mfma_f32_32x32x16_bf16 v[48:63], v[96:99], v[104:107], v[48:63]
    v_mfma_f32_32x32x16_bf16 v[64:79], v[96:99], v[108:111], v[64:79]
    s_cbranch_vccz L_s3_22
    v_mfma_f32_32x32x16_bf16 v[80:95], v[100:103], v[104:107], v[80:95]
L_s3_22:
    s_waitcnt vmcnt(4)
    ds_read_b64_tr_b16 v[96:97], v5 offset:8192
    ds_read_b64_tr_b16 v[98:99], v5 offset:8704
    ds_read_b128 v[104:107], v146 offset:64
    ds_read_b128 v[108:111], v147 offset:64
    ds_read_b64_tr_b16 v[100:101], v6 offset:8192
    ds_read_b64_tr_b16 v[102:103], v6 offset:8704
    s_waitcnt lgkmcnt(6)
    s_mov_b64 exec, s[16:17]
    s_add_u32 m0, s63, 14336
    s_nop 0
    buffer_load_dwordx4 v7, s[20:23], s50 offen lds
    s_add_u32 s50, s50, 22016
    s_add_u32 m0, s63, 15360
    s_nop 0
    buffer_load_dwordx4 v7, s[20:23], s50 offen lds
    s_add_u32 s50, s50, 22016
    s_mov_b64 exec, -1
    v_mfma_f32_32x32x16_bf16 v[48:63], v[112:115], v[120:123], v[48:63]
    v_mfma_f32_32x32x16_bf16 v[64:79], v[112:115], v[124:127], v[64:79]
    s_cbranch_vccz L_s3_23
    v_mfma_f32_32x32x16_bf16 v[80:95], v[116:119], v[120:123], v[80:95]
L_s3_23:
    s_waitcnt vmcnt(4)
    ds_read_b64_tr_b16 v[112:113], v5 offset:10240
    ds_read_b64_tr_b16 v[114:115], v5 offset:10752
    ds_read_b128 v[120:123], v146 offset:96
    ds_read_b128 v[124:127], v147 offset:96
    ds_read_b64_tr_b16 v[116:117], v6 offset:10240
    ds_read_b64_tr_b16 v[118:119], v6 offset:10752
    s_waitcnt lgkmcnt(6)
    s_mov_b64 exec, s[16:17]
    s_add_u32 m0, s63, 0
    s_nop 0
    buffer_load_dwordx4 v7, s[20:23], s50 offen lds
    s_add_u32 s50, s50, 22016
    s_add_u32 m0, s63, 1024
    s_nop 0
    buffer_load_dwordx4 v7, s[20:23], s50 offen lds
    s_add_u32 s50, s50, 22016
    s_mov_b64 exec, -1
    v_mfma_f32_32x32x16_bf16 v[48:63], v[96:99], v[104:107], v[48:63]
    v_mfma_f32_32x32x16_bf16 v[64:79], v[96:99], v[108:111], v[64:79]
    s_cbranch_vccz L_s3_24
    v_mfma_f32_32x32x16_bf16 v[80:95], v[100:103], v[104:107], v[80:95]
L_s3_24:
    s_waitcnt vmcnt(4)
    ds_read_b64_tr_b16 v[96:97], v5 offset:12288
    ds_read_b64_tr_b16 v[98:99], v5 offset:12800
    ds_read_b128 v[104:107], v148 offset:0
    ds_read_b128 v[108:111], v149 offset:0
    ds_read_b64_tr_b16 v[100:101], v6 offset:12288
    ds_read_b64_tr_b16 v[102:103], v6 offset:12800
    s_waitcnt lgkmcnt(6)
    s_mov_b64 exec, s[16:17]
    s_add_u32 m0, s63, 2048
    s_nop 0
    buffer_load_dwordx4 v7, s[20:23], s50 offen lds
    s_add_u32 s50, s50, 22016
    s_add_u32 m0, s63, 3072
    s_nop 0
    buffer_load_dwordx4 v7, s[20:23], s50 offen lds
    s_add_u32 s50, s50, 22016
    s_cmp_eq_u32 s50, 1409024
    s_cselect_b32 s50, 0, s50
    s_mov_b64 exec, -1
    v_mfma_f32_32x32x16_bf16 v[48:63], v[112:115], v[120:123], v[48:63]
    v_mfma_f32_32x32x16_bf16 v[64:79], v[112:115], v[124:127], v[64:79]
    s_cbranch_vccz L_s3_25
    v_mfma_f32_32x32x16_bf16 v[80:95], v[116:119], v[120:123], v[80:95]
L_s3_25:
    s_waitcnt vmcnt(4)
    ds_read_b64_tr_b16 v[112:113], v5 offset:14336
    ds_read_b64_tr_b16 v[114:115], v5 offset:14848
    ds_read_b128 v[120:123], v148 offset:32
    ds_read_b128 v[124:127], v149 offset:32
    ds_read_b64_tr_b16 v[116:117], v6 offset:14336
    ds_read_b64_tr_b16 v[118:119], v6 offset:14848
    s_waitcnt lgkmcnt(6)
    s_mov_b64 exec, s[16:17]
    s_add_u32 m0, s63, 4096
    s_nop 0
    buffer_load_dwordx4 v7, s[20:23], s50 offen lds
    s_add_u32 s50, s50, 22016
    s_add_u32 m0, s63, 5120
    s_nop 0
    buffer_load_dwordx4 v7, s[20:23], s50 offen lds
    s_add_u32 s50, s50, 22016
    s_mov_b64 exec, -1
    v_mfma_f32_32x32x16_bf16 v[48:63], v[96:99], v[104:107], v[48:63]
    v_mfma_f32_32x32x16_bf16 v[64:79], v[96:99], v[108:111], v[64:79]
    s_cbranch_vccz L_s3_26
    v_mfma_f32_32x32x16_bf16 v[80:95], v[100:103], v[104:107], v[80:95]
L_s3_26:
    s_waitcnt vmcnt(4)
    ds_read_b64_tr_b16 v[96:97], v5 offset:0
    ds_read_b64_tr_b16 v[98:99], v5 offset:512
    ds_read_b128 v[104:107], v148 offset:64
    ds_read_b128 v[108:111], v149 offset:64
    ds_read_b64_tr_b16 v[100:101], v6 offset:0
    ds_read_b64_tr_b16 v[102:103], v6 offset:512
    s_waitcnt lgkmcnt(6)
    s_mov_b64 exec, s[16:17]
    s_add_u32 m0, s63, 6144
    s_nop 0
    buffer_load_dwordx4 v7, s[20:23], s50 offen lds
    s_add_u32 s50, s50, 22016
    s_add_u32 m0, s63, 7168
    s_nop 0
    buffer_load_dwordx4 v7, s[20:23], s50 offen lds
    s_add_u32 s50, s50, 22016
    s_mov_b64 exec, -1
    v_mfma_f32_32x32x16_bf16 v[48:63], v[112:115], v[120:123], v[48:63]
    v_mfma_f32_32x32x16_bf16 v[64:79], v[112:115], v[124:127], v[64:79]
    s_cbranch_vccz L_s3_27
    v_mfma_f32_32x32x16_bf16 v[80:95], v[116:119], v[120:123], v[80:95]
L_s3_27:
    s_waitcnt vmcnt(4)
    ds_read_b64_tr_b16 v[112:113], v5 offset:2048
    ds_read_b64_tr_b16 v[114:115], v5 offset:2560
    ds_read_b128 v[120:123], v148 offset:96
    ds_read_b128 v[124:127], v149 offset:96
    ds_read_b64_tr_b16 v[116:117], v6 offset:2048
    ds_read_b64_tr_b16 v[118:119], v6 offset:2560
    s_waitcnt lgkmcnt(6)
    s_mov_b64 exec, s[16:17]
    s_add_u32 m0, s63, 8192
    s_nop 0
    buffer_load_dwordx4 v7, s[20:23], s50 offen lds
    s_add_u32 s50, s50, 22016
    s_add_u32 m0, s63, 9216
    s_nop 0
    buffer_load_dwordx4 v7, s[20:23], s50 offen lds
    s_add_u32 s50, s50, 22016
    s_mov_b64 exec, -1
    v_mfma_f32_32x32x16_bf16 v[48:63], v[96:99], v[104:107], v[48:63]
    v_mfma_f32_32x32x16_bf16 v[64:79], v[96:99], v[108:111], v[64:79]
    s_cbranch_vccz L_s3_28
    v_mfma_f32_32x32x16_bf16 v[80:95], v[100:103], v[104:107], v[80:95]
L_s3_28:
    s_waitcnt vmcnt(4)
    ds_read_b64_tr_b16 v[96:97], v5 offset:4096
    ds_read_b64_tr_b16 v[98:99], v5 offset:4608
    ds_read_b128 v[104:107], v150 offset:0
    ds_read_b128 v[108:111], v151 offset:0
    ds_read_b64_tr_b16 v[100:101], v6 offset:4096
    ds_read_b64_tr_b16 v[102:103], v6 offset:4608
    s_waitcnt lgkmcnt(6)
    s_mov_b64 exec, s[16:17]
    s_add_u32 m0, s63, 10240
    s_nop 0
    buffer_load_dwordx4 v7, s[20:23], s50 offen lds
    s_add_u32 s50, s50, 22016
    s_add_u32 m0, s63, 11264
    s_nop 0
    buffer_load_dwordx4 v7, s[20:23], s50 offen lds
    s_add_u32 s50, s50, 22016
    s_cmp_eq_u32 s50, 1409024
    s_cselect_b32 s50, 0, s50
    s_mov_b64 exec, -1
    v_mfma_f32_32x32x16_bf16 v[48:63], v[112:115], v[120:123], v[48:63]
    v_mfma_f32_32x32x16_bf16 v[64:79], v[112:115], v[124:127], v[64:79]
    s_cbranch_vccz L_s3_29
    v_mfma_f32_32x32x16_bf16 v[80:95], v[116:119], v[120:123], v[80:95]
L_s3_29:
    s_waitcnt vmcnt(4)
    ds_read_b64_tr_b16 v[112:113], v5 offset:6144
    ds_read_b64_tr_b16 v[114:115], v5 offset:6656
    ds_read_b128 v[120:123], v150 offset:32
    ds_read_b128 v[124:127], v151 offset:32
    ds_read_b64_tr_b16 v[116:117], v6 offset:6144
    ds_read_b64_tr_b16 v[118:119], v6 offset:6656
    s_waitcnt lgkmcnt(6)
    s_mov_b64 exec, s[16:17]
    s_add_u32 m0, s63, 12288
    s_nop 0
    buffer_load_dwordx4 v7, s[20:23], s50 offen lds
    s_add_u32 s50, s50, 22016
    s_add_u32 m0, s63, 13312
    s_nop 0
    buffer_load_dwordx4 v7, s[20:23], s50 offen lds
    s_add_u32 s50, s50, 22016
    s_mov_b64 exec, -1
    v_mfma_f32_32x32x16_bf16 v[48:63], v[96:99], v[104:107], v[48:63]
    v_mfma_f32_32x32x16_bf16 v[64:79], v[96:99], v[108:111], v[64:79]
    s_cbranch_vccz L_s3_30
    v_mfma_f32_32x32x16_bf16 v[80:95], v[100:103], v[104:107], v[80:95]
L_s3_30:
    s_waitcnt vmcnt(4)
    ds_read_b64_tr_b16 v[96:97], v5 offset:8192
    ds_read_b64_tr_b16 v[98:99], v5 offset:8704
    ds_read_b128 v[104:107], v150 offset:64
    ds_read_b128 v[108:111], v151 offset:64
    ds_read_b64_tr_b16 v[100:101], v6 offset:8192
    ds_read_b64_tr_b16 v[102:103], v6 offset:8704
    s_waitcnt lgkmcnt(6)
    s_mov_b64 exec, s[16:17]
    s_add_u32 m0, s63, 14336
    s_nop 0
    buffer_load_dwordx4 v7, s[20:23], s50 offen lds
    s_add_u32 s50, s50, 22016
    s_add_u32 m0, s63, 15360
    s_nop 0
    buffer_load_dwordx4 v7, s[20:23], s50 offen lds
    s_add_u32 s50, s50, 22016
    s_mov_b64 exec, -1
    v_mfma_f32_32x32x16_bf16 v[48:63], v[112:115], v[120:123], v[48:63]
    v_mfma_f32_32x32x16_bf16 v[64:79], v[112:115], v[124:127], v[64:79]
    s_cbranch_vccz L_s3_31
    v_mfma_f32_32x32x16_bf16 v[80:95], v[116:119], v[120:123], v[80:95]
L_s3_31:
    s_waitcnt vmcnt(4)
    ds_read_b64_tr_b16 v[112:113], v5 offset:10240
    ds_read_b64_tr_b16 v[114:115], v5 offset:10752
    ds_read_b128 v[120:123], v150 offset:96
    ds_read_b128 v[124:127], v151 offset:96
    ds_read_b64_tr_b16 v[116:117], v6 offset:10240
    ds_read_b64_tr_b16 v[118:119], v6 offset:10752
    s_waitcnt lgkmcnt(6)
    s_mov_b64 exec, s[16:17]
    s_add_u32 m0, s63, 0
    s_nop 0
    buffer_load_dwordx4 v7, s[20:23], s50 offen lds
    s_add_u32 s50, s50, 22016
    s_add_u32 m0, s63, 1024
    s_nop 0
    buffer_load_dwordx4 v7, s[20:23], s50 offen lds
    s_add_u32 s50, s50, 22016
    s_mov_b64 exec, -1
    v_mfma_f32_32x32x16_bf16 v[48:63], v[96:99], v[104:107], v[48:63]
    v_mfma_f32_32x32x16_bf16 v[64:79], v[96:99], v[108:111], v[64:79]
    s_cbranch_vccz L_s3_32
    v_mfma_f32_32x32x16_bf16 v[80:95], v[100:103], v[104:107], v[80:95]
L_s3_32:
    s_waitcnt vmcnt(4)
    ds_read_b64_tr_b16 v[96:97], v5 offset:12288
    ds_read_b64_tr_b16 v[98:99], v5 offset:12800
    ds_read_b128 v[104:107], v152 offset:0
    ds_read_b128 v[108:111], v153 offset:0
    ds_read_b64_tr_b16 v[100:101], v6 offset:12288
    ds_read_b64_tr_b16 v[102:103], v6 offset:12800
    s_waitcnt lgkmcnt(6)
    s_mov_b64 exec, s[16:17]
    s_add_u32 m0, s63, 2048
    s_nop 0
    buffer_load_dwordx4 v7, s[20:23], s50 offen lds
    s_add_u32 s50, s50, 22016
    s_add_u32 m0, s63, 3072
    s_nop 0
    buffer_load_dwordx4 v7, s[20:23], s50 offen lds
    s_add_u32 s50, s50, 22016
    s_cmp_eq_u32 s50, 1409024
    s_cselect_b32 s50, 0, s50
    s_mov_b64 exec, -1
    v_mfma_f32_32x32x16_bf16 v[48:63], v[112:115], v[120:123], v[48:63]
    v_mfma_f32_32x32x16_bf16 v[64:79], v[112:115], v[124:127], v[64:79]
    s_cbranch_vccz L_s3_33
    v_mfma_f32_32x32x16_bf16 v[80:95], v[116:119], v[120:123], v[80:95]
L_s3_33:
    s_waitcnt vmcnt(4)
    ds_read_b64_tr_b16 v[112:113], v5 offset:14336
    ds_read_b64_tr_b16 v[114:115], v5 offset:14848
    ds_read_b128 v[120:123], v152 offset:32
    ds_read_b128 v[124:127], v153 offset:32
    ds_read_b64_tr_b16 v[116:117], v6 offset:14336
    ds_read_b64_tr_b16 v[118:119], v6 offset:14848
    s_waitcnt lgkmcnt(6)
    s_mov_b64 exec, s[16:17]
    s_add_u32 m0, s63, 4096
    s_nop 0
    buffer_load_dwordx4 v7, s[20:23], s50 offen lds
    s_add_u32 s50, s50, 22016
    s_add_u32 m0, s63, 5120
    s_nop 0
    buffer_load_dwordx4 v7, s[20:23], s50 offen lds
    s_add_u32 s50, s50, 22016
    s_mov_b64 exec, -1
    buffer_load_dwordx2 v[134:135], v132, s[8:11], 0 offen sc1
    v_mfma_f32_32x32x16_bf16 v[48:63], v[96:99], v[104:107], v[48:63]
    v_mfma_f32_32x32x16_bf16 v[64:79], v[96:99], v[108:111], v[64:79]
    s_cbranch_vccz L_s3_34
    v_mfma_f32_32x32x16_bf16 v[80:95], v[100:103], v[104:107], v[80:95]
L_s3_34:
    s_waitcnt vmcnt(5)
    ds_read_b64_tr_b16 v[96:97], v5 offset:0
    ds_read_b64_tr_b16 v[98:99], v5 offset:512
    ds_read_b128 v[104:107], v152 offset:64
    ds_read_b128 v[108:111], v153 offset:64
    ds_read_b64_tr_b16 v[100:101], v6 offset:0
    ds_read_b64_tr_b16 v[102:103], v6 offset:512
    s_waitcnt lgkmcnt(6)
    s_mov_b64 exec, s[16:17]
    s_add_u32 m0, s63, 6144
    s_nop 0
    buffer_load_dwordx4 v7, s[20:23], s50 offen lds
    s_add_u32 s50, s50, 22016
    s_add_u32 m0, s63, 7168
    s_nop 0
    buffer_load_dwordx4 v7, s[20:23], s50 offen lds
    s_add_u32 s50, s50, 22016
    s_mov_b64 exec, -1
    v_mfma_f32_32x32x16_bf16 v[48:63], v[112:115], v[120:123], v[48:63]
    v_mfma_f32_32x32x16_bf16 v[64:79], v[112:115], v[124:127], v[64:79]
    s_cbranch_vccz L_s3_35
    v_mfma_f32_32x32x16_bf16 v[80:95], v[116:119], v[120:123], v[80:95]
L_s3_35:
    s_waitcnt vmcnt(5)
    ds_read_b64_tr_b16 v[112:113], v5 offset:2048
    ds_read_b64_tr_b16 v[114:115], v5 offset:2560
    ds_read_b128 v[120:123], v152 offset:96
    ds_read_b128 v[124:127], v153 offset:96
    ds_read_b64_tr_b16 v[116:117], v6 offset:2048
    ds_read_b64_tr_b16 v[118:119], v6 offset:2560
    s_waitcnt lgkmcnt(6)
    s_mov_b64 exec, s[16:17]
    s_add_u32 m0, s63, 8192
    s_nop 0
    buffer_load_dwordx4 v7, s[20:23], s50 offen lds
    s_add_u32 s50, s50, 22016
    s_add_u32 m0, s63, 9216
    s_nop 0
    buffer_load_dwordx4 v7, s[20:23], s50 offen lds
    s_add_u32 s50, s50, 22016
    s_mov_b64 exec, -1
    v_mfma_f32_32x32x16_bf16 v[48:63], v[96:99], v[104:107], v[48:63]
    v_mfma_f32_32x32x16_bf16 v[64:79], v[96:99], v[108:111], v[64:79]
    s_cbranch_vccz L_s3_36
    v_mfma_f32_32x32x16_bf16 v[80:95], v[100:103], v[104:107], v[80:95]
L_s3_36:
    s_waitcnt vmcnt(5)
    ds_read_b64_tr_b16 v[96:97], v5 offset:4096
    ds_read_b64_tr_b16 v[98:99], v5 offset:4608
    ds_read_b128 v[104:107], v154 offset:0
    ds_read_b128 v[108:111], v155 offset:0
    ds_read_b64_tr_b16 v[100:101], v6 offset:4096
    ds_read_b64_tr_b16 v[102:103], v6 offset:4608
    s_waitcnt lgkmcnt(6)
    s_mov_b64 exec, s[16:17]
    s_add_u32 m0, s63, 10240
    s_nop 0
    buffer_load_dwordx4 v7, s[20:23], s50 offen lds
    s_add_u32 s50, s50, 22016
    s_add_u32 m0, s63, 11264
    s_nop 0
    buffer_load_dwordx4 v7, s[20:23], s50 offen lds
    s_add_u32 s50, s50, 22016
    s_cmp_eq_u32 s50, 1409024
    s_cselect_b32 s50, 0, s50
    s_mov_b64 exec, -1
    v_mfma_f32_32x32x16_bf16 v[48:63], v[112:115], v[120:123], v[48:63]
    v_mfma_f32_32x32x16_bf16 v[64:79], v[112:115], v[124:127], v[64:79]
    s_cbranch_vccz L_s3_37
    v_mfma_f32_32x32x16_bf16 v[80:95], v[116:119], v[120:123], v[80:95]
L_s3_37:
    s_waitcnt vmcnt(4)
    ds_read_b64_tr_b16 v[112:113], v5 offset:6144
    ds_read_b64_tr_b16 v[114:115], v5 offset:6656
    ds_read_b128 v[120:123], v154 offset:32
    ds_read_b128 v[124:127], v155 offset:32
    ds_read_b64_tr_b16 v[116:117], v6 offset:6144
    ds_read_b64_tr_b16 v[118:119], v6 offset:6656
    s_waitcnt lgkmcnt(6)
    s_mov_b64 exec, s[16:17]
    s_add_u32 m0, s63, 12288
    s_nop 0
    buffer_load_dwordx4 v7, s[20:23], s50 offen lds
    s_add_u32 s50, s50, 22016
    s_add_u32 m0, s63, 13312
    s_nop 0
    buffer_load_dwordx4 v7, s[20:23], s50 offen lds
    s_add_u32 s50, s50, 22016
    s_mov_b64 exec, -1
    buffer_load_dwordx2 v[224:225], v243, s[4:7], 0 offen offset:0
    buffer_load_dwordx2 v[226:227], v243, s[4:7], 0 offen offset:32
    buffer_load_dwordx2 v[228:229], v243, s[4:7], 0 offen offset:64
    buffer_load_dwordx2 v[230:231], v243, s[4:7], 0 offen offset:96
    v_mfma_f32_32x32x16_bf16 v[48:63], v[96:99], v[104:107], v[48:63]
    v_mfma_f32_32x32x16_bf16 v[64:79], v[96:99], v[108:111], v[64:79]
    s_cbranch_vccz L_s3_38
    v_mfma_f32_32x32x16_bf16 v[80:95], v[100:103], v[104:107], v[80:95]
L_s3_38:
    s_waitcnt vmcnt(8)
    ds_read_b64_tr_b16 v[96:97], v5 offset:8192
    ds_read_b64_tr_b16 v[98:99], v5 offset:8704
    ds_read_b128 v[104:107], v154 offset:64
    ds_read_b128 v[108:111], v155 offset:64
    ds_read_b64_tr_b16 v[100:101], v6 offset:8192
    ds_read_b64_tr_b16 v[102:103], v6 offset:8704
    s_waitcnt lgkmcnt(6)
    s_mov_b64 exec, s[16:17]
    s_add_u32 m0, s63, 14336
    s_nop 0
    buffer_load_dwordx4 v7, s[20:23], s50 offen lds
    s_add_u32 s50, s50, 22016
    s_add_u32 m0, s63, 15360
    s_nop 0
    buffer_load_dwordx4 v7, s[20:23], s50 offen lds
    s_add_u32 s50, s50, 22016
    s_mov_b64 exec, -1
    v_mfma_f32_32x32x16_bf16 v[48:63], v[112:115], v[120:123], v[48:63]
    v_mfma_f32_32x32x16_bf16 v[64:79], v[112:115], v[124:127], v[64:79]
    s_cbranch_vccz L_s3_39
    v_mfma_f32_32x32x16_bf16 v[80:95], v[116:119], v[120:123], v[80:95]
L_s3_39:
    s_waitcnt vmcnt(8)
    ds_read_b64_tr_b16 v[112:113], v5 offset:10240
    ds_read_b64_tr_b16 v[114:115], v5 offset:10752
    ds_read_b128 v[120:123], v154 offset:96
    ds_read_b128 v[124:127], v155 offset:96
    ds_read_b64_tr_b16 v[116:117], v6 offset:10240
    ds_read_b64_tr_b16 v[118:119], v6 offset:10752
    s_waitcnt lgkmcnt(6)
    s_mov_b64 exec, s[16:17]
    s_add_u32 m0, s63, 0
    s_nop 0
    buffer_load_dwordx4 v7, s[20:23], s50 offen lds
    s_add_u32 s50, s50, 22016
    s_add_u32 m0, s63, 1024
    s_nop 0
    buffer_load_dwordx4 v7, s[20:23], s50 offen lds
    s_add_u32 s50, s50, 22016
    s_mov_b64 exec, -1
    v_mfma_f32_32x32x16_bf16 v[48:63], v[96:99], v[104:107], v[48:63]
    v_mfma_f32_32x32x16_bf16 v[64:79], v[96:99], v[108:111], v[64:79]
    s_cbranch_vccz L_s3_40
    v_mfma_f32_32x32x16_bf16 v[80:95], v[100:103], v[104:107], v[80:95]
L_s3_40:
    s_waitcnt vmcnt(8)
    ds_read_b64_tr_b16 v[96:97], v5 offset:12288
    ds_read_b64_tr_b16 v[98:99], v5 offset:12800
    ds_read_b128 v[104:107], v156 offset:0
    ds_read_b128 v[108:111], v157 offset:0
    ds_read_b64_tr_b16 v[100:101], v6 offset:12288
    ds_read_b64_tr_b16 v[102:103], v6 offset:12800
    s_waitcnt lgkmcnt(6)
    s_mov_b64 exec, s[16:17]
    s_add_u32 m0, s63, 2048
    s_nop 0
    buffer_load_dwordx4 v7, s[20:23], s50 offen lds
    s_add_u32 s50, s50, 22016
    s_add_u32 m0, s63, 3072
    s_nop 0
    buffer_load_dwordx4 v7, s[20:23], s50 offen lds
    s_add_u32 s50, s50, 22016
    s_cmp_eq_u32 s50, 1409024
    s_cselect_b32 s50, 0, s50
    s_mov_b64 exec, -1
    v_mfma_f32_32x32x16_bf16 v[48:63], v[112:115], v[120:123], v[48:63]
    v_mfma_f32_32x32x16_bf16 v[64:79], v[112:115], v[124:127], v[64:79]
    s_cbranch_vccz L_s3_41
    v_mfma_f32_32x32x16_bf16 v[80:95], v[116:119], v[120:123], v[80:95]
L_s3_41:
    s_waitcnt vmcnt(4)
    ds_read_b64_tr_b16 v[112:113], v5 offset:14336
    ds_read_b64_tr_b16 v[114:115], v5 offset:14848
    ds_read_b128 v[120:123], v156 offset:32
    ds_read_b128 v[124:127], v157 offset:32
    ds_read_b64_tr_b16 v[116:117], v6 offset:14336
    ds_read_b64_tr_b16 v[118:119], v6 offset:14848
    s_waitcnt lgkmcnt(6)
    s_mov_b64 exec, s[16:17]
    s_add_u32 m0, s63, 4096
    s_nop 0
    buffer_load_dwordx4 v7, s[20:23], s50 offen lds
    s_add_u32 s50, s50, 22016
    s_add_u32 m0, s63, 5120
    s_nop 0
    buffer_load_dwordx4 v7, s[20:23], s50 offen lds
    s_add_u32 s50, s50, 22016
    s_mov_b64 exec, -1
    v_mfma_f32_32x32x16_bf16 v[48:63], v[96:99], v[104:107], v[48:63]
    v_mfma_f32_32x32x16_bf16 v[64:79], v[96:99], v[108:111], v[64:79]
    s_cbranch_vccz L_s3_42
    v_mfma_f32_32x32x16_bf16 v[80:95], v[100:103], v[104:107], v[80:95]
L_s3_42:
    s_waitcnt vmcnt(4)
    ds_read_b64_tr_b16 v[96:97], v5 offset:0
    ds_read_b64_tr_b16 v[98:99], v5 offset:512
    ds_read_b128 v[104:107], v156 offset:64
    ds_read_b128 v[108:111], v157 offset:64
    ds_read_b64_tr_b16 v[100:101], v6 offset:0
    ds_read_b64_tr_b16 v[102:103], v6 offset:512
    s_waitcnt lgkmcnt(6)
    s_mov_b64 exec, s[16:17]
    s_add_u32 m0, s63, 6144
    s_nop 0
    buffer_load_dwordx4 v7, s[20:23], s50 offen lds
    s_add_u32 s50, s50, 22016
    s_add_u32 m0, s63, 7168
    s_nop 0
    buffer_load_dwordx4 v7, s[20:23], s50 offen lds
    s_add_u32 s50, s50, 22016
    s_mov_b64 exec, -1
    v_mfma_f32_32x32x16_bf16 v[48:63], v[112:115], v[120:123], v[48:63]
    v_mfma_f32_32x32x16_bf16 v[64:79], v[112:115], v[124:127], v[64:79]
    s_cbranch_vccz L_s3_43
    v_mfma_f32_32x32x16_bf16 v[80:95], v[116:119], v[120:123], v[80:95]
L_s3_43:
    s_waitcnt vmcnt(4)
    ds_read_b64_tr_b16 v[112:113], v5 offset:2048
    ds_read_b64_tr_b16 v[114:115], v5 offset:2560
    ds_read_b128 v[120:123], v156 offset:96
    ds_read_b128 v[124:127], v157 offset:96
    ds_read_b64_tr_b16 v[116:117], v6 offset:2048
    ds_read_b64_tr_b16 v[118:119], v6 offset:2560
    s_waitcnt lgkmcnt(6)
    s_mov_b64 exec, s[16:17]
    s_add_u32 m0, s63, 8192
    s_nop 0
    buffer_load_dwordx4 v7, s[20:23], s50 offen lds
    s_add_u32 s50, s50, 22016
    s_add_u32 m0, s63, 9216
    s_nop 0
    buffer_load_dwordx4 v7, s[20:23], s50 offen lds
    s_add_u32 s50, s50, 22016
    s_mov_b64 exec, -1
    v_mfma_f32_32x32x16_bf16 v[48:63], v[96:99], v[104:107], v[48:63]
    v_mfma_f32_32x32x16_bf16 v[64:79], v[96:99], v[108:111], v[64:79]
    s_cbranch_vccz L_s3_44
    v_mfma_f32_32x32x16_bf16 v[80:95], v[100:103], v[104:107], v[80:95]
L_s3_44:
    s_waitcnt vmcnt(4)
    ds_read_b64_tr_b16 v[96:97], v5 offset:4096
    ds_read_b64_tr_b16 v[98:99], v5 offset:4608
    ds_read_b128 v[104:107], v158 offset:0
    ds_read_b128 v[108:111], v159 offset:0
    ds_read_b64_tr_b16 v[100:101], v6 offset:4096
    ds_read_b64_tr_b16 v[102:103], v6 offset:4608
    s_waitcnt lgkmcnt(6)
    s_mov_b64 exec, s[16:17]
    s_add_u32 m0, s63, 10240
    s_nop 0
    buffer_load_dwordx4 v7, s[20:23], s50 offen lds
    s_add_u32 s50, s50, 22016
    s_add_u32 m0, s63, 11264
    s_nop 0
    buffer_load_dwordx4 v7, s[20:23], s50 offen lds
    s_add_u32 s50, s50, 22016
    s_cmp_eq_u32 s50, 1409024
    s_cselect_b32 s50, 0, s50
    s_mov_b64 exec, -1
    v_mfma_f32_32x32x16_bf16 v[48:63], v[112:115], v[120:123], v[48:63]
    v_mfma_f32_32x32x16_bf16 v[64:79], v[112:115], v[124:127], v[64:79]
    s_cbranch_vccz L_s3_45
    v_mfma_f32_32x32x16_bf16 v[80:95], v[116:119], v[120:123], v[80:95]
L_s3_45:
    s_waitcnt vmcnt(4)
    ds_read_b64_tr_b16 v[112:113], v5 offset:6144
    ds_read_b64_tr_b16 v[114:115], v5 offset:6656
    ds_read_b128 v[120:123], v158 offset:32
    ds_read_b128 v[124:127], v159 offset:32
    ds_read_b64_tr_b16 v[116:117], v6 offset:6144
    ds_read_b64_tr_b16 v[118:119], v6 offset:6656
    s_waitcnt lgkmcnt(6)
    s_add_u32 m0, s63, 12288
    s_nop 0
    buffer_load_dwordx4 v9, s[24:27], s51 offen lds
    s_add_u32 s51, s51, 8192
    s_add_u32 m0, s63, 13312
    s_nop 0
    buffer_load_dwordx4 v9, s[24:27], s51 offen lds
    s_add_u32 s51, s51, 8192
    s_cmp_eq_u32 s51, s69
    s_cselect_b32 s51, s52, s51
    v_mfma_f32_32x32x16_bf16 v[48:63], v[96:99], v[104:107], v[48:63]
    v_mfma_f32_32x32x16_bf16 v[64:79], v[96:99], v[108:111], v[64:79]
    s_cbranch_vccz L_s3_46
    v_mfma_f32_32x32x16_bf16 v[80:95], v[100:103], v[104:107], v[80:95]
L_s3_46:
    s_waitcnt vmcnt(4)
    ds_read_b64_tr_b16 v[96:97], v5 offset:8192
    ds_read_b64_tr_b16 v[98:99], v5 offset:8704
    ds_read_b128 v[104:107], v158 offset:64
    ds_read_b128 v[108:111], v159 offset:64
    ds_read_b64_tr_b16 v[100:101], v6 offset:8192
    ds_read_b64_tr_b16 v[102:103], v6 offset:8704
    s_waitcnt lgkmcnt(6)
    s_add_u32 m0, s63, 14336
    s_nop 0
    buffer_load_dwordx4 v9, s[24:27], s51 offen lds
    s_add_u32 s51, s51, 8192
    s_add_u32 m0, s63, 15360
    s_nop 0
    buffer_load_dwordx4 v9, s[24:27], s51 offen lds
    s_add_u32 s51, s51, 8192
    s_cmp_eq_u32 s51, s69
    s_cselect_b32 s51, s52, s51
    v_mfma_f32_32x32x16_bf16 v[48:63], v[112:115], v[120:123], v[48:63]
    v_mfma_f32_32x32x16_bf16 v[64:79], v[112:115], v[124:127], v[64:79]
    s_cbranch_vccz L_s3_47
    v_mfma_f32_32x32x16_bf16 v[80:95], v[116:119], v[120:123], v[80:95]
L_s3_47:
    s_waitcnt vmcnt(4)
    ds_read_b64_tr_b16 v[112:113], v5 offset:10240
    ds_read_b64_tr_b16 v[114:115], v5 offset:10752
    ds_read_b128 v[120:123], v158 offset:96
    ds_read_b128 v[124:127], v159 offset:96
    ds_read_b64_tr_b16 v[116:117], v6 offset:10240
    ds_read_b64_tr_b16 v[118:119], v6 offset:10752
    s_waitcnt lgkmcnt(6)
    s_add_u32 m0, s63, 0
    s_nop 0
    buffer_load_dwordx4 v9, s[24:27], s51 offen lds
    s_add_u32 s51, s51, 8192
    s_add_u32 m0, s63, 1024
    s_nop 0
    buffer_load_dwordx4 v9, s[24:27], s51 offen lds
    s_add_u32 s51, s51, 8192
    s_cmp_eq_u32 s51, s69
    s_cselect_b32 s51, s52, s51
    v_mfma_f32_32x32x16_bf16 v[48:63], v[96:99], v[104:107], v[48:63]
    v_mfma_f32_32x32x16_bf16 v[64:79], v[96:99], v[108:111], v[64:79]
    s_cbranch_vccz L_s3_48
    v_mfma_f32_32x32x16_bf16 v[80:95], v[100:103], v[104:107], v[80:95]
L_s3_48:
    s_waitcnt lgkmcnt(0)
    s_add_u32 m0, s63, 2048
    s_nop 0
    buffer_load_dwordx4 v9, s[24:27], s51 offen lds
    s_add_u32 s51, s51, 8192
    s_add_u32 m0, s63, 3072
    s_nop 0
    buffer_load_dwordx4 v9, s[24:27], s51 offen lds
    s_add_u32 s51, s51, 8192
    s_cmp_eq_u32 s51, s69
    s_cselect_b32 s51, s52, s51
    v_mfma_f32_32x32x16_bf16 v[48:63], v[112:115], v[120:123], v[48:63]
    v_mfma_f32_32x32x16_bf16 v[64:79], v[112:115], v[124:127], v[64:79]
    s_cbranch_vccz L_s3_49
    v_mfma_f32_32x32x16_bf16 v[80:95], v[116:119], v[120:123], v[80:95]
L_s3_49:
    s_add_u32 m0, s63, 4096
    s_nop 0
    buffer_load_dwordx4 v9, s[24:27], s51 offen lds
    s_add_u32 s51, s51, 8192
    s_add_u32 m0, s63, 5120
    s_nop 0
    buffer_load_dwordx4 v9, s[24:27], s51 offen lds
    s_add_u32 s51, s51, 8192
    s_cmp_eq_u32 s51, s69
    s_cselect_b32 s51, s52, s51
    s_add_u32 m0, s63, 6144
    s_nop 0
    buffer_load_dwordx4 v9, s[24:27], s51 offen lds
    s_add_u32 s51, s51, 8192
    s_add_u32 m0, s63, 7168
    s_nop 0
    buffer_load_dwordx4 v9, s[24:27], s51 offen lds
    s_add_u32 s51, s51, 8192
    s_cmp_eq_u32 s51, s69
    s_cselect_b32 s51, s52, s51
    s_add_u32 m0, s63, 8192
    s_nop 0
    buffer_load_dwordx4 v9, s[24:27], s51 offen lds
    s_add_u32 s51, s51, 8192
    s_add_u32 m0, s63, 9216
    s_nop 0
    buffer_load_dwordx4 v9, s[24:27], s51 offen lds
    s_add_u32 s51, s51, 8192
    s_cmp_eq_u32 s51, s69
    s_cselect_b32 s51, s52, s51
    s_add_u32 m0, s63, 10240
    s_nop 0
    buffer_load_dwordx4 v9, s[24:27], s51 offen lds
    s_add_u32 s51, s51, 8192
    s_add_u32 m0, s63, 11264
    s_nop 0
    buffer_load_dwordx4 v9, s[24:27], s51 offen lds
    s_add_u32 s51, s51, 8192
    s_cmp_eq_u32 s51, s69
    s_cselect_b32 s51, s52, s51
    s_setprio 3
    v_and_b32 v135, 15, v135
    v_cmp_ne_u32 vcc, s47, v134
    v_cmp_ne_u32 s[48:49], s100, v135
    s_or_b64 s[48:49], s[48:49], vcc
    s_cselect_b32 s101, 0, 1
    s_mov_b32 s48, 0xbdd2d3e8
    s_mov_b32 s49, 0xbdd2d3e8
    v_pk_fma_f32 v[48:49], v[48:49], v[10:11], v[16:17] op_sel_hi:[1,0,1]
    v_pk_fma_f32 v[50:51], v[50:51], v[10:11], v[18:19] op_sel_hi:[1,0,1]
    v_pk_fma_f32 v[52:53], v[52:53], v[10:11], v[20:21] op_sel_hi:[1,0,1]
    v_pk_fma_f32 v[54:55], v[54:55], v[10:11], v[22:23] op_sel_hi:[1,0,1]
    v_pk_mul_f32 v[136:137], v[48:49], v[48:49]
    v_pk_mul_f32 v[138:139], v[50:51], v[50:51]
    v_pk_mul_f32 v[140:141], v[52:53], v[52:53]
    v_pk_mul_f32 v[142:143], v[54:55], v[54:55]
    v_pk_fma_f32 v[136:137], v[136:137], s[48:49], v[128:129]
    v_pk_fma_f32 v[138:139], v[138:139], s[48:49], v[128:129]
    v_pk_fma_f32 v[140:141], v[140:141], s[48:49], v[128:129]
    v_pk_fma_f32 v[142:143], v[142:143], s[48:49], v[128:129]
    v_pk_mul_f32 v[136:137], v[136:137], v[48:49]
    v_pk_mul_f32 v[138:139], v[138:139], v[50:51]
    v_pk_mul_f32 v[140:141], v[140:141], v[52:53]
    v_pk_mul_f32 v[142:143], v[142:143], v[54:55]
    v_exp_f32 v136, v136
    v_exp_f32 v138, v138
    v_exp_f32 v140, v140
    v_exp_f32 v142, v142
    v_exp_f32 v137, v137
    v_exp_f32 v139, v139
    v_exp_f32 v141, v141
    v_exp_f32 v143, v143
    v_pk_add_f32 v[136:137], v[136:137], 1.0 op_sel_hi:[1,0]
    v_pk_add_f32 v[138:139], v[138:139], 1.0 op_sel_hi:[1,0]
    v_pk_add_f32 v[140:141], v[140:141], 1.0 op_sel_hi:[1,0]
    v_pk_add_f32 v[142:143], v[142:143], 1.0 op_sel_hi:[1,0]
    v_rcp_f32 v136, v136
    v_rcp_f32 v138, v138
    v_rcp_f32 v140, v140
    v_rcp_f32 v142, v142
    v_rcp_f32 v137, v137
    v_rcp_f32 v139, v139
    v_rcp_f32 v141, v141
    v_rcp_f32 v143, v143
    v_pk_mul_f32 v[48:49], v[48:49], v[136:137]
    v_pk_mul_f32 v[50:51], v[50:51], v[138:139]
    v_pk_mul_f32 v[52:53], v[52:53], v[140:141]
    v_pk_mul_f32 v[54:55], v[54:55], v[142:143]
    v_cvt_pk_bf16_f32 v160, v48, v49
    v_cvt_pk_bf16_f32 v161, v50, v51
    v_cvt_pk_bf16_f32 v162, v52, v53
    v_cvt_pk_bf16_f32 v163, v54, v55
    buffer_store_dwordx4 v[160:163], v2, s[8:11], s96 offen offset:0 sc1
    v_pk_fma_f32 v[56:57], v[56:57], v[10:11], v[24:25] op_sel_hi:[1,0,1]
    v_pk_fma_f32 v[58:59], v[58:59], v[10:11], v[26:27] op_sel_hi:[1,0,1]
    v_pk_fma_f32 v[60:61], v[60:61], v[10:11], v[28:29] op_sel_hi:[1,0,1]
    v_pk_fma_f32 v[62:63], v[62:63], v[10:11], v[30:31] op_sel_hi:[1,0,1]
    v_pk_mul_f32 v[136:137], v[56:57], v[56:57]
    v_pk_mul_f32 v[138:139], v[58:59], v[58:59]
    v_pk_mul_f32 v[140:141], v[60:61], v[60:61]
    v_pk_mul_f32 v[142:143], v[62:63], v[62:63]
    v_pk_fma_f32 v[136:137], v[136:137], s[48:49], v[128:129]
    v_pk_fma_f32 v[138:139], v[138:139], s[48:49], v[128:129]
    v_pk_fma_f32 v[140:141], v[140:141], s[48:49], v[128:129]
    v_pk_fma_f32 v[142:143], v[142:143], s[48:49], v[128:129]
    v_pk_mul_f32 v[136:137], v[136:137], v[56:57]
    v_pk_mul_f32 v[138:139], v[138:139], v[58:59]
    v_pk_mul_f32 v[140:141], v[140:141], v[60:61]
    v_pk_mul_f32 v[142:143], v[142:143], v[62:63]
    v_exp_f32 v136, v136
    v_exp_f32 v138, v138
    v_exp_f32 v140, v140
    v_exp_f32 v142, v142
    v_exp_f32 v137, v137
    v_exp_f32 v139, v139
    v_exp_f32 v141, v141
    v_exp_f32 v143, v143
    v_pk_add_f32 v[136:137], v[136:137], 1.0 op_sel_hi:[1,0]
    v_pk_add_f32 v[138:139], v[138:139], 1.0 op_sel_hi:[1,0]
    v_pk_add_f32 v[140:141], v[140:141], 1.0 op_sel_hi:[1,0]
    v_pk_add_f32 v[142:143], v[142:143], 1.0 op_sel_hi:[1,0]
    v_rcp_f32 v136, v136
    v_rcp_f32 v138, v138
    v_rcp_f32 v140, v140
    v_rcp_f32 v142, v142
    v_rcp_f32 v137, v137
    v_rcp_f32 v139, v139
    v_rcp_f32 v141, v141
    v_rcp_f32 v143, v143
    v_pk_mul_f32 v[56:57], v[56:57], v[136:137]
    v_pk_mul_f32 v[58:59], v[58:59], v[138:139]
    v_pk_mul_f32 v[60:61], v[60:61], v[140:141]
    v_pk_mul_f32 v[62:63], v[62:63], v[142:143]
    v_cvt_pk_bf16_f32 v164, v56, v57
    v_cvt_pk_bf16_f32 v165, v58, v59
    v_cvt_pk_bf16_f32 v166, v60, v61
    v_cvt_pk_bf16_f32 v167, v62, v63
    buffer_store_dwordx4 v[164:167], v2, s[8:11], s96 offen offset:2048 sc1
    v_pk_fma_f32 v[64:65], v[64:65], v[14:15], v[16:17] op_sel_hi:[1,0,1]
    v_pk_fma_f32 v[66:67], v[66:67], v[14:15], v[18:19] op_sel_hi:[1,0,1]
    v_pk_fma_f32 v[68:69], v[68:69], v[14:15], v[20:21] op_sel_hi:[1,0,1]
    v_pk_fma_f32 v[70:71], v[70:71], v[14:15], v[22:23] op_sel_hi:[1,0,1]
    v_pk_mul_f32 v[136:137], v[64:65], v[64:65]
    v_pk_mul_f32 v[138:139], v[66:67], v[66:67]
    v_pk_mul_f32 v[140:141], v[68:69], v[68:69]
    v_pk_mul_f32 v[142:143], v[70:71], v[70:71]
    v_pk_fma_f32 v[136:137], v[136:137], s[48:49], v[128:129]
    v_pk_fma_f32 v[138:139], v[138:139], s[48:49], v[128:129]
    v_pk_fma_f32 v[140:141], v[140:141], s[48:49], v[128:129]
    v_pk_fma_f32 v[142:143], v[142:143], s[48:49], v[128:129]
    v_pk_mul_f32 v[136:137], v[136:137], v[64:65]
    v_pk_mul_f32 v[138:139], v[138:139], v[66:67]
    v_pk_mul_f32 v[140:141], v[140:141], v[68:69]
    v_pk_mul_f32 v[142:143], v[142:143], v[70:71]
    v_exp_f32 v136, v136
    v_exp_f32 v138, v138
    v_exp_f32 v140, v140
    v_exp_f32 v142, v142
    v_exp_f32 v137, v137
    v_exp_f32 v139, v139
    v_exp_f32 v141, v141
    v_exp_f32 v143, v143
    v_pk_add_f32 v[136:137], v[136:137], 1.0 op_sel_hi:[1,0]
    v_pk_add_f32 v[138:139], v[138:139], 1.0 op_sel_hi:[1,0]
    v_pk_add_f32 v[140:141], v[140:141], 1.0 op_sel_hi:[1,0]
    v_pk_add_f32 v[142:143], v[142:143], 1.0 op_sel_hi:[1,0]
    v_rcp_f32 v136, v136
    v_rcp_f32 v138, v138
    v_rcp_f32 v140, v140
    v_rcp_f32 v142, v142
    v_rcp_f32 v137, v137
    v_rcp_f32 v139, v139
    v_rcp_f32 v141, v141
    v_rcp_f32 v143, v143
    v_pk_mul_f32 v[64:65], v[64:65], v[136:137]
    v_pk_mul_f32 v[66:67], v[66:67], v[138:139]
    v_pk_mul_f32 v[68:69], v[68:69], v[140:141]
    v_pk_mul_f32 v[70:71], v[70:71], v[142:143]
    v_cvt_pk_bf16_f32 v168, v64, v65
    v_cvt_pk_bf16_f32 v169, v66, v67
    v_cvt_pk_bf16_f32 v170, v68, v69
    v_cvt_pk_bf16_f32 v171, v70, v71
    buffer_store_dwordx4 v[168:171], v2, s[8:11], s97 offen offset:0 sc1
    v_pk_fma_f32 v[72:73], v[72:73], v[14:15], v[24:25] op_sel_hi:[1,0,1]
    v_pk_fma_f32 v[74:75], v[74:75], v[14:15], v[26:27] op_sel_hi:[1,0,1]
    v_pk_fma_f32 v[76:77], v[76:77], v[14:15], v[28:29] op_sel_hi:[1,0,1]
    v_pk_fma_f32 v[78:79], v[78:79], v[14:15], v[30:31] op_sel_hi:[1,0,1]
    v_pk_mul_f32 v[136:137], v[72:73], v[72:73]
    v_pk_mul_f32 v[138:139], v[74:75], v[74:75]
    v_pk_mul_f32 v[140:141], v[76:77], v[76:77]
    v_pk_mul_f32 v[142:143], v[78:79], v[78:79]
    v_pk_fma_f32 v[136:137], v[136:137], s[48:49], v[128:129]
    v_pk_fma_f32 v[138:139], v[138:139], s[48:49], v[128:129]
    v_pk_fma_f32 v[140:141], v[140:141], s[48:49], v[128:129]
    v_pk_fma_f32 v[142:143], v[142:143], s[48:49], v[128:129]
    v_pk_mul_f32 v[136:137], v[136:137], v[72:73]
    v_pk_mul_f32 v[138:139], v[138:139], v[74:75]
    v_pk_mul_f32 v[140:141], v[140:141], v[76:77]
    v_pk_mul_f32 v[142:143], v[142:143], v[78:79]
    v_exp_f32 v136, v136
    v_exp_f32 v138, v138
    v_exp_f32 v140, v140
    v_exp_f32 v142, v142
    v_exp_f32 v137, v137
    v_exp_f32 v139, v139
    v_exp_f32 v141, v141
    v_exp_f32 v143, v143
    v_pk_add_f32 v[136:137], v[136:137], 1.0 op_sel_hi:[1,0]
    v_pk_add_f32 v[138:139], v[138:139], 1.0 op_sel_hi:[1,0]
    v_pk_add_f32 v[140:141], v[140:141], 1.0 op_sel_hi:[1,0]
    v_pk_add_f32 v[142:143], v[142:143], 1.0 op_sel_hi:[1,0]
    v_rcp_f32 v136, v136
    v_rcp_f32 v138, v138
    v_rcp_f32 v140, v140
    v_rcp_f32 v142, v142
    v_rcp_f32 v137, v137
    v_rcp_f32 v139, v139
    v_rcp_f32 v141, v141
    v_rcp_f32 v143, v143
    v_pk_mul_f32 v[72:73], v[72:73], v[136:137]
    v_pk_mul_f32 v[74:75], v[74:75], v[138:139]
    v_pk_mul_f32 v[76:77], v[76:77], v[140:141]
    v_pk_mul_f32 v[78:79], v[78:79], v[142:143]
    v_cvt_pk_bf16_f32 v172, v72, v73
    v_cvt_pk_bf16_f32 v173, v74, v75
    v_cvt_pk_bf16_f32 v174, v76, v77
    v_cvt_pk_bf16_f32 v175, v78, v79
    buffer_store_dwordx4 v[172:175], v2, s[8:11], s97 offen offset:2048 sc1
    s_cmp_eq_u32 s60, 0
    s_cbranch_scc1 L_nohalf
    v_pk_fma_f32 v[80:81], v[80:81], v[10:11], v[32:33] op_sel_hi:[1,0,1]
    v_pk_fma_f32 v[82:83], v[82:83], v[10:11], v[34:35] op_sel_hi:[1,0,1]
    v_pk_fma_f32 v[84:85], v[84:85], v[10:11], v[36:37] op_sel_hi:[1,0,1]
    v_pk_fma_f32 v[86:87], v[86:87], v[10:11], v[38:39] op_sel_hi:[1,0,1]
    v_pk_mul_f32 v[136:137], v[80:81], v[80:81]
    v_pk_mul_f32 v[138:139], v[82:83], v[82:83]
    v_pk_mul_f32 v[140:141], v[84:85], v[84:85]
    v_pk_mul_f32 v[142:143], v[86:87], v[86:87]
    v_pk_fma_f32 v[136:137], v[136:137], s[48:49], v[128:129]
    v_pk_fma_f32 v[138:139], v[138:139], s[48:49], v[128:129]
    v_pk_fma_f32 v[140:141], v[140:141], s[48:49], v[128:129]
    v_pk_fma_f32 v[142:143], v[142:143], s[48:49], v[128:129]
    v_pk_mul_f32 v[136:137], v[136:137], v[80:81]
    v_pk_mul_f32 v[138:139], v[138:139], v[82:83]
    v_pk_mul_f32 v[140:141], v[140:141], v[84:85]
    v_pk_mul_f32 v[142:143], v[142:143], v[86:87]
    v_exp_f32 v136, v136
    v_exp_f32 v138, v138
    v_exp_f32 v140, v140
    v_exp_f32 v142, v142
    v_exp_f32 v137, v137
    v_exp_f32 v139, v139
    v_exp_f32 v141, v141
    v_exp_f32 v143, v143
    v_pk_add_f32 v[136:137], v[136:137], 1.0 op_sel_hi:[1,0]
    v_pk_add_f32 v[138:139], v[138:139], 1.0 op_sel_hi:[1,0]
    v_pk_add_f32 v[140:141], v[140:141], 1.0 op_sel_hi:[1,0]
    v_pk_add_f32 v[142:143], v[142:143], 1.0 op_sel_hi:[1,0]
    v_rcp_f32 v136, v136
    v_rcp_f32 v138, v138
    v_rcp_f32 v140, v140
    v_rcp_f32 v142, v142
    v_rcp_f32 v137, v137
    v_rcp_f32 v139, v139
    v_rcp_f32 v141, v141
    v_rcp_f32 v143, v143
    v_pk_mul_f32 v[80:81], v[80:81], v[136:137]
    v_pk_mul_f32 v[82:83], v[82:83], v[138:139]
    v_pk_mul_f32 v[84:85], v[84:85], v[140:141]
    v_pk_mul_f32 v[86:87], v[86:87], v[142:143]
    v_cvt_pk_bf16_f32 v176, v80, v81
    v_cvt_pk_bf16_f32 v177, v82, v83
    v_cvt_pk_bf16_f32 v178, v84, v85
    v_cvt_pk_bf16_f32 v179, v86, v87
    buffer_store_dwordx4 v[176:179], v2, s[8:11], s98 offen offset:0 sc1
    v_pk_fma_f32 v[88:89], v[88:89], v[10:11], v[40:41] op_sel_hi:[1,0,1]
    v_pk_fma_f32 v[90:91], v[90:91], v[10:11], v[42:43] op_sel_hi:[1,0,1]
    v_pk_fma_f32 v[92:93], v[92:93], v[10:11], v[44:45] op_sel_hi:[1,0,1]
    v_pk_fma_f32 v[94:95], v[94:95], v[10:11], v[46:47] op_sel_hi:[1,0,1]
    v_pk_mul_f32 v[136:137], v[88:89], v[88:89]
    v_pk_mul_f32 v[138:139], v[90:91], v[90:91]
    v_pk_mul_f32 v[140:141], v[92:93], v[92:93]
    v_pk_mul_f32 v[142:143], v[94:95], v[94:95]
    v_pk_fma_f32 v[136:137], v[136:137], s[48:49], v[128:129]
    v_pk_fma_f32 v[138:139], v[138:139], s[48:49], v[128:129]
    v_pk_fma_f32 v[140:141], v[140:141], s[48:49], v[128:129]
    v_pk_fma_f32 v[142:143], v[142:143], s[48:49], v[128:129]
    v_pk_mul_f32 v[136:137], v[136:137], v[88:89]
    v_pk_mul_f32 v[138:139], v[138:139], v[90:91]
    v_pk_mul_f32 v[140:141], v[140:141], v[92:93]
    v_pk_mul_f32 v[142:143], v[142:143], v[94:95]
    v_exp_f32 v136, v136
    v_exp_f32 v138, v138
    v_exp_f32 v140, v140
    v_exp_f32 v142, v142
    v_exp_f32 v137, v137
    v_exp_f32 v139, v139
    v_exp_f32 v141, v141
    v_exp_f32 v143, v143
    v_pk_add_f32 v[136:137], v[136:137], 1.0 op_sel_hi:[1,0]
    v_pk_add_f32 v[138:139], v[138:139], 1.0 op_sel_hi:[1,0]
    v_pk_add_f32 v[140:141], v[140:141], 1.0 op_sel_hi:[1,0]
    v_pk_add_f32 v[142:143], v[142:143], 1.0 op_sel_hi:[1,0]
    v_rcp_f32 v136, v136
    v_rcp_f32 v138, v138
    v_rcp_f32 v140, v140
    v_rcp_f32 v142, v142
    v_rcp_f32 v137, v137
    v_rcp_f32 v139, v139
    v_rcp_f32 v141, v141
    v_rcp_f32 v143, v143
    v_pk_mul_f32 v[88:89], v[88:89], v[136:137]
    v_pk_mul_f32 v[90:91], v[90:91], v[138:139]
    v_pk_mul_f32 v[92:93], v[92:93], v[140:141]
    v_pk_mul_f32 v[94:95], v[94:95], v[142:143]
    v_cvt_pk_bf16_f32 v180, v88, v89
    v_cvt_pk_bf16_f32 v181, v90, v91
    v_cvt_pk_bf16_f32 v182, v92, v93
    v_cvt_pk_bf16_f32 v183, v94, v95
    buffer_store_dwordx4 v[180:183], v2, s[8:11], s98 offen offset:2048 sc1
L_nohalf:
    s_lshl_b32 s56, s45, 7
    s_add_u32 s56, s56, 8192
    s_lshl_b32 s3, s46, 2
    s_add_u32 s3, s3, s53
    s_lshl_b32 s3, s3, 2
    s_add_u32 s57, s56, s3
    s_mul_i32 s62, s53, 16640
    s_lshl_b32 s61, s53, 17
    s_lshl_b32 s60, s0, 11
    s_waitcnt vmcnt(0)
    s_mov_b64 exec, 1
    s_cmp_lg_u32 s101, 0
    s_cbranch_scc0 L_ds_50
    buffer_store_dword v238, v239, s[8:11], s57 offen
L_de_51:
    s_mov_b64 exec, -1
    s_lshr_b32 s58, s69, 3
    s_add_u32 s58, s58, s99
    s_lshr_b32 s59, s52, 3
    s_add_u32 s59, s59, s99
    s_mov_b32 s54, 1048576
L_fw_52:
    buffer_load_dword v19, v237, s[8:11], s56 offen sc1
    s_waitcnt vmcnt(0)
    v_cmp_ne_u32 vcc, s47, v19
    s_cbranch_vccz L_fd_53
    s_sleep 2
    s_sub_u32 s54, s54, 1
    s_cmp_lg_u32 s54, 0
    s_cbranch_scc1 L_fw_52
L_fd_53:
    s_setprio 0
    buffer_load_dwordx4 v[128:131], v2, s[8:11], s67 offen sc1
    buffer_load_dwordx4 v[132:135], v2, s[8:11], s67 offen offset:1024 sc1
    s_add_u32 s67, s67, 2048
    s_cmp_eq_u32 s67, s58
    s_cselect_b32 s67, s59, s67
    buffer_load_dwordx4 v[136:139], v2, s[8:11], s67 offen sc1
    buffer_load_dwordx4 v[140:143], v2, s[8:11], s67 offen offset:1024 sc1
    s_add_u32 s67, s67, 2048
    s_cmp_eq_u32 s67, s58
    s_cselect_b32 s67, s59, s67
    buffer_load_dwordx4 v[144:147], v2, s[8:11], s67 offen sc1
    buffer_load_dwordx4 v[148:151], v2, s[8:11], s67 offen offset:1024 sc1
    s_add_u32 s67, s67, 2048
    s_cmp_eq_u32 s67, s58
    s_cselect_b32 s67, s59, s67
    buffer_load_dwordx4 v[152:155], v2, s[8:11], s67 offen sc1
    buffer_load_dwordx4 v[156:159], v2, s[8:11], s67 offen offset:1024 sc1
    s_add_u32 s67, s67, 2048
    s_cmp_eq_u32 s67, s58
    s_cselect_b32 s67, s59, s67
    ds_read_b64_tr_b16 v[112:113], v232 offset:12288
    ds_read_b64_tr_b16 v[114:115], v232 offset:13312
    ds_read_b64_tr_b16 v[116:117], v233 offset:12288
    ds_read_b64_tr_b16 v[118:119], v233 offset:13312
    ds_read_b64_tr_b16 v[120:121], v232 offset:14336
    ds_read_b64_tr_b16 v[122:123], v232 offset:15360
    ds_read_b64_tr_b16 v[124:125], v233 offset:14336
    ds_read_b64_tr_b16 v[126:127], v233 offset:15360
    s_waitcnt vmcnt(6)
    s_waitcnt lgkmcnt(4)
    v_mfma_f32_32x32x16_bf16 v[48:63], v[112:115], v[128:131], 0
    v_mfma_f32_32x32x16_bf16 v[64:79], v[116:119], v[128:131], 0
    v_mfma_f32_32x32x16_bf16 v[80:95], v[112:115], v[132:135], 0
    v_mfma_f32_32x32x16_bf16 v[96:111], v[116:119], v[132:135], 0
    buffer_load_dwordx4 v[128:131], v2, s[8:11], s67 offen sc1
    buffer_load_dwordx4 v[132:135], v2, s[8:11], s67 offen offset:1024 sc1
    s_add_u32 s67, s67, 2048
    s_cmp_eq_u32 s67, s58
    s_cselect_b32 s67, s59, s67
    ds_read_b64_tr_b16 v[112:113], v232 offset:0
    ds_read_b64_tr_b16 v[114:115], v232 offset:1024
    ds_read_b64_tr_b16 v[116:117], v233 offset:0
    ds_read_b64_tr_b16 v[118:119], v233 offset:1024
    s_waitcnt vmcnt(6)
    s_waitcnt lgkmcnt(4)
    v_mfma_f32_32x32x16_bf16 v[48:63], v[120:123], v[136:139], v[48:63]
    v_mfma_f32_32x32x16_bf16 v[64:79], v[124:127], v[136:139], v[64:79]
    v_mfma_f32_32x32x16_bf16 v[80:95], v[120:123], v[140:143], v[80:95]
    v_mfma_f32_32x32x16_bf16 v[96:111], v[124:127], v[140:143], v[96:111]
    buffer_load_dwordx4 v[136:139], v2, s[8:11], s67 offen sc1
    buffer_load_dwordx4 v[140:143], v2, s[8:11], s67 offen offset:1024 sc1
    s_add_u32 s67, s67, 2048
    s_cmp_eq_u32 s67, s58
    s_cselect_b32 s67, s59, s67
    ds_read_b64_tr_b16 v[120:121], v232 offset:2048
    ds_read_b64_tr_b16 v[122:123], v232 offset:3072
    ds_read_b64_tr_b16 v[124:125], v233 offset:2048
    ds_read_b64_tr_b16 v[126:127], v233 offset:3072
    s_waitcnt vmcnt(6)
    s_waitcnt lgkmcnt(4)
    v_mfma_f32_32x32x16_bf16 v[48:63], v[112:115], v[144:147], v[48:63]
    v_mfma_f32_32x32x16_bf16 v[64:79], v[116:119], v[144:147], v[64:79]
    v_mfma_f32_32x32x16_bf16 v[80:95], v[112:115], v[148:151], v[80:95]
    v_mfma_f32_32x32x16_bf16 v[96:111], v[116:119], v[148:151], v[96:111]
    buffer_load_dwordx4 v[144:147], v2, s[8:11], s67 offen sc1
    buffer_load_dwordx4 v[148:151], v2, s[8:11], s67 offen offset:1024 sc1
    s_add_u32 s67, s67, 2048
    s_cmp_eq_u32 s67, s58
    s_cselect_b32 s67, s59, s67
    ds_read_b64_tr_b16 v[112:113], v232 offset:4096
    ds_read_b64_tr_b16 v[114:115], v232 offset:5120
    ds_read_b64_tr_b16 v[116:117], v233 offset:4096
    ds_read_b64_tr_b16 v[118:119], v233 offset:5120
    s_waitcnt vmcnt(6)
    s_waitcnt lgkmcnt(4)
    v_mfma_f32_32x32x16_bf16 v[48:63], v[120:123], v[152:155], v[48:63]
    v_mfma_f32_32x32x16_bf16 v[64:79], v[124:127], v[152:155], v[64:79]
    v_mfma_f32_32x32x16_bf16 v[80:95], v[120:123], v[156:159], v[80:95]
    v_mfma_f32_32x32x16_bf16 v[96:111], v[124:127], v[156:159], v[96:111]
    buffer_load_dwordx4 v[152:155], v2, s[8:11], s67 offen sc1
    buffer_load_dwordx4 v[156:159], v2, s[8:11], s67 offen offset:1024 sc1
    s_add_u32 s67, s67, 2048
    s_cmp_eq_u32 s67, s58
    s_cselect_b32 s67, s59, s67
    ds_read_b64_tr_b16 v[120:121], v232 offset:6144
    ds_read_b64_tr_b16 v[122:123], v232 offset:7168
    ds_read_b64_tr_b16 v[124:125], v233 offset:6144
    ds_read_b64_tr_b16 v[126:127], v233 offset:7168
    s_waitcnt vmcnt(6)
    s_waitcnt lgkmcnt(4)
    v_mfma_f32_32x32x16_bf16 v[48:63], v[112:115], v[128:131], v[48:63]
    v_mfma_f32_32x32x16_bf16 v[64:79], v[116:119], v[128:131], v[64:79]
    v_mfma_f32_32x32x16_bf16 v[80:95], v[112:115], v[132:135], v[80:95]
    v_mfma_f32_32x32x16_bf16 v[96:111], v[116:119], v[132:135], v[96:111]
    buffer_load_dwordx4 v[128:131], v2, s[8:11], s67 offen sc1
    buffer_load_dwordx4 v[132:135], v2, s[8:11], s67 offen offset:1024 sc1
    s_add_u32 s67, s67, 2048
    s_cmp_eq_u32 s67, s58
    s_cselect_b32 s67, s59, s67
    s_add_u32 m0, s62, 0
    s_nop 0
    buffer_load_dwordx4 v9, s[24:27], s51 offen lds
    s_add_u32 s51, s51, 8192
    s_add_u32 m0, s62, 1024
    s_nop 0
    buffer_load_dwordx4 v9, s[24:27], s51 offen lds
    s_add_u32 s51, s51, 8192
    s_cmp_eq_u32 s51, s69
    s_cselect_b32 s51, s52, s51
    ds_read_b64_tr_b16 v[112:113], v232 offset:8192
    ds_read_b64_tr_b16 v[114:115], v232 offset:9216
    ds_read_b64_tr_b16 v[116:117], v233 offset:8192
    ds_read_b64_tr_b16 v[118:119], v233 offset:9216
    s_waitcnt vmcnt(8)
    s_waitcnt lgkmcnt(4)
    v_mfma_f32_32x32x16_bf16 v[48:63], v[120:123], v[136:139], v[48:63]
    v_mfma_f32_32x32x16_bf16 v[64:79], v[124:127], v[136:139], v[64:79]
    v_mfma_f32_32x32x16_bf16 v[80:95], v[120:123], v[140:143], v[80:95]
    v_mfma_f32_32x32x16_bf16 v[96:111], v[124:127], v[140:143], v[96:111]
    buffer_load_dwordx4 v[136:139], v2, s[8:11], s67 offen sc1
    buffer_load_dwordx4 v[140:143], v2, s[8:11], s67 offen offset:1024 sc1
    s_add_u32 s67, s67, 2048
    s_cmp_eq_u32 s67, s58
    s_cselect_b32 s67, s59, s67
    s_add_u32 m0, s62, 2048
    s_nop 0
    buffer_load_dwordx4 v9, s[24:27], s51 offen lds
    s_add_u32 s51, s51, 8192
    s_add_u32 m0, s62, 3072
    s_nop 0
    buffer_load_dwordx4 v9, s[24:27], s51 offen lds
    s_add_u32 s51, s51, 8192
    s_cmp_eq_u32 s51, s69
    s_cselect_b32 s51, s52, s51
    ds_read_b64_tr_b16 v[120:121], v232 offset:10240
    ds_read_b64_tr_b16 v[122:123], v232 offset:11264
    ds_read_b64_tr_b16 v[124:125], v233 offset:10240
    ds_read_b64_tr_b16 v[126:127], v233 offset:11264
    s_waitcnt vmcnt(10)
    s_waitcnt lgkmcnt(4)
    v_mfma_f32_32x32x16_bf16 v[48:63], v[112:115], v[144:147], v[48:63]
    v_mfma_f32_32x32x16_bf16 v[64:79], v[116:119], v[144:147], v[64:79]
    v_mfma_f32_32x32x16_bf16 v[80:95], v[112:115], v[148:151], v[80:95]
    v_mfma_f32_32x32x16_bf16 v[96:111], v[116:119], v[148:151], v[96:111]
    buffer_load_dwordx4 v[144:147], v2, s[8:11], s67 offen sc1
    buffer_load_dwordx4 v[148:151], v2, s[8:11], s67 offen offset:1024 sc1
    s_add_u32 s67, s67, 2048
    s_cmp_eq_u32 s67, s58
    s_cselect_b32 s67, s59, s67
    s_add_u32 m0, s62, 4096
    s_nop 0
    buffer_load_dwordx4 v9, s[24:27], s51 offen lds
    s_add_u32 s51, s51, 8192
    s_add_u32 m0, s62, 5120
    s_nop 0
    buffer_load_dwordx4 v9, s[24:27], s51 offen lds
    s_add_u32 s51, s51, 8192
    s_cmp_eq_u32 s51, s69
    s_cselect_b32 s51, s52, s51
    s_waitcnt vmcnt(8)
    ds_read_b64_tr_b16 v[112:113], v234 offset:0
    ds_read_b64_tr_b16 v[114:115], v234 offset:1024
    ds_read_b64_tr_b16 v[116:117], v235 offset:0
    ds_read_b64_tr_b16 v[118:119], v235 offset:1024
    s_waitcnt lgkmcnt(4)
    v_mfma_f32_32x32x16_bf16 v[48:63], v[120:123], v[152:155], v[48:63]
    v_mfma_f32_32x32x16_bf16 v[64:79], v[124:127], v[152:155], v[64:79]
    v_mfma_f32_32x32x16_bf16 v[80:95], v[120:123], v[156:159], v[80:95]
    v_mfma_f32_32x32x16_bf16 v[96:111], v[124:127], v[156:159], v[96:111]
    buffer_load_dwordx4 v[152:155], v2, s[8:11], s67 offen sc1
    buffer_load_dwordx4 v[156:159], v2, s[8:11], s67 offen offset:1024 sc1
    s_add_u32 s67, s67, 2048
    s_cmp_eq_u32 s67, s58
    s_cselect_b32 s67, s59, s67
    s_add_u32 m0, s62, 6144
    s_nop 0
    buffer_load_dwordx4 v9, s[24:27], s51 offen lds
    s_add_u32 s51, s51, 8192
    s_add_u32 m0, s62, 7168
    s_nop 0
    buffer_load_dwordx4 v9, s[24:27], s51 offen lds
    s_add_u32 s51, s51, 8192
    s_cmp_eq_u32 s51, s69
    s_cselect_b32 s51, s52, s51
    s_waitcnt vmcnt(8)
    ds_read_b64_tr_b16 v[120:121], v234 offset:2048
    ds_read_b64_tr_b16 v[122:123], v234 offset:3072
    ds_read_b64_tr_b16 v[124:125], v235 offset:2048
    ds_read_b64_tr_b16 v[126:127], v235 offset:3072
    s_waitcnt lgkmcnt(4)
    v_mfma_f32_32x32x16_bf16 v[48:63], v[112:115], v[128:131], v[48:63]
    v_mfma_f32_32x32x16_bf16 v[64:79], v[116:119], v[128:131], v[64:79]
    v_mfma_f32_32x32x16_bf16 v[80:95], v[112:115], v[132:135], v[80:95]
    v_mfma_f32_32x32x16_bf16 v[96:111], v[116:119], v[132:135], v[96:111]
    buffer_load_dwordx4 v[128:131], v2, s[8:11], s67 offen sc1
    buffer_load_dwordx4 v[132:135], v2, s[8:11], s67 offen offset:1024 sc1
    s_add_u32 s67, s67, 2048
    s_cmp_eq_u32 s67, s58
    s_cselect_b32 s67, s59, s67
    s_add_u32 m0, s62, 8192
    s_nop 0
    buffer_load_dwordx4 v9, s[24:27], s51 offen lds
    s_add_u32 s51, s51, 8192
    s_add_u32 m0, s62, 9216
    s_nop 0
    buffer_load_dwordx4 v9, s[24:27], s51 offen lds
    s_add_u32 s51, s51, 8192
    s_cmp_eq_u32 s51, s69
    s_cselect_b32 s51, s52, s51
    s_waitcnt vmcnt(8)
    ds_read_b64_tr_b16 v[112:113], v234 offset:4096
    ds_read_b64_tr_b16 v[114:115], v234 offset:5120
    ds_read_b64_tr_b16 v[116:117], v235 offset:4096
    ds_read_b64_tr_b16 v[118:119], v235 offset:5120
    s_waitcnt lgkmcnt(4)
    v_mfma_f32_32x32x16_bf16 v[48:63], v[120:123], v[136:139], v[48:63]
    v_mfma_f32_32x32x16_bf16 v[64:79], v[124:127], v[136:139], v[64:79]
    v_mfma_f32_32x32x16_bf16 v[80:95], v[120:123], v[140:143], v[80:95]
    v_mfma_f32_32x32x16_bf16 v[96:111], v[124:127], v[140:143], v[96:111]
    buffer_load_dwordx4 v[136:139], v2, s[8:11], s67 offen sc1
    buffer_load_dwordx4 v[140:143], v2, s[8:11], s67 offen offset:1024 sc1
    s_add_u32 s67, s67, 2048
    s_cmp_eq_u32 s67, s58
    s_cselect_b32 s67, s59, s67
    s_add_u32 m0, s62, 10240
    s_nop 0
    buffer_load_dwordx4 v9, s[24:27], s51 offen lds
    s_add_u32 s51, s51, 8192
    s_add_u32 m0, s62, 11264
    s_nop 0
    buffer_load_dwordx4 v9, s[24:27], s51 offen lds
    s_add_u32 s51, s51, 8192
    s_cmp_eq_u32 s51, s69
    s_cselect_b32 s51, s52, s51
    s_waitcnt vmcnt(8)
    ds_read_b64_tr_b16 v[120:121], v234 offset:6144
    ds_read_b64_tr_b16 v[122:123], v234 offset:7168
    ds_read_b64_tr_b16 v[124:125], v235 offset:6144
    ds_read_b64_tr_b16 v[126:127], v235 offset:7168
    s_waitcnt lgkmcnt(4)
    v_mfma_f32_32x32x16_bf16 v[48:63], v[112:115], v[144:147], v[48:63]
    v_mfma_f32_32x32x16_bf16 v[64:79], v[116:119], v[144:147], v[64:79]
    v_mfma_f32_32x32x16_bf16 v[80:95], v[112:115], v[148:151], v[80:95]
    v_mfma_f32_32x32x16_bf16 v[96:111], v[116:119], v[148:151], v[96:111]
    buffer_load_dwordx4 v[144:147], v2, s[8:11], s67 offen sc1
    buffer_load_dwordx4 v[148:151], v2, s[8:11], s67 offen offset:1024 sc1
    s_add_u32 s67, s67, 2048
    s_cmp_eq_u32 s67, s58
    s_cselect_b32 s67, s59, s67
    s_add_u32 m0, s62, 12288
    s_nop 0
    buffer_load_dwordx4 v9, s[24:27], s51 offen lds
    s_add_u32 s51, s51, 8192
    s_add_u32 m0, s62, 13312
    s_nop 0
    buffer_load_dwordx4 v9, s[24:27], s51 offen lds
    s_add_u32 s51, s51, 8192
    s_cmp_eq_u32 s51, s69
    s_cselect_b32 s51, s52, s51
    s_waitcnt vmcnt(8)
    ds_read_b64_tr_b16 v[112:113], v234 offset:8192
    ds_read_b64_tr_b16 v[114:115], v234 offset:9216
    ds_read_b64_tr_b16 v[116:117], v235 offset:8192
    ds_read_b64_tr_b16 v[118:119], v235 offset:9216
    s_waitcnt lgkmcnt(4)
    v_mfma_f32_32x32x16_bf16 v[48:63], v[120:123], v[152:155], v[48:63]
    v_mfma_f32_32x32x16_bf16 v[64:79], v[124:127], v[152:155], v[64:79]
    v_mfma_f32_32x32x16_bf16 v[80:95], v[120:123], v[156:159], v[80:95]
    v_mfma_f32_32x32x16_bf16 v[96:111], v[124:127], v[156:159], v[96:111]
    buffer_load_dwordx4 v[152:155], v2, s[8:11], s67 offen sc1
    buffer_load_dwordx4 v[156:159], v2, s[8:11], s67 offen offset:1024 sc1
    s_add_u32 s67, s67, 2048
    s_cmp_eq_u32 s67, s58
    s_cselect_b32 s67, s59, s67
    s_add_u32 m0, s62, 14336
    s_nop 0
    buffer_load_dwordx4 v9, s[24:27], s51 offen lds
    s_add_u32 s51, s51, 8192
    s_add_u32 m0, s62, 15360
    s_nop 0
    buffer_load_dwordx4 v9, s[24:27], s51 offen lds
    s_add_u32 s51, s51, 8192
    s_cmp_eq_u32 s51, s69
    s_cselect_b32 s51, s52, s51
    s_waitcnt vmcnt(8)
    ds_read_b64_tr_b16 v[120:121], v234 offset:10240
    ds_read_b64_tr_b16 v[122:123], v234 offset:11264
    ds_read_b64_tr_b16 v[124:125], v235 offset:10240
    ds_read_b64_tr_b16 v[126:127], v235 offset:11264
    s_waitcnt lgkmcnt(4)
    v_mfma_f32_32x32x16_bf16 v[48:63], v[112:115], v[128:131], v[48:63]
    v_mfma_f32_32x32x16_bf16 v[64:79], v[116:119], v[128:131], v[64:79]
    v_mfma_f32_32x32x16_bf16 v[80:95], v[112:115], v[132:135], v[80:95]
    v_mfma_f32_32x32x16_bf16 v[96:111], v[116:119], v[132:135], v[96:111]
    buffer_load_dwordx4 v[128:131], v2, s[8:11], s67 offen sc1
    buffer_load_dwordx4 v[132:135], v2, s[8:11], s67 offen offset:1024 sc1
    s_add_u32 s67, s67, 2048
    s_cmp_eq_u32 s67, s58
    s_cselect_b32 s67, s59, s67
    s_add_u32 m0, s62, 0
    s_nop 0
    buffer_load_dwordx4 v9, s[24:27], s51 offen lds
    s_add_u32 s51, s51, 8192
    s_add_u32 m0, s62, 1024
    s_nop 0
    buffer_load_dwordx4 v9, s[24:27], s51 offen lds
    s_add_u32 s51, s51, 8192
    s_cmp_eq_u32 s51, s69
    s_cselect_b32 s51, s52, s51
    s_waitcnt vmcnt(8)
    ds_read_b64_tr_b16 v[112:113], v234 offset:12288
    ds_read_b64_tr_b16 v[114:115], v234 offset:13312
    ds_read_b64_tr_b16 v[116:117], v235 offset:12288
    ds_read_b64_tr_b16 v[118:119], v235 offset:13312
    s_waitcnt lgkmcnt(4)
    v_mfma_f32_32x32x16_bf16 v[48:63], v[120:123], v[136:139], v[48:63]
    v_mfma_f32_32x32x16_bf16 v[64:79], v[124:127], v[136:139], v[64:79]
    v_mfma_f32_32x32x16_bf16 v[80:95], v[120:123], v[140:143], v[80:95]
    v_mfma_f32_32x32x16_bf16 v[96:111], v[124:127], v[140:143], v[96:111]
    buffer_load_dwordx4 v[136:139], v2, s[8:11], s67 offen sc1
    buffer_load_dwordx4 v[140:143], v2, s[8:11], s67 offen offset:1024 sc1
    s_add_u32 s67, s67, 2048
    s_cmp_eq_u32 s67, s58
    s_cselect_b32 s67, s59, s67
    s_add_u32 m0, s62, 2048
    s_nop 0
    buffer_load_dwordx4 v9, s[24:27], s51 offen lds
    s_add_u32 s51, s51, 8192
    s_add_u32 m0, s62, 3072
    s_nop 0
    buffer_load_dwordx4 v9, s[24:27], s51 offen lds
    s_add_u32 s51, s51, 8192
    s_cmp_eq_u32 s51, s69
    s_cselect_b32 s51, s52, s51
    s_add_u32 m0, s63, s60
    s_lshl_b32 s3, s60, 3
    s_add_u32 s3, s3, s61
    buffer_load_dwordx4 v236, s[28:31], s3 offen lds
    s_add_u32 s60, s60, 1024
    s_and_b32 s60, s60, 0x3fff
    s_add_u32 m0, s63, s60
    s_lshl_b32 s3, s60, 3
    s_add_u32 s3, s3, s61
    buffer_load_dwordx4 v236, s[28:31], s3 offen lds
    s_add_u32 s60, s60, 1024
    s_and_b32 s60, s60, 0x3fff
    s_waitcnt vmcnt(10)
    ds_read_b64_tr_b16 v[120:121], v234 offset:14336
    ds_read_b64_tr_b16 v[122:123], v234 offset:15360
    ds_read_b64_tr_b16 v[124:125], v235 offset:14336
    ds_read_b64_tr_b16 v[126:127], v235 offset:15360
    s_waitcnt lgkmcnt(4)
    v_mfma_f32_32x32x16_bf16 v[48:63], v[112:115], v[144:147], v[48:63]
    v_mfma_f32_32x32x16_bf16 v[64:79], v[116:119], v[144:147], v[64:79]
    v_mfma_f32_32x32x16_bf16 v[80:95], v[112:115], v[148:151], v[80:95]
    v_mfma_f32_32x32x16_bf16 v[96:111], v[116:119], v[148:151], v[96:111]
    buffer_load_dwordx4 v[144:147], v2, s[8:11], s67 offen sc1
    buffer_load_dwordx4 v[148:151], v2, s[8:11], s67 offen offset:1024 sc1
    s_add_u32 s67, s67, 2048
    s_cmp_eq_u32 s67, s58
    s_cselect_b32 s67, s59, s67
    s_add_u32 m0, s62, 4096
    s_nop 0
    buffer_load_dwordx4 v9, s[24:27], s51 offen lds
    s_add_u32 s51, s51, 8192
    s_add_u32 m0, s62, 5120
    s_nop 0
    buffer_load_dwordx4 v9, s[24:27], s51 offen lds
    s_add_u32 s51, s51, 8192
    s_cmp_eq_u32 s51, s69
    s_cselect_b32 s51, s52, s51
    s_add_u32 m0, s63, s60
    s_lshl_b32 s3, s60, 3
    s_add_u32 s3, s3, s61
    buffer_load_dwordx4 v236, s[28:31], s3 offen lds
    s_add_u32 s60, s60, 1024
    s_and_b32 s60, s60, 0x3fff
    s_add_u32 m0, s63, s60
    s_lshl_b32 s3, s60, 3
    s_add_u32 s3, s3, s61
    buffer_load_dwordx4 v236, s[28:31], s3 offen lds
    s_add_u32 s60, s60, 1024
    s_and_b32 s60, s60, 0x3fff
    s_waitcnt vmcnt(12)
    ds_read_b64_tr_b16 v[112:113], v234 offset:0
    ds_read_b64_tr_b16 v[114:115], v234 offset:1024
    ds_read_b64_tr_b16 v[116:117], v235 offset:0
    ds_read_b64_tr_b16 v[118:119], v235 offset:1024
    s_waitcnt lgkmcnt(4)
    v_mfma_f32_32x32x16_bf16 v[48:63], v[120:123], v[152:155], v[48:63]
    v_mfma_f32_32x32x16_bf16 v[64:79], v[124:127], v[152:155], v[64:79]
    v_mfma_f32_32x32x16_bf16 v[80:95], v[120:123], v[156:159], v[80:95]
    v_mfma_f32_32x32x16_bf16 v[96:111], v[124:127], v[156:159], v[96:111]
    buffer_load_dwordx4 v[152:155], v2, s[8:11], s67 offen sc1
    buffer_load_dwordx4 v[156:159], v2, s[8:11], s67 offen offset:1024 sc1
    s_add_u32 s67, s67, 2048
    s_cmp_eq_u32 s67, s58
    s_cselect_b32 s67, s59, s67
    s_add_u32 m0, s62, 6144
    s_nop 0
    buffer_load_dwordx4 v9, s[24:27], s51 offen lds
    s_add_u32 s51, s51, 8192
    s_add_u32 m0, s62, 7168
    s_nop 0
    buffer_load_dwordx4 v9, s[24:27], s51 offen lds
    s_add_u32 s51, s51, 8192
    s_cmp_eq_u32 s51, s69
    s_cselect_b32 s51, s52, s51
    s_add_u32 m0, s63, s60
    s_lshl_b32 s3, s60, 3
    s_add_u32 s3, s3, s61
    buffer_load_dwordx4 v236, s[28:31], s3 offen lds
    s_add_u32 s60, s60, 1024
    s_and_b32 s60, s60, 0x3fff
    s_add_u32 m0, s63, s60
    s_lshl_b32 s3, s60, 3
    s_add_u32 s3, s3, s61
    buffer_load_dwordx4 v236, s[28:31], s3 offen lds
    s_add_u32 s60, s60, 1024
    s_and_b32 s60, s60, 0x3fff
    s_waitcnt vmcnt(14)
    ds_read_b64_tr_b16 v[120:121], v234 offset:2048
    ds_read_b64_tr_b16 v[122:123], v234 offset:3072
    ds_read_b64_tr_b16 v[124:125], v235 offset:2048
    ds_read_b64_tr_b16 v[126:127], v235 offset:3072
    s_waitcnt lgkmcnt(4)
    v_mfma_f32_32x32x16_bf16 v[48:63], v[112:115], v[128:131], v[48:63]
    v_mfma_f32_32x32x16_bf16 v[64:79], v[116:119], v[128:131], v[64:79]
    v_mfma_f32_32x32x16_bf16 v[80:95], v[112:115], v[132:135], v[80:95]
    v_mfma_f32_32x32x16_bf16 v[96:111], v[116:119], v[132:135], v[96:111]
    buffer_load_dwordx4 v[128:131], v2, s[8:11], s67 offen sc1
    buffer_load_dwordx4 v[132:135], v2, s[8:11], s67 offen offset:1024 sc1
    s_add_u32 s67, s67, 2048
    s_cmp_eq_u32 s67, s58
    s_cselect_b32 s67, s59, s67
    s_add_u32 m0, s62, 8192
    s_nop 0
    buffer_load_dwordx4 v9, s[24:27], s51 offen lds
    s_add_u32 s51, s51, 8192
    s_add_u32 m0, s62, 9216
    s_nop 0
    buffer_load_dwordx4 v9, s[24:27], s51 offen lds
    s_add_u32 s51, s51, 8192
    s_cmp_eq_u32 s51, s69
    s_cselect_b32 s51, s52, s51
    s_add_u32 m0, s63, s60
    s_lshl_b32 s3, s60, 3
    s_add_u32 s3, s3, s61
    buffer_load_dwordx4 v236, s[28:31], s3 offen lds
    s_add_u32 s60, s60, 1024
    s_and_b32 s60, s60, 0x3fff
    s_add_u32 m0, s63, s60
    s_lshl_b32 s3, s60, 3
    s_add_u32 s3, s3, s61
    buffer_load_dwordx4 v236, s[28:31], s3 offen lds
    s_add_u32 s60, s60, 1024
    s_and_b32 s60, s60, 0x3fff
    s_waitcnt vmcnt(14)
    ds_read_b64_tr_b16 v[112:113], v234 offset:4096
    ds_read_b64_tr_b16 v[114:115], v234 offset:5120
    ds_read_b64_tr_b16 v[116:117], v235 offset:4096
    ds_read_b64_tr_b16 v[118:119], v235 offset:5120
    s_waitcnt lgkmcnt(4)
    v_mfma_f32_32x32x16_bf16 v[48:63], v[120:123], v[136:139], v[48:63]
    v_mfma_f32_32x32x16_bf16 v[64:79], v[124:127], v[136:139], v[64:79]
    v_mfma_f32_32x32x16_bf16 v[80:95], v[120:123], v[140:143], v[80:95]
    v_mfma_f32_32x32x16_bf16 v[96:111], v[124:127], v[140:143], v[96:111]
    buffer_load_dwordx4 v[136:139], v2, s[8:11], s67 offen sc1
    buffer_load_dwordx4 v[140:143], v2, s[8:11], s67 offen offset:1024 sc1
    s_add_u32 s67, s67, 2048
    s_cmp_eq_u32 s67, s58
    s_cselect_b32 s67, s59, s67
    s_add_u32 m0, s62, 10240
    s_nop 0
    buffer_load_dwordx4 v9, s[24:27], s51 offen lds
    s_add_u32 s51, s51, 8192
    s_add_u32 m0, s62, 11264
    s_nop 0
    buffer_load_dwordx4 v9, s[24:27], s51 offen lds
    s_add_u32 s51, s51, 8192
    s_cmp_eq_u32 s51, s69
    s_cselect_b32 s51, s52, s51
    s_add_u32 m0, s63, s60
    s_lshl_b32 s3, s60, 3
    s_add_u32 s3, s3, s61
    buffer_load_dwordx4 v236, s[28:31], s3 offen lds
    s_add_u32 s60, s60, 1024
    s_and_b32 s60, s60, 0x3fff
    s_add_u32 m0, s63, s60
    s_lshl_b32 s3, s60, 3
    s_add_u32 s3, s3, s61
    buffer_load_dwordx4 v236, s[28:31], s3 offen lds
    s_add_u32 s60, s60, 1024
    s_and_b32 s60, s60, 0x3fff
    s_waitcnt vmcnt(14)
    ds_read_b64_tr_b16 v[120:121], v234 offset:6144
    ds_read_b64_tr_b16 v[122:123], v234 offset:7168
    ds_read_b64_tr_b16 v[124:125], v235 offset:6144
    ds_read_b64_tr_b16 v[126:127], v235 offset:7168
    s_waitcnt lgkmcnt(4)
    v_mfma_f32_32x32x16_bf16 v[48:63], v[112:115], v[144:147], v[48:63]
    v_mfma_f32_32x32x16_bf16 v[64:79], v[116:119], v[144:147], v[64:79]
    v_mfma_f32_32x32x16_bf16 v[80:95], v[112:115], v[148:151], v[80:95]
    v_mfma_f32_32x32x16_bf16 v[96:111], v[116:119], v[148:151], v[96:111]
    s_add_u32 m0, s63, s60
    s_lshl_b32 s3, s60, 3
    s_add_u32 s3, s3, s61
    buffer_load_dwordx4 v236, s[28:31], s3 offen lds
    s_add_u32 s60, s60, 1024
    s_and_b32 s60, s60, 0x3fff
    s_add_u32 m0, s63, s60
    s_lshl_b32 s3, s60, 3
    s_add_u32 s3, s3, s61
    buffer_load_dwordx4 v236, s[28:31], s3 offen lds
    s_add_u32 s60, s60, 1024
    s_and_b32 s60, s60, 0x3fff
    s_waitcnt vmcnt(10)
    ds_read_b64_tr_b16 v[112:113], v234 offset:8192
    ds_read_b64_tr_b16 v[114:115], v234 offset:9216
    ds_read_b64_tr_b16 v[116:117], v235 offset:8192
    ds_read_b64_tr_b16 v[118:119], v235 offset:9216
    s_waitcnt lgkmcnt(4)
    v_mfma_f32_32x32x16_bf16 v[48:63], v[120:123], v[152:155], v[48:63]
    v_mfma_f32_32x32x16_bf16 v[64:79], v[124:127], v[152:155], v[64:79]
    v_mfma_f32_32x32x16_bf16 v[80:95], v[120:123], v[156:159], v[80:95]
    v_mfma_f32_32x32x16_bf16 v[96:111], v[124:127], v[156:159], v[96:111]
    s_add_u32 m0, s63, s60
    s_lshl_b32 s3, s60, 3
    s_add_u32 s3, s3, s61
    buffer_load_dwordx4 v236, s[28:31], s3 offen lds
    s_add_u32 s60, s60, 1024
    s_and_b32 s60, s60, 0x3fff
    s_add_u32 m0, s63, s60
    s_lshl_b32 s3, s60, 3
    s_add_u32 s3, s3, s61
    buffer_load_dwordx4 v236, s[28:31], s3 offen lds
    s_add_u32 s60, s60, 1024
    s_and_b32 s60, s60, 0x3fff
    s_waitcnt vmcnt(6)
    ds_read_b64_tr_b16 v[120:121], v234 offset:10240
    ds_read_b64_tr_b16 v[122:123], v234 offset:11264
    ds_read_b64_tr_b16 v[124:125], v235 offset:10240
    ds_read_b64_tr_b16 v[126:127], v235 offset:11264
    s_waitcnt lgkmcnt(4)
    v_mfma_f32_32x32x16_bf16 v[48:63], v[112:115], v[128:131], v[48:63]
    v_mfma_f32_32x32x16_bf16 v[64:79], v[116:119], v[128:131], v[64:79]
    v_mfma_f32_32x32x16_bf16 v[80:95], v[112:115], v[132:135], v[80:95]
    v_mfma_f32_32x32x16_bf16 v[96:111], v[116:119], v[132:135], v[96:111]
    s_add_u32 m0, s63, s60
    s_lshl_b32 s3, s60, 3
    s_add_u32 s3, s3, s61
    buffer_load_dwordx4 v236, s[28:31], s3 offen lds
    s_add_u32 s60, s60, 1024
    s_and_b32 s60, s60, 0x3fff
    s_add_u32 m0, s63, s60
    s_lshl_b32 s3, s60, 3
    s_add_u32 s3, s3, s61
    buffer_load_dwordx4 v236, s[28:31], s3 offen lds
    s_add_u32 s60, s60, 1024
    s_and_b32 s60, s60, 0x3fff
    s_waitcnt lgkmcnt(0)
    s_cmp_ge_u32 s53, 2
    s_cbranch_scc1 L_skip21
    v_mfma_f32_32x32x16_bf16 v[48:63], v[120:123], v[136:139], v[48:63]
    v_mfma_f32_32x32x16_bf16 v[64:79], v[124:127], v[136:139], v[64:79]
    v_mfma_f32_32x32x16_bf16 v[80:95], v[120:123], v[140:143], v[80:95]
    v_mfma_f32_32x32x16_bf16 v[96:111], v[124:127], v[140:143], v[96:111]
L_skip21:
    s_setprio 3
    s_nop 7
    ds_write_b128 v240, v[48:51] offset:0
    s_nop 0
    ds_write_b128 v240, v[80:83] offset:8192
    ds_write_b128 v248, v[52:55] offset:0
    ds_write_b128 v248, v[84:87] offset:8192
    ds_write_b128 v249, v[56:59] offset:0
    ds_write_b128 v249, v[88:91] offset:8192
    ds_write_b128 v250, v[60:63] offset:0
    ds_write_b128 v250, v[92:95] offset:8192
    ds_write_b128 v251, v[64:67] offset:0
    ds_write_b128 v251, v[96:99] offset:8192
    ds_write_b128 v252, v[68:71] offset:0
    ds_write_b128 v252, v[100:103] offset:8192
    ds_write_b128 v253, v[72:75] offset:0
    ds_write_b128 v253, v[104:107] offset:8192
    ds_write_b128 v254, v[76:79] offset:0
    ds_write_b128 v254, v[108:111] offset:8192
    s_waitcnt vmcnt(0)
    s_mov_b64 exec, 1
    ds_add_u32 v12, v13 offset:20
    s_mov_b64 exec, -1
    s_mov_b32 s54, 1048576
L_cw_54:
    ds_read_b32 v8, v12 offset:20
    s_waitcnt lgkmcnt(0)
    v_readfirstlane_b32 s55, v8
    s_cmp_ge_u32 s55, 4
    s_cbranch_scc1 L_cd_55
    s_sleep 2
    s_sub_u32 s54, s54, 1
    s_cmp_lg_u32 s54, 0
    s_cbranch_scc1 L_cw_54
L_cd_55:
    ds_read_b128 v[128:131], v241 offset:0
    ds_read_b128 v[132:135], v241 offset:16640
    ds_read_b128 v[136:139], v241 offset:33280
    ds_read_b128 v[140:143], v241 offset:49920
    v_xor_b32 v6, 64, v241
    ds_read_b128 v[144:147], v6 offset:0
    ds_read_b128 v[148:151], v6 offset:16640
    ds_read_b128 v[152:155], v6 offset:33280
    ds_read_b128 v[156:159], v6 offset:49920
    v_xor_b32 v6, 128, v241
    ds_read_b128 v[160:163], v6 offset:0
    ds_read_b128 v[164:167], v6 offset:16640
    ds_read_b128 v[168:171], v6 offset:33280
    ds_read_b128 v[172:175], v6 offset:49920
    v_xor_b32 v6, 192, v241
    ds_read_b128 v[176:179], v6 offset:0
    ds_read_b128 v[180:183], v6 offset:16640
    ds_read_b128 v[184:187], v6 offset:33280
    ds_read_b128 v[188:191], v6 offset:49920
    s_mov_b32 s48, 0xbfb8aa3b
    s_mov_b32 s49, 0xbfb8aa3b
    v_mov_b32 v8, s101
L_g_x:
    s_waitcnt lgkmcnt(0)
    s_mov_b64 exec, 1
    ds_max_u32 v12, v8 offset:12
    ds_add_u32 v12, v13 offset:8
    s_mov_b64 exec, -1
    s_setprio 0
    ds_read_b64_tr_b16 v[16:17], v244 offset:24576
    ds_read_b64_tr_b16 v[18:19], v244 offset:25600
    ds_read_b64_tr_b16 v[20:21], v245 offset:24576
    ds_read_b64_tr_b16 v[22:23], v245 offset:25600
    ds_read_b64_tr_b16 v[24:25], v246 offset:24576
    ds_read_b64_tr_b16 v[26:27], v246 offset:25600
    ds_read_b64_tr_b16 v[28:29], v247 offset:24576
    ds_read_b64_tr_b16 v[30:31], v247 offset:25600
    ds_read_b64_tr_b16 v[32:33], v244 offset:28672
    ds_read_b64_tr_b16 v[34:35], v244 offset:29696
    ds_read_b64_tr_b16 v[36:37], v245 offset:28672
    ds_read_b64_tr_b16 v[38:39], v245 offset:29696
    ds_read_b64_tr_b16 v[40:41], v246 offset:28672
    ds_read_b64_tr_b16 v[42:43], v246 offset:29696
    ds_read_b64_tr_b16 v[44:45], v247 offset:28672
    ds_read_b64_tr_b16 v[46:47], v247 offset:29696
    ds_read_b64_tr_b16 v[48:49], v244 offset:32768
    ds_read_b64_tr_b16 v[50:51], v244 offset:33792
    ds_read_b64_tr_b16 v[52:53], v245 offset:32768
    ds_read_b64_tr_b16 v[54:55], v245 offset:33792
    ds_read_b64_tr_b16 v[56:57], v246 offset:32768
    ds_read_b64_tr_b16 v[58:59], v246 offset:33792
    ds_read_b64_tr_b16 v[60:61], v247 offset:32768
    ds_read_b64_tr_b16 v[62:63], v247 offset:33792
    ds_read_b64_tr_b16 v[64:65], v244 offset:36864
    ds_read_b64_tr_b16 v[66:67], v244 offset:37888
    ds_read_b64_tr_b16 v[68:69], v245 offset:36864
    ds_read_b64_tr_b16 v[70:71], v245 offset:37888
    ds_read_b64_tr_b16 v[72:73], v246 offset:36864
    ds_read_b64_tr_b16 v[74:75], v246 offset:37888
    ds_read_b64_tr_b16 v[76:77], v247 offset:36864
    ds_read_b64_tr_b16 v[78:79], v247 offset:37888
    ds_read_b64_tr_b16 v[80:81], v244 offset:40960
    ds_read_b64_tr_b16 v[82:83], v244 offset:41984
    ds_read_b64_tr_b16 v[84:85], v245 offset:40960
    ds_read_b64_tr_b16 v[86:87], v245 offset:41984
    ds_read_b64_tr_b16 v[88:89], v246 offset:40960
    ds_read_b64_tr_b16 v[90:91], v246 offset:41984
    ds_read_b64_tr_b16 v[92:93], v247 offset:40960
    ds_read_b64_tr_b16 v[94:95], v247 offset:41984
    ds_read_b64_tr_b16 v[96:97], v244 offset:45056
    ds_read_b64_tr_b16 v[98:99], v244 offset:46080
    ds_read_b64_tr_b16 v[100:101], v245 offset:45056
    ds_read_b64_tr_b16 v[102:103], v245 offset:46080
    ds_read_b64_tr_b16 v[104:105], v246 offset:45056
    ds_read_b64_tr_b16 v[106:107], v246 offset:46080
    ds_read_b64_tr_b16 v[108:109], v247 offset:45056
    ds_read_b64_tr_b16 v[110:111], v247 offset:46080
    ds_read_b64_tr_b16 v[112:113], v244 offset:49152
    ds_read_b64_tr_b16 v[114:115], v244 offset:50176
    ds_read_b64_tr_b16 v[116:117], v245 offset:49152
    ds_read_b64_tr_b16 v[118:119], v245 offset:50176
    ds_read_b64_tr_b16 v[120:121], v246 offset:49152
    ds_read_b64_tr_b16 v[122:123], v246 offset:50176
    ds_read_b64_tr_b16 v[124:125], v247 offset:49152
    ds_read_b64_tr_b16 v[126:127], v247 offset:50176
    s_lshl_b32 s58, s45, 7
    s_add_u32 s58, s58, 12288
    s_lshl_b32 s59, s45, 16
    s_add_u32 s59, s59, 262144
    s_barrier
    ds_read_b32 v6, v12 offset:24
    s_waitcnt lgkmcnt(0)
    v_readfirstlane_b32 s3, v6
    s_cmp_eq_u32 s3, 0
    s_cbranch_scc1 L_final
    s_barrier
    s_barrier
L_final:
    v_pk_add_f32 v[208:209], v[208:209], v[128:129]
    v_pk_add_f32 v[210:211], v[210:211], v[130:131]
    v_pk_add_f32 v[212:213], v[212:213], v[144:145]
    v_pk_add_f32 v[214:215], v[214:215], v[146:147]
    v_pk_add_f32 v[208:209], v[208:209], v[132:133]
    v_pk_add_f32 v[210:211], v[210:211], v[134:135]
    v_pk_add_f32 v[212:213], v[212:213], v[148:149]
    v_pk_add_f32 v[214:215], v[214:215], v[150:151]
    v_pk_add_f32 v[208:209], v[208:209], v[136:137]
    v_pk_add_f32 v[210:211], v[210:211], v[138:139]
    v_pk_add_f32 v[212:213], v[212:213], v[152:153]
    v_pk_add_f32 v[214:215], v[214:215], v[154:155]
    v_pk_add_f32 v[208:209], v[208:209], v[140:141]
    v_pk_add_f32 v[210:211], v[210:211], v[142:143]
    v_pk_add_f32 v[212:213], v[212:213], v[156:157]
    v_pk_add_f32 v[214:215], v[214:215], v[158:159]
    v_pk_mul_f32 v[192:193], v[208:209], s[48:49]
    v_pk_mul_f32 v[194:195], v[210:211], s[48:49]
    v_pk_mul_f32 v[196:197], v[212:213], s[48:49]
    v_pk_mul_f32 v[198:199], v[214:215], s[48:49]
    v_exp_f32 v192, v192
    v_exp_f32 v194, v194
    v_exp_f32 v196, v196
    v_exp_f32 v198, v198
    v_exp_f32 v193, v193
    v_exp_f32 v195, v195
    v_exp_f32 v197, v197
    v_exp_f32 v199, v199
    v_pk_add_f32 v[192:193], v[192:193], 1.0 op_sel_hi:[1,0]
    v_pk_add_f32 v[194:195], v[194:195], 1.0 op_sel_hi:[1,0]
    v_pk_add_f32 v[196:197], v[196:197], 1.0 op_sel_hi:[1,0]
    v_pk_add_f32 v[198:199], v[198:199], 1.0 op_sel_hi:[1,0]
    v_rcp_f32 v192, v192
    v_rcp_f32 v194, v194
    v_rcp_f32 v196, v196
    v_rcp_f32 v198, v198
    v_rcp_f32 v193, v193
    v_rcp_f32 v195, v195
    v_rcp_f32 v197, v197
    v_rcp_f32 v199, v199
    v_pk_mul_f32 v[208:209], v[208:209], v[192:193]
    v_pk_mul_f32 v[210:211], v[210:211], v[194:195]
    v_pk_mul_f32 v[212:213], v[212:213], v[196:197]
    v_pk_mul_f32 v[214:215], v[214:215], v[198:199]
    v_pk_add_f32 v[216:217], v[216:217], v[160:161]
    v_pk_add_f32 v[218:219], v[218:219], v[162:163]
    v_pk_add_f32 v[220:221], v[220:221], v[176:177]
    v_pk_add_f32 v[222:223], v[222:223], v[178:179]
    v_pk_add_f32 v[216:217], v[216:217], v[164:165]
    v_pk_add_f32 v[218:219], v[218:219], v[166:167]
    v_pk_add_f32 v[220:221], v[220:221], v[180:181]
    v_pk_add_f32 v[222:223], v[222:223], v[182:183]
    v_pk_add_f32 v[216:217], v[216:217], v[168:169]
    v_pk_add_f32 v[218:219], v[218:219], v[170:171]
    v_pk_add_f32 v[220:221], v[220:221], v[184:185]
    v_pk_add_f32 v[222:223], v[222:223], v[186:187]
    v_pk_add_f32 v[216:217], v[216:217], v[172:173]
    v_pk_add_f32 v[218:219], v[218:219], v[174:175]
    v_pk_add_f32 v[220:221], v[220:221], v[188:189]
    v_pk_add_f32 v[222:223], v[222:223], v[190:191]
    v_pk_mul_f32 v[192:193], v[216:217], s[48:49]
    v_pk_mul_f32 v[194:195], v[218:219], s[48:49]
    v_pk_mul_f32 v[196:197], v[220:221], s[48:49]
    v_pk_mul_f32 v[198:199], v[222:223], s[48:49]
    v_exp_f32 v192, v192
    v_exp_f32 v194, v194
    v_exp_f32 v196, v196
    v_exp_f32 v198, v198
    v_exp_f32 v193, v193
    v_exp_f32 v195, v195
    v_exp_f32 v197, v197
    v_exp_f32 v199, v199
    v_pk_add_f32 v[192:193], v[192:193], 1.0 op_sel_hi:[1,0]
    v_pk_add_f32 v[194:195], v[194:195], 1.0 op_sel_hi:[1,0]
    v_pk_add_f32 v[196:197], v[196:197], 1.0 op_sel_hi:[1,0]
    v_pk_add_f32 v[198:199], v[198:199], 1.0 op_sel_hi:[1,0]
    v_rcp_f32 v192, v192
    v_rcp_f32 v194, v194
    v_rcp_f32 v196, v196
    v_rcp_f32 v198, v198
    v_rcp_f32 v193, v193
    v_rcp_f32 v195, v195
    v_rcp_f32 v197, v197
    v_rcp_f32 v199, v199
    v_pk_mul_f32 v[216:217], v[216:217], v[192:193]
    v_pk_mul_f32 v[218:219], v[218:219], v[194:195]
    v_pk_mul_f32 v[220:221], v[220:221], v[196:197]
    v_pk_mul_f32 v[222:223], v[222:223], v[198:199]
    v_lshlrev_b32 v232, 16, v224
    v_and_b32 v233, 0xffff0000, v224
    v_lshlrev_b32 v234, 16, v225
    v_and_b32 v235, 0xffff0000, v225
    v_lshlrev_b32 v238, 16, v226
    v_and_b32 v239, 0xffff0000, v226
    v_lshlrev_b32 v240, 16, v227
    v_and_b32 v241, 0xffff0000, v227
    v_lshlrev_b32 v248, 16, v228
    v_and_b32 v249, 0xffff0000, v228
    v_lshlrev_b32 v250, 16, v229
    v_and_b32 v251, 0xffff0000, v229
    v_lshlrev_b32 v252, 16, v230
    v_and_b32 v253, 0xffff0000, v230
    v_lshlrev_b32 v254, 16, v231
    v_and_b32 v255, 0xffff0000, v231
    v_lshrrev_b32 v8, 4, v1
    v_and_b32 v9, 1, v8
    v_lshrrev_b32 v10, 1, v8
    v_lshlrev_b32 v8, 3, v8
    v_sub_u32 v243, v243, v8
    v_lshl_add_u32 v243, v9, 5, v243
    v_lshl_add_u32 v243, v10, 4, v243
    buffer_load_dword v8, v237, s[8:11], s58 offen sc1
    s_waitcnt vmcnt(0)
    v_cmp_ne_u32 vcc, s47, v8
    s_mov_b32 s54, 1048576
    s_and_b32 s3, vcc_lo, 0xfffff000
    s_cbranch_scc0 L_od_57
L_ow_56:
    buffer_load_dword v8, v237, s[8:11], s58 offen sc1
    s_waitcnt vmcnt(0)
    v_cmp_ne_u32 vcc, s47, v8
    s_sub_u32 s54, s54, 1
    s_cselect_b64 vcc, 0, vcc
    s_and_b32 s3, vcc_lo, 0xfffff000
    s_cbranch_scc1 L_ow_56
L_od_57:
    s_add_u32 s3, s59, 24576
    buffer_load_dwordx4 v[128:131], v242, s[8:11], s3 offen sc1
    s_add_u32 s3, s59, 28672
    buffer_load_dwordx4 v[132:135], v242, s[8:11], s3 offen sc1
    s_add_u32 s3, s59, 32768
    buffer_load_dwordx4 v[136:139], v242, s[8:11], s3 offen sc1
    s_add_u32 s3, s59, 36864
    buffer_load_dwordx4 v[140:143], v242, s[8:11], s3 offen sc1
    s_waitcnt vmcnt(3)
    v_mfma_f32_16x16x32_bf16 v[192:195], v[16:19], v[128:131], 0
    ds_read_b64_tr_b16 v[16:17], v244 offset:53248
    ds_read_b64_tr_b16 v[18:19], v244 offset:54272
    s_add_u32 s3, s59, 40960
    buffer_load_dwordx4 v[144:147], v242, s[8:11], s3 offen sc1
    v_mfma_f32_16x16x32_bf16 v[196:199], v[20:23], v[128:131], 0
    ds_read_b64_tr_b16 v[20:21], v245 offset:53248
    ds_read_b64_tr_b16 v[22:23], v245 offset:54272
    v_mfma_f32_16x16x32_bf16 v[200:203], v[24:27], v[128:131], 0
    ds_read_b64_tr_b16 v[24:25], v246 offset:53248
    ds_read_b64_tr_b16 v[26:27], v246 offset:54272
    v_mfma_f32_16x16x32_bf16 v[204:207], v[28:31], v[128:131], 0
    ds_read_b64_tr_b16 v[28:29], v247 offset:53248
    ds_read_b64_tr_b16 v[30:31], v247 offset:54272
    s_waitcnt vmcnt(3)
    v_mfma_f32_16x16x32_bf16 v[192:195], v[32:35], v[132:135], v[192:195]
    ds_read_b64_tr_b16 v[32:33], v244 offset:57344
    ds_read_b64_tr_b16 v[34:35], v244 offset:58368
    s_add_u32 s3, s59, 45056
    buffer_load_dwordx4 v[148:151], v242, s[8:11], s3 offen sc1
    v_mfma_f32_16x16x32_bf16 v[196:199], v[36:39], v[132:135], v[196:199]
    ds_read_b64_tr_b16 v[36:37], v245 offset:57344
    ds_read_b64_tr_b16 v[38:39], v245 offset:58368
    v_mfma_f32_16x16x32_bf16 v[200:203], v[40:43], v[132:135], v[200:203]
    ds_read_b64_tr_b16 v[40:41], v246 offset:57344
    ds_read_b64_tr_b16 v[42:43], v246 offset:58368
    v_mfma_f32_16x16x32_bf16 v[204:207], v[44:47], v[132:135], v[204:207]
    ds_read_b64_tr_b16 v[44:45], v247 offset:57344
    ds_read_b64_tr_b16 v[46:47], v247 offset:58368
    s_waitcnt vmcnt(3)
    v_mfma_f32_16x16x32_bf16 v[192:195], v[48:51], v[136:139], v[192:195]
    ds_read_b64_tr_b16 v[48:49], v244 offset:61440
    ds_read_b64_tr_b16 v[50:51], v244 offset:62464
    s_add_u32 s3, s59, 49152
    buffer_load_dwordx4 v[152:155], v242, s[8:11], s3 offen sc1
    v_mfma_f32_16x16x32_bf16 v[196:199], v[52:55], v[136:139], v[196:199]
    ds_read_b64_tr_b16 v[52:53], v245 offset:61440
    ds_read_b64_tr_b16 v[54:55], v245 offset:62464
    v_mfma_f32_16x16x32_bf16 v[200:203], v[56:59], v[136:139], v[200:203]
    ds_read_b64_tr_b16 v[56:57], v246 offset:61440
    ds_read_b64_tr_b16 v[58:59], v246 offset:62464
    v_mfma_f32_16x16x32_bf16 v[204:207], v[60:63], v[136:139], v[204:207]
    ds_read_b64_tr_b16 v[60:61], v247 offset:61440
    ds_read_b64_tr_b16 v[62:63], v247 offset:62464
    s_waitcnt vmcnt(3)
    v_mfma_f32_16x16x32_bf16 v[192:195], v[64:67], v[140:143], v[192:195]
    ds_read_b64_tr_b16 v[64:65], v244 offset:0
    ds_read_b64_tr_b16 v[66:67], v244 offset:1024
    s_add_u32 s3, s59, 53248
    buffer_load_dwordx4 v[156:159], v242, s[8:11], s3 offen sc1
    v_mfma_f32_16x16x32_bf16 v[196:199], v[68:71], v[140:143], v[196:199]
    ds_read_b64_tr_b16 v[68:69], v245 offset:0
    ds_read_b64_tr_b16 v[70:71], v245 offset:1024
    v_mfma_f32_16x16x32_bf16 v[200:203], v[72:75], v[140:143], v[200:203]
    ds_read_b64_tr_b16 v[72:73], v246 offset:0
    ds_read_b64_tr_b16 v[74:75], v246 offset:1024
    v_mfma_f32_16x16x32_bf16 v[204:207], v[76:79], v[140:143], v[204:207]
    ds_read_b64_tr_b16 v[76:77], v247 offset:0
    ds_read_b64_tr_b16 v[78:79], v247 offset:1024
    s_waitcnt vmcnt(3)
    v_mfma_f32_16x16x32_bf16 v[192:195], v[80:83], v[144:147], v[192:195]
    ds_read_b64_tr_b16 v[80:81], v244 offset:4096
    ds_read_b64_tr_b16 v[82:83], v244 offset:5120
    s_add_u32 s3, s59, 57344
    buffer_load_dwordx4 v[160:163], v242, s[8:11], s3 offen sc1
    v_mfma_f32_16x16x32_bf16 v[196:199], v[84:87], v[144:147], v[196:199]
    ds_read_b64_tr_b16 v[84:85], v245 offset:4096
    ds_read_b64_tr_b16 v[86:87], v245 offset:5120
    v_mfma_f32_16x16x32_bf16 v[200:203], v[88:91], v[144:147], v[200:203]
    ds_read_b64_tr_b16 v[88:89], v246 offset:4096
    ds_read_b64_tr_b16 v[90:91], v246 offset:5120
    v_mfma_f32_16x16x32_bf16 v[204:207], v[92:95], v[144:147], v[204:207]
    ds_read_b64_tr_b16 v[92:93], v247 offset:4096
    ds_read_b64_tr_b16 v[94:95], v247 offset:5120
    s_waitcnt vmcnt(3)
    v_mfma_f32_16x16x32_bf16 v[192:195], v[96:99], v[148:151], v[192:195]
    ds_read_b64_tr_b16 v[96:97], v244 offset:8192
    ds_read_b64_tr_b16 v[98:99], v244 offset:9216
    s_add_u32 s3, s59, 61440
    buffer_load_dwordx4 v[164:167], v242, s[8:11], s3 offen sc1
    buffer_load_dword v8, v237, s[8:11], s58 offen sc1
    v_mfma_f32_16x16x32_bf16 v[196:199], v[100:103], v[148:151], v[196:199]
    ds_read_b64_tr_b16 v[100:101], v245 offset:8192
    ds_read_b64_tr_b16 v[102:103], v245 offset:9216
    v_mfma_f32_16x16x32_bf16 v[200:203], v[104:107], v[148:151], v[200:203]
    ds_read_b64_tr_b16 v[104:105], v246 offset:8192
    ds_read_b64_tr_b16 v[106:107], v246 offset:9216
    v_mfma_f32_16x16x32_bf16 v[204:207], v[108:111], v[148:151], v[204:207]
    ds_read_b64_tr_b16 v[108:109], v247 offset:8192
    ds_read_b64_tr_b16 v[110:111], v247 offset:9216
    s_waitcnt vmcnt(4)
    v_mfma_f32_16x16x32_bf16 v[192:195], v[112:115], v[152:155], v[192:195]
    ds_read_b64_tr_b16 v[112:113], v244 offset:12288
    ds_read_b64_tr_b16 v[114:115], v244 offset:13312
    v_mfma_f32_16x16x32_bf16 v[196:199], v[116:119], v[152:155], v[196:199]
    ds_read_b64_tr_b16 v[116:117], v245 offset:12288
    ds_read_b64_tr_b16 v[118:119], v245 offset:13312
    v_mfma_f32_16x16x32_bf16 v[200:203], v[120:123], v[152:155], v[200:203]
    ds_read_b64_tr_b16 v[120:121], v246 offset:12288
    ds_read_b64_tr_b16 v[122:123], v246 offset:13312
    v_mfma_f32_16x16x32_bf16 v[204:207], v[124:127], v[152:155], v[204:207]
    ds_read_b64_tr_b16 v[124:125], v247 offset:12288
    ds_read_b64_tr_b16 v[126:127], v247 offset:13312
    s_waitcnt vmcnt(3)
    s_waitcnt lgkmcnt(14)
    v_mfma_f32_16x16x32_bf16 v[192:195], v[16:19], v[156:159], v[192:195]
    ds_read_b64_tr_b16 v[16:17], v244 offset:16384
    ds_read_b64_tr_b16 v[18:19], v244 offset:17408
    v_mfma_f32_16x16x32_bf16 v[196:199], v[20:23], v[156:159], v[196:199]
    ds_read_b64_tr_b16 v[20:21], v245 offset:16384
    ds_read_b64_tr_b16 v[22:23], v245 offset:17408
    v_mfma_f32_16x16x32_bf16 v[200:203], v[24:27], v[156:159], v[200:203]
    ds_read_b64_tr_b16 v[24:25], v246 offset:16384
    ds_read_b64_tr_b16 v[26:27], v246 offset:17408
    v_mfma_f32_16x16x32_bf16 v[204:207], v[28:31], v[156:159], v[204:207]
    ds_read_b64_tr_b16 v[28:29], v247 offset:16384
    ds_read_b64_tr_b16 v[30:31], v247 offset:17408
    s_waitcnt vmcnt(0)
    v_cmp_ne_u32 vcc, s47, v8
    s_mov_b32 s54, 1048576
    s_and_b32 s3, vcc_lo, 0xfff
    s_cbranch_scc0 L_od_59
L_ow_58:
    buffer_load_dword v8, v237, s[8:11], s58 offen sc1
    s_waitcnt vmcnt(0)
    v_cmp_ne_u32 vcc, s47, v8
    s_sub_u32 s54, s54, 1
    s_cselect_b64 vcc, 0, vcc
    s_and_b32 s3, vcc_lo, 0xfff
    s_cbranch_scc1 L_ow_58
L_od_59:
    s_add_u32 s3, s59, 0
    buffer_load_dwordx4 v[168:171], v242, s[8:11], s3 offen sc1
    s_add_u32 s3, s59, 4096
    buffer_load_dwordx4 v[172:175], v242, s[8:11], s3 offen sc1
    s_add_u32 s3, s59, 8192
    buffer_load_dwordx4 v[176:179], v242, s[8:11], s3 offen sc1
    s_add_u32 s3, s59, 12288
    buffer_load_dwordx4 v[180:183], v242, s[8:11], s3 offen sc1
    s_add_u32 s3, s59, 16384
    buffer_load_dwordx4 v[184:187], v242, s[8:11], s3 offen sc1
    s_add_u32 s3, s59, 20480
    buffer_load_dwordx4 v[188:191], v242, s[8:11], s3 offen sc1
    v_mfma_f32_16x16x32_bf16 v[192:195], v[32:35], v[160:163], v[192:195]
    ds_read_b64_tr_b16 v[32:33], v244 offset:20480
    ds_read_b64_tr_b16 v[34:35], v244 offset:21504
    v_mfma_f32_16x16x32_bf16 v[196:199], v[36:39], v[160:163], v[196:199]
    ds_read_b64_tr_b16 v[36:37], v245 offset:20480
    ds_read_b64_tr_b16 v[38:39], v245 offset:21504
    v_mfma_f32_16x16x32_bf16 v[200:203], v[40:43], v[160:163], v[200:203]
    ds_read_b64_tr_b16 v[40:41], v246 offset:20480
    ds_read_b64_tr_b16 v[42:43], v246 offset:21504
    v_mfma_f32_16x16x32_bf16 v[204:207], v[44:47], v[160:163], v[204:207]
    ds_read_b64_tr_b16 v[44:45], v247 offset:20480
    ds_read_b64_tr_b16 v[46:47], v247 offset:21504
    v_mfma_f32_16x16x32_bf16 v[192:195], v[48:51], v[164:167], v[192:195]
    v_mfma_f32_16x16x32_bf16 v[196:199], v[52:55], v[164:167], v[196:199]
    v_mfma_f32_16x16x32_bf16 v[200:203], v[56:59], v[164:167], v[200:203]
    v_mfma_f32_16x16x32_bf16 v[204:207], v[60:63], v[164:167], v[204:207]
    s_waitcnt vmcnt(5)
    v_mfma_f32_16x16x32_bf16 v[192:195], v[64:67], v[168:171], v[192:195]
    v_mfma_f32_16x16x32_bf16 v[196:199], v[68:71], v[168:171], v[196:199]
    v_mfma_f32_16x16x32_bf16 v[200:203], v[72:75], v[168:171], v[200:203]
    v_mfma_f32_16x16x32_bf16 v[204:207], v[76:79], v[168:171], v[204:207]
    s_waitcnt vmcnt(4)
    v_mfma_f32_16x16x32_bf16 v[192:195], v[80:83], v[172:175], v[192:195]
    v_mfma_f32_16x16x32_bf16 v[196:199], v[84:87], v[172:175], v[196:199]
    v_mfma_f32_16x16x32_bf16 v[200:203], v[88:91], v[172:175], v[200:203]
    v_mfma_f32_16x16x32_bf16 v[204:207], v[92:95], v[172:175], v[204:207]
    s_waitcnt vmcnt(3)
    s_waitcnt lgkmcnt(14)
    v_mfma_f32_16x16x32_bf16 v[192:195], v[96:99], v[176:179], v[192:195]
    v_mfma_f32_16x16x32_bf16 v[196:199], v[100:103], v[176:179], v[196:199]
    v_mfma_f32_16x16x32_bf16 v[200:203], v[104:107], v[176:179], v[200:203]
    v_mfma_f32_16x16x32_bf16 v[204:207], v[108:111], v[176:179], v[204:207]
    s_waitcnt vmcnt(2)
    v_mfma_f32_16x16x32_bf16 v[192:195], v[112:115], v[180:183], v[192:195]
    v_mfma_f32_16x16x32_bf16 v[196:199], v[116:119], v[180:183], v[196:199]
    v_mfma_f32_16x16x32_bf16 v[200:203], v[120:123], v[180:183], v[200:203]
    v_mfma_f32_16x16x32_bf16 v[204:207], v[124:127], v[180:183], v[204:207]
    s_waitcnt vmcnt(1)
    s_waitcnt lgkmcnt(8)
    v_mfma_f32_16x16x32_bf16 v[192:195], v[16:19], v[184:187], v[192:195]
    v_mfma_f32_16x16x32_bf16 v[196:199], v[20:23], v[184:187], v[196:199]
    v_mfma_f32_16x16x32_bf16 v[200:203], v[24:27], v[184:187], v[200:203]
    v_mfma_f32_16x16x32_bf16 v[204:207], v[28:31], v[184:187], v[204:207]
    s_waitcnt vmcnt(0)
    s_waitcnt lgkmcnt(0)
    v_mfma_f32_16x16x32_bf16 v[192:195], v[32:35], v[188:191], v[192:195]
    v_mfma_f32_16x16x32_bf16 v[196:199], v[36:39], v[188:191], v[196:199]
    v_mfma_f32_16x16x32_bf16 v[200:203], v[40:43], v[188:191], v[200:203]
    v_mfma_f32_16x16x32_bf16 v[204:207], v[44:47], v[188:191], v[204:207]
    s_nop 4
    v_pk_fma_f32 v[192:193], v[192:193], v[208:209], v[232:233]
    v_pk_fma_f32 v[194:195], v[194:195], v[210:211], v[234:235]
    v_cvt_pk_bf16_f32 v16, v192, v193
    v_cvt_pk_bf16_f32 v17, v194, v195
    v_pk_fma_f32 v[196:197], v[196:197], v[212:213], v[238:239]
    v_pk_fma_f32 v[198:199], v[198:199], v[214:215], v[240:241]
    v_cvt_pk_bf16_f32 v18, v196, v197
    v_cvt_pk_bf16_f32 v19, v198, v199
    v_pk_fma_f32 v[200:201], v[200:201], v[216:217], v[248:249]
    v_pk_fma_f32 v[202:203], v[202:203], v[218:219], v[250:251]
    v_cvt_pk_bf16_f32 v20, v200, v201
    v_cvt_pk_bf16_f32 v21, v202, v203
    v_pk_fma_f32 v[204:205], v[204:205], v[220:221], v[252:253]
    v_pk_fma_f32 v[206:207], v[206:207], v[222:223], v[254:255]
    v_cvt_pk_bf16_f32 v22, v204, v205
    v_cvt_pk_bf16_f32 v23, v206, v207
    v_permlane16_swap_b32 v16, v18
    v_permlane16_swap_b32 v17, v19
    buffer_store_dwordx4 v[16:19], v243, s[40:43], 0 offen offset:0
    v_permlane16_swap_b32 v20, v22
    v_permlane16_swap_b32 v21, v23
    buffer_store_dwordx4 v[20:23], v243, s[40:43], 0 offen offset:64
L_finish:
L_exit:
    s_endpgm
L_ds_8:
    buffer_store_dwordx4 v[96:99], v2, s[8:11], s56 offen offset:0 sc1
    s_branch L_de_9
L_ds_10:
    buffer_store_dwordx4 v[100:103], v2, s[8:11], s56 offen offset:1024 sc1
    s_branch L_de_11
L_ds_12:
    buffer_store_dword v6, v7, s[8:11], s56 offen sc1
    s_branch L_de_13
L_ds_50:
    buffer_store_dword v238, v239, s[8:11], s57 offen sc1
    s_branch L_de_51
L_code_end:
.section .rodata,"a"
.p2align 6
.amdhsa_kernel recurrent_scan__grouped_kv_mqa__mixer_channel_mlp__prompt_kernel
  .amdhsa_next_free_vgpr 256
  .amdhsa_next_free_sgpr 102
  .amdhsa_accum_offset 256
  .amdhsa_group_segment_fixed_size 0
  .amdhsa_kernarg_size 104
  .amdhsa_user_sgpr_count 2
  .amdhsa_user_sgpr_kernarg_segment_ptr 1
  .amdhsa_system_sgpr_workgroup_id_x 1
  .amdhsa_float_denorm_mode_32 3
.end_amdhsa_kernel
```
